```python
import torch

def _softmax(x, axis=-1):
    return torch.softmax(x, dim=axis)
def _gelu(x):
    return torch.nn.functional.gelu(x, approximate="tanh")
def _silu(x):
    return torch.nn.functional.silu(x)
def _sigmoid(x):
    return torch.sigmoid(x)
def _layernorm(x, axis=-1, eps=1e-5):
    m = x.mean(dim=axis, keepdim=True)
    v = x.var(dim=axis, keepdim=True, unbiased=False)
    return (x - m) / torch.sqrt(v + eps)
def _scatter_add(tgt, idx, src, axis=0):
    return tgt.clone().index_add_(axis, idx, src)
def _segment_sum(src, seg, n):
    out = torch.zeros((n,) + src.shape[1:], dtype=src.dtype)
    return out.index_add_(0, seg, src)
def _pad(x, pw):
    flat = tuple(v for pair in reversed(pw) for v in pair)
    return torch.nn.functional.pad(x, flat)

kernel_name = 'standalone__gqa_block_cached__near_ridge'

def setup_inputs():

    _w = (lambda a: (lambda t: t.to(torch.bfloat16) if t.is_floating_point() else t)(torch.as_tensor(a)))
    B, Sq, D = 8, 112, 448
    Hq, Hkv, Sk, Dh = 16, 8, 1024, 256
    assert Hq % Hkv == 0, (Hq, Hkv)
    return {
        "x": _w((lambda *s: torch.randn(*s, dtype=torch.bfloat16) * 0.8)(B, Sq, D)),
        "k_cache": _w((lambda *s: torch.randn(*s, dtype=torch.bfloat16) * 0.8)(B, Hkv, Sk, Dh)),
        "v_cache": _w((lambda *s: torch.randn(*s, dtype=torch.bfloat16) * 0.05)(B, Hkv, Sk, Dh)),
        "wq": _w((lambda *s: torch.randn(*s, dtype=torch.bfloat16) * 0.8)(D, Hq * Dh) * (D ** -0.5)),
        "wo": _w((lambda *s: torch.randn(*s, dtype=torch.bfloat16) * 0.05)(Hq * Dh, D) * ((Hq * Dh) ** -0.5)),
    }

def reference(x, k_cache, v_cache, wq, wo):
    B, Sq, D = x.shape
    Hq, Dh = 16, 256
    Hkv = k_cache.shape[1]
    rep = Hq // Hkv
    q = (lambda x, *d: x.permute(*d))((x @ wq).reshape(B, Sq, Hq, Dh), 0, 2, 1, 3)
    k = (lambda x, n, axis: torch.repeat_interleave(x, n, dim=axis))(k_cache, rep, axis=1)
    v = (lambda x, n, axis: torch.repeat_interleave(x, n, dim=axis))(v_cache, rep, axis=1)
    scores = torch.einsum("bhqd,bhkd->bhqk", q, k) * (Dh ** -0.5)
    p = _softmax(scores, axis=-1)
    o = torch.einsum("bhqk,bhkd->bhqd", p, v)
    return (lambda x, *d: x.permute(*d))(o, 0, 2, 1, 3).reshape(B, Sq, Hq * Dh) @ wo
```

```asm
; @launch kernel=fused_kernel grid=(256,1,1) block=(256,1,1) lds=163840
; @launch kernel=reduce_kernel grid=(392,1,1) block=(256,1,1) lds=0
.amdgcn_target "amdgcn-amd-amdhsa--gfx950"
.text
.globl fused_kernel
.p2align 8
.type fused_kernel,@function
fused_kernel:
    s_cmp_ge_u32 s2, 256
    s_cbranch_scc1 fused_kernel_end
    s_load_dwordx4 s[4:7], s[0:1], 0
    s_load_dwordx4 s[8:11], s[0:1], 16
    s_load_dwordx2 s[40:41], s[0:1], 32
    s_load_dwordx2 s[42:43], s[0:1], 56
    s_and_b32 s24, s2, 7
    s_lshr_b32 s25, s2, 3
    s_lshr_b32 s27, s25, 2
    s_and_b32 s25, s25, 3
    s_lshl_b32 s27, s27, 3
    s_add_u32 s24, s24, s27
    v_and_b32 v1, 63, v0
    v_lshrrev_b32 v2, 6, v0
    s_nop 0
    v_readfirstlane_b32 s26, v2
    s_lshr_b32 s28, s24, 3
    s_and_b32 s29, s24, 7
    s_lshl_b32 s29, s29, 1
    s_lshr_b32 s27, s25, 1
    s_add_u32 s29, s29, s27
    s_and_b32 s27, s25, 1
    s_mul_i32 s27, s27, 56
    s_mul_i32 s31, s26, 40960
    s_lshl_b32 s30, s24, 19
    s_lshl_b32 s34, s26, 17
    s_add_u32 s30, s30, s34
    s_mov_b32 s33, 0x3db8aa3b
    s_waitcnt lgkmcnt(0)
    s_mov_b32 s12, s6
    s_and_b32 s13, s7, 0xffff
    s_mov_b32 s14, 0x2000000
    s_mov_b32 s15, 0x00020000
    s_mov_b32 s16, s8
    s_and_b32 s17, s9, 0xffff
    s_mov_b32 s18, 0x2000000
    s_mov_b32 s19, 0x00020000
    s_mov_b32 s20, s4
    s_and_b32 s21, s5, 0xffff
    s_mov_b32 s22, 0xc4000
    s_mov_b32 s23, 0x00020000
    s_mov_b32 s36, s10
    s_and_b32 s37, s11, 0xffff
    s_mov_b32 s38, 0x380000
    s_mov_b32 s39, 0x00020000
    s_getpc_b64 s[46:47]
fused_kernel_pc0:
    s_add_u32 s46, s46, fused_kernel_sub0-fused_kernel_pc0
    s_addc_u32 s47, s47, 0
    s_getpc_b64 s[48:49]
fused_kernel_pc1:
    s_add_u32 s48, s48, fused_kernel_sub1-fused_kernel_pc1
    s_addc_u32 s49, s49, 0
    v_and_b32 v3, 31, v1
    v_lshrrev_b32 v4, 5, v1
    v_lshlrev_b32 v5, 4, v1
    s_mul_i32 s34, s28, 112
    s_add_u32 s34, s34, s27
    s_mul_i32 s34, s34, 896
    s_mul_i32 s35, s26, 14336
    s_add_u32 s34, s34, s35
    s_add_u32 s35, s35, 98304
    s_add_u32 m0, s35, 0
    s_add_u32 s32, s34, 0
    buffer_load_dwordx4 v5, s[20:23], s32 offen lds
    s_add_u32 m0, s35, 1024
    s_add_u32 s32, s34, 1024
    buffer_load_dwordx4 v5, s[20:23], s32 offen lds
    s_add_u32 m0, s35, 2048
    s_add_u32 s32, s34, 2048
    buffer_load_dwordx4 v5, s[20:23], s32 offen lds
    s_add_u32 m0, s35, 3072
    s_add_u32 s32, s34, 3072
    buffer_load_dwordx4 v5, s[20:23], s32 offen lds
    s_add_u32 m0, s35, 4096
    s_add_u32 s32, s34, 4096
    buffer_load_dwordx4 v5, s[20:23], s32 offen lds
    s_add_u32 m0, s35, 5120
    s_add_u32 s32, s34, 5120
    buffer_load_dwordx4 v5, s[20:23], s32 offen lds
    s_add_u32 m0, s35, 6144
    s_add_u32 s32, s34, 6144
    buffer_load_dwordx4 v5, s[20:23], s32 offen lds
    s_add_u32 m0, s35, 7168
    s_add_u32 s32, s34, 7168
    buffer_load_dwordx4 v5, s[20:23], s32 offen lds
    s_add_u32 m0, s35, 8192
    s_add_u32 s32, s34, 8192
    buffer_load_dwordx4 v5, s[20:23], s32 offen lds
    s_add_u32 m0, s35, 9216
    s_add_u32 s32, s34, 9216
    buffer_load_dwordx4 v5, s[20:23], s32 offen lds
    s_add_u32 m0, s35, 10240
    s_add_u32 s32, s34, 10240
    buffer_load_dwordx4 v5, s[20:23], s32 offen lds
    s_add_u32 m0, s35, 11264
    s_add_u32 s32, s34, 11264
    buffer_load_dwordx4 v5, s[20:23], s32 offen lds
    s_add_u32 m0, s35, 12288
    s_add_u32 s32, s34, 12288
    buffer_load_dwordx4 v5, s[20:23], s32 offen lds
    s_add_u32 m0, s35, 13312
    s_add_u32 s32, s34, 13312
    buffer_load_dwordx4 v5, s[20:23], s32 offen lds
    s_mul_i32 s31, s26, 24576
    v_lshrrev_b32 v5, 3, v1
    v_and_b32 v6, 7, v1
    v_and_b32 v7, 1, v5
    v_lshlrev_b32 v7, 2, v7
    v_xor_b32 v6, v6, v7
    v_lshlrev_b32 v6, 4, v6
    v_lshlrev_b32 v5, 13, v5
    v_add_u32 v7, v5, v6
    s_lshl_b32 s34, s29, 9
    s_lshl_b32 s35, s26, 7
    s_add_u32 s34, s34, s35
    v_add_u32 v7, s34, v7
    s_add_u32 m0, s31, 0
    s_mov_b32 s34, 0
    buffer_load_dwordx4 v7, s[36:39], s34 offen lds
    s_add_u32 m0, s31, 1024
    s_mov_b32 s34, 65536
    buffer_load_dwordx4 v7, s[36:39], s34 offen lds
    s_add_u32 m0, s31, 2048
    s_mov_b32 s34, 131072
    buffer_load_dwordx4 v7, s[36:39], s34 offen lds
    s_add_u32 m0, s31, 3072
    s_mov_b32 s34, 196608
    buffer_load_dwordx4 v7, s[36:39], s34 offen lds
    s_add_u32 m0, s31, 4096
    s_mov_b32 s34, 262144
    buffer_load_dwordx4 v7, s[36:39], s34 offen lds
    s_add_u32 m0, s31, 5120
    s_mov_b32 s34, 327680
    buffer_load_dwordx4 v7, s[36:39], s34 offen lds
    s_add_u32 m0, s31, 6144
    s_mov_b32 s34, 393216
    buffer_load_dwordx4 v7, s[36:39], s34 offen lds
    s_add_u32 m0, s31, 7168
    s_mov_b32 s34, 458752
    buffer_load_dwordx4 v7, s[36:39], s34 offen lds
    s_add_u32 m0, s31, 8192
    s_mov_b32 s34, 524288
    buffer_load_dwordx4 v7, s[36:39], s34 offen lds
    s_add_u32 m0, s31, 9216
    s_mov_b32 s34, 589824
    buffer_load_dwordx4 v7, s[36:39], s34 offen lds
    s_add_u32 m0, s31, 10240
    s_mov_b32 s34, 655360
    buffer_load_dwordx4 v7, s[36:39], s34 offen lds
    s_add_u32 m0, s31, 11264
    s_mov_b32 s34, 720896
    buffer_load_dwordx4 v7, s[36:39], s34 offen lds
    s_add_u32 m0, s31, 12288
    s_mov_b32 s34, 786432
    buffer_load_dwordx4 v7, s[36:39], s34 offen lds
    s_add_u32 m0, s31, 13312
    s_mov_b32 s34, 851968
    buffer_load_dwordx4 v7, s[36:39], s34 offen lds
    s_add_u32 m0, s31, 14336
    s_mov_b32 s34, 917504
    buffer_load_dwordx4 v7, s[36:39], s34 offen lds
    s_add_u32 m0, s31, 15360
    s_mov_b32 s34, 983040
    buffer_load_dwordx4 v7, s[36:39], s34 offen lds
    s_add_u32 m0, s31, 16384
    s_mov_b32 s34, 1048576
    buffer_load_dwordx4 v7, s[36:39], s34 offen lds
    s_add_u32 m0, s31, 17408
    s_mov_b32 s34, 1114112
    buffer_load_dwordx4 v7, s[36:39], s34 offen lds
    s_add_u32 m0, s31, 18432
    s_mov_b32 s34, 1179648
    buffer_load_dwordx4 v7, s[36:39], s34 offen lds
    s_add_u32 m0, s31, 19456
    s_mov_b32 s34, 1245184
    buffer_load_dwordx4 v7, s[36:39], s34 offen lds
    s_add_u32 m0, s31, 20480
    s_mov_b32 s34, 1310720
    buffer_load_dwordx4 v7, s[36:39], s34 offen lds
    s_add_u32 m0, s31, 21504
    s_mov_b32 s34, 1376256
    buffer_load_dwordx4 v7, s[36:39], s34 offen lds
    s_add_u32 m0, s31, 22528
    s_mov_b32 s34, 1441792
    buffer_load_dwordx4 v7, s[36:39], s34 offen lds
    s_add_u32 m0, s31, 23552
    s_mov_b32 s34, 1507328
    buffer_load_dwordx4 v7, s[36:39], s34 offen lds
    v_and_b32 v5, 15, v1
    v_lshrrev_b32 v5, 2, v5
    v_lshlrev_b32 v6, 3, v4
    v_add_u32 v6, v6, v5
    v_lshlrev_b32 v6, 7, v6
    v_lshrrev_b32 v8, 4, v1
    v_and_b32 v8, 1, v8
    v_lshlrev_b32 v8, 5, v8
    v_add_u32 v6, v6, v8
    v_and_b32 v8, 3, v1
    v_lshlrev_b32 v8, 3, v8
    v_add_u32 v6, v6, v8
    v_add_u32 v6, s31, v6
    v_and_b32 v5, 1, v5
    v_xor_b32 v9, 0, v5
    v_lshlrev_b32 v9, 6, v9
    v_add_u32 v8, v6, v9
    v_xor_b32 v9, 1, v5
    v_lshlrev_b32 v9, 6, v9
    v_add_u32 v9, v6, v9
    s_waitcnt vmcnt(24)
    s_barrier
    s_movk_i32 s34, 896
    v_mul_lo_u32 v5, v3, s34
    v_lshlrev_b32 v6, 4, v4
    v_add_u32 v5, v5, v6
    v_add_u32 v5, 98304, v5
    ds_read_b128 v[32:35], v5 offset:0
    ds_read_b128 v[36:39], v5 offset:32
    ds_read_b128 v[40:43], v5 offset:64
    ds_read_b128 v[44:47], v5 offset:96
    ds_read_b128 v[48:51], v5 offset:128
    ds_read_b128 v[52:55], v5 offset:160
    ds_read_b128 v[56:59], v5 offset:192
    ds_read_b128 v[60:63], v5 offset:224
    ds_read_b128 v[64:67], v5 offset:256
    ds_read_b128 v[68:71], v5 offset:288
    ds_read_b128 v[72:75], v5 offset:320
    ds_read_b128 v[76:79], v5 offset:352
    ds_read_b128 v[80:83], v5 offset:384
    ds_read_b128 v[84:87], v5 offset:416
    ds_read_b128 v[88:91], v5 offset:448
    ds_read_b128 v[92:95], v5 offset:480
    ds_read_b128 v[96:99], v5 offset:512
    ds_read_b128 v[100:103], v5 offset:544
    ds_read_b128 v[104:107], v5 offset:576
    ds_read_b128 v[108:111], v5 offset:608
    ds_read_b128 v[112:115], v5 offset:640
    ds_read_b128 v[116:119], v5 offset:672
    ds_read_b128 v[120:123], v5 offset:704
    ds_read_b128 v[124:127], v5 offset:736
    ds_read_b128 v[128:131], v5 offset:768
    ds_read_b128 v[132:135], v5 offset:800
    ds_read_b128 v[136:139], v5 offset:832
    ds_read_b128 v[140:143], v5 offset:864
    ds_read_b128 v[144:147], v5 offset:28672
    ds_read_b128 v[148:151], v5 offset:28704
    ds_read_b128 v[152:155], v5 offset:28736
    ds_read_b128 v[156:159], v5 offset:28768
    ds_read_b128 v[160:163], v5 offset:28800
    ds_read_b128 v[164:167], v5 offset:28832
    ds_read_b128 v[168:171], v5 offset:28864
    ds_read_b128 v[172:175], v5 offset:28896
    ds_read_b128 v[176:179], v5 offset:28928
    ds_read_b128 v[180:183], v5 offset:28960
    ds_read_b128 v[184:187], v5 offset:28992
    ds_read_b128 v[188:191], v5 offset:29024
    ds_read_b128 v[192:195], v5 offset:29056
    ds_read_b128 v[196:199], v5 offset:29088
    ds_read_b128 v[200:203], v5 offset:29120
    ds_read_b128 v[204:207], v5 offset:29152
    ds_read_b128 v[208:211], v5 offset:29184
    ds_read_b128 v[212:215], v5 offset:29216
    ds_read_b128 v[216:219], v5 offset:29248
    ds_read_b128 v[220:223], v5 offset:29280
    ds_read_b128 v[224:227], v5 offset:29312
    ds_read_b128 v[228:231], v5 offset:29344
    ds_read_b128 v[232:235], v5 offset:29376
    ds_read_b128 v[236:239], v5 offset:29408
    ds_read_b128 v[240:243], v5 offset:29440
    ds_read_b128 v[244:247], v5 offset:29472
    ds_read_b128 v[248:251], v5 offset:29504
    ds_read_b128 v[252:255], v5 offset:29536
    s_waitcnt vmcnt(16)
    ds_read_b64_tr_b16 a[64:65], v8 offset:0
    ds_read_b64_tr_b16 a[66:67], v8 offset:512
    ds_read_b64_tr_b16 a[68:69], v9 offset:0
    ds_read_b64_tr_b16 a[70:71], v9 offset:512
    s_waitcnt lgkmcnt(0)
    v_mfma_f32_32x32x16_bf16 a[0:15], a[64:67], v[32:35], 0
    v_mfma_f32_32x32x16_bf16 a[16:31], a[64:67], v[144:147], 0
    v_mfma_f32_32x32x16_bf16 a[32:47], a[68:71], v[32:35], 0
    v_mfma_f32_32x32x16_bf16 a[48:63], a[68:71], v[144:147], 0
    ds_read_b64_tr_b16 a[72:73], v8 offset:2048
    ds_read_b64_tr_b16 a[74:75], v8 offset:2560
    ds_read_b64_tr_b16 a[76:77], v9 offset:2048
    ds_read_b64_tr_b16 a[78:79], v9 offset:2560
    s_waitcnt lgkmcnt(0)
    v_mfma_f32_32x32x16_bf16 a[0:15], a[72:75], v[36:39], a[0:15]
    v_mfma_f32_32x32x16_bf16 a[16:31], a[72:75], v[148:151], a[16:31]
    v_mfma_f32_32x32x16_bf16 a[32:47], a[76:79], v[36:39], a[32:47]
    v_mfma_f32_32x32x16_bf16 a[48:63], a[76:79], v[148:151], a[48:63]
    ds_read_b64_tr_b16 a[64:65], v8 offset:4096
    ds_read_b64_tr_b16 a[66:67], v8 offset:4608
    ds_read_b64_tr_b16 a[68:69], v9 offset:4096
    ds_read_b64_tr_b16 a[70:71], v9 offset:4608
    s_waitcnt lgkmcnt(0)
    v_mfma_f32_32x32x16_bf16 a[0:15], a[64:67], v[40:43], a[0:15]
    v_mfma_f32_32x32x16_bf16 a[16:31], a[64:67], v[152:155], a[16:31]
    v_mfma_f32_32x32x16_bf16 a[32:47], a[68:71], v[40:43], a[32:47]
    v_mfma_f32_32x32x16_bf16 a[48:63], a[68:71], v[152:155], a[48:63]
    ds_read_b64_tr_b16 a[72:73], v8 offset:6144
    ds_read_b64_tr_b16 a[74:75], v8 offset:6656
    ds_read_b64_tr_b16 a[76:77], v9 offset:6144
    ds_read_b64_tr_b16 a[78:79], v9 offset:6656
    s_waitcnt lgkmcnt(0)
    v_mfma_f32_32x32x16_bf16 a[0:15], a[72:75], v[44:47], a[0:15]
    v_mfma_f32_32x32x16_bf16 a[16:31], a[72:75], v[156:159], a[16:31]
    v_mfma_f32_32x32x16_bf16 a[32:47], a[76:79], v[44:47], a[32:47]
    v_mfma_f32_32x32x16_bf16 a[48:63], a[76:79], v[156:159], a[48:63]
    s_add_u32 m0, s31, 0
    s_mov_b32 s34, 1572864
    buffer_load_dwordx4 v7, s[36:39], s34 offen lds
    s_add_u32 m0, s31, 1024
    s_mov_b32 s34, 1638400
    buffer_load_dwordx4 v7, s[36:39], s34 offen lds
    s_add_u32 m0, s31, 2048
    s_mov_b32 s34, 1703936
    buffer_load_dwordx4 v7, s[36:39], s34 offen lds
    s_add_u32 m0, s31, 3072
    s_mov_b32 s34, 1769472
    buffer_load_dwordx4 v7, s[36:39], s34 offen lds
    s_add_u32 m0, s31, 4096
    s_mov_b32 s34, 1835008
    buffer_load_dwordx4 v7, s[36:39], s34 offen lds
    s_add_u32 m0, s31, 5120
    s_mov_b32 s34, 1900544
    buffer_load_dwordx4 v7, s[36:39], s34 offen lds
    s_add_u32 m0, s31, 6144
    s_mov_b32 s34, 1966080
    buffer_load_dwordx4 v7, s[36:39], s34 offen lds
    s_add_u32 m0, s31, 7168
    s_mov_b32 s34, 2031616
    buffer_load_dwordx4 v7, s[36:39], s34 offen lds
    s_waitcnt vmcnt(16)
    ds_read_b64_tr_b16 a[64:65], v8 offset:8192
    ds_read_b64_tr_b16 a[66:67], v8 offset:8704
    ds_read_b64_tr_b16 a[68:69], v9 offset:8192
    ds_read_b64_tr_b16 a[70:71], v9 offset:8704
    s_waitcnt lgkmcnt(0)
    v_mfma_f32_32x32x16_bf16 a[0:15], a[64:67], v[48:51], a[0:15]
    v_mfma_f32_32x32x16_bf16 a[16:31], a[64:67], v[160:163], a[16:31]
    v_mfma_f32_32x32x16_bf16 a[32:47], a[68:71], v[48:51], a[32:47]
    v_mfma_f32_32x32x16_bf16 a[48:63], a[68:71], v[160:163], a[48:63]
    ds_read_b64_tr_b16 a[72:73], v8 offset:10240
    ds_read_b64_tr_b16 a[74:75], v8 offset:10752
    ds_read_b64_tr_b16 a[76:77], v9 offset:10240
    ds_read_b64_tr_b16 a[78:79], v9 offset:10752
    s_waitcnt lgkmcnt(0)
    v_mfma_f32_32x32x16_bf16 a[0:15], a[72:75], v[52:55], a[0:15]
    v_mfma_f32_32x32x16_bf16 a[16:31], a[72:75], v[164:167], a[16:31]
    v_mfma_f32_32x32x16_bf16 a[32:47], a[76:79], v[52:55], a[32:47]
    v_mfma_f32_32x32x16_bf16 a[48:63], a[76:79], v[164:167], a[48:63]
    ds_read_b64_tr_b16 a[64:65], v8 offset:12288
    ds_read_b64_tr_b16 a[66:67], v8 offset:12800
    ds_read_b64_tr_b16 a[68:69], v9 offset:12288
    ds_read_b64_tr_b16 a[70:71], v9 offset:12800
    s_waitcnt lgkmcnt(0)
    v_mfma_f32_32x32x16_bf16 a[0:15], a[64:67], v[56:59], a[0:15]
    v_mfma_f32_32x32x16_bf16 a[16:31], a[64:67], v[168:171], a[16:31]
    v_mfma_f32_32x32x16_bf16 a[32:47], a[68:71], v[56:59], a[32:47]
    v_mfma_f32_32x32x16_bf16 a[48:63], a[68:71], v[168:171], a[48:63]
    ds_read_b64_tr_b16 a[72:73], v8 offset:14336
    ds_read_b64_tr_b16 a[74:75], v8 offset:14848
    ds_read_b64_tr_b16 a[76:77], v9 offset:14336
    ds_read_b64_tr_b16 a[78:79], v9 offset:14848
    s_waitcnt lgkmcnt(0)
    v_mfma_f32_32x32x16_bf16 a[0:15], a[72:75], v[60:63], a[0:15]
    v_mfma_f32_32x32x16_bf16 a[16:31], a[72:75], v[172:175], a[16:31]
    v_mfma_f32_32x32x16_bf16 a[32:47], a[76:79], v[60:63], a[32:47]
    v_mfma_f32_32x32x16_bf16 a[48:63], a[76:79], v[172:175], a[48:63]
    s_add_u32 m0, s31, 8192
    s_mov_b32 s34, 2097152
    buffer_load_dwordx4 v7, s[36:39], s34 offen lds
    s_add_u32 m0, s31, 9216
    s_mov_b32 s34, 2162688
    buffer_load_dwordx4 v7, s[36:39], s34 offen lds
    s_add_u32 m0, s31, 10240
    s_mov_b32 s34, 2228224
    buffer_load_dwordx4 v7, s[36:39], s34 offen lds
    s_add_u32 m0, s31, 11264
    s_mov_b32 s34, 2293760
    buffer_load_dwordx4 v7, s[36:39], s34 offen lds
    s_add_u32 m0, s31, 12288
    s_mov_b32 s34, 2359296
    buffer_load_dwordx4 v7, s[36:39], s34 offen lds
    s_add_u32 m0, s31, 13312
    s_mov_b32 s34, 2424832
    buffer_load_dwordx4 v7, s[36:39], s34 offen lds
    s_add_u32 m0, s31, 14336
    s_mov_b32 s34, 2490368
    buffer_load_dwordx4 v7, s[36:39], s34 offen lds
    s_add_u32 m0, s31, 15360
    s_mov_b32 s34, 2555904
    buffer_load_dwordx4 v7, s[36:39], s34 offen lds
    s_waitcnt vmcnt(16)
    ds_read_b64_tr_b16 a[64:65], v8 offset:16384
    ds_read_b64_tr_b16 a[66:67], v8 offset:16896
    ds_read_b64_tr_b16 a[68:69], v9 offset:16384
    ds_read_b64_tr_b16 a[70:71], v9 offset:16896
    s_waitcnt lgkmcnt(0)
    v_mfma_f32_32x32x16_bf16 a[0:15], a[64:67], v[64:67], a[0:15]
    v_mfma_f32_32x32x16_bf16 a[16:31], a[64:67], v[176:179], a[16:31]
    v_mfma_f32_32x32x16_bf16 a[32:47], a[68:71], v[64:67], a[32:47]
    v_mfma_f32_32x32x16_bf16 a[48:63], a[68:71], v[176:179], a[48:63]
    ds_read_b64_tr_b16 a[72:73], v8 offset:18432
    ds_read_b64_tr_b16 a[74:75], v8 offset:18944
    ds_read_b64_tr_b16 a[76:77], v9 offset:18432
    ds_read_b64_tr_b16 a[78:79], v9 offset:18944
    s_waitcnt lgkmcnt(0)
    v_mfma_f32_32x32x16_bf16 a[0:15], a[72:75], v[68:71], a[0:15]
    v_mfma_f32_32x32x16_bf16 a[16:31], a[72:75], v[180:183], a[16:31]
    v_mfma_f32_32x32x16_bf16 a[32:47], a[76:79], v[68:71], a[32:47]
    v_mfma_f32_32x32x16_bf16 a[48:63], a[76:79], v[180:183], a[48:63]
    ds_read_b64_tr_b16 a[64:65], v8 offset:20480
    ds_read_b64_tr_b16 a[66:67], v8 offset:20992
    ds_read_b64_tr_b16 a[68:69], v9 offset:20480
    ds_read_b64_tr_b16 a[70:71], v9 offset:20992
    s_waitcnt lgkmcnt(0)
    v_mfma_f32_32x32x16_bf16 a[0:15], a[64:67], v[72:75], a[0:15]
    v_mfma_f32_32x32x16_bf16 a[16:31], a[64:67], v[184:187], a[16:31]
    v_mfma_f32_32x32x16_bf16 a[32:47], a[68:71], v[72:75], a[32:47]
    v_mfma_f32_32x32x16_bf16 a[48:63], a[68:71], v[184:187], a[48:63]
    ds_read_b64_tr_b16 a[72:73], v8 offset:22528
    ds_read_b64_tr_b16 a[74:75], v8 offset:23040
    ds_read_b64_tr_b16 a[76:77], v9 offset:22528
    ds_read_b64_tr_b16 a[78:79], v9 offset:23040
    s_waitcnt lgkmcnt(0)
    v_mfma_f32_32x32x16_bf16 a[0:15], a[72:75], v[76:79], a[0:15]
    v_mfma_f32_32x32x16_bf16 a[16:31], a[72:75], v[188:191], a[16:31]
    v_mfma_f32_32x32x16_bf16 a[32:47], a[76:79], v[76:79], a[32:47]
    v_mfma_f32_32x32x16_bf16 a[48:63], a[76:79], v[188:191], a[48:63]
    s_add_u32 m0, s31, 16384
    s_mov_b32 s34, 2621440
    buffer_load_dwordx4 v7, s[36:39], s34 offen lds
    s_add_u32 m0, s31, 17408
    s_mov_b32 s34, 2686976
    buffer_load_dwordx4 v7, s[36:39], s34 offen lds
    s_add_u32 m0, s31, 18432
    s_mov_b32 s34, 2752512
    buffer_load_dwordx4 v7, s[36:39], s34 offen lds
    s_add_u32 m0, s31, 19456
    s_mov_b32 s34, 2818048
    buffer_load_dwordx4 v7, s[36:39], s34 offen lds
    s_add_u32 m0, s31, 20480
    s_mov_b32 s34, 2883584
    buffer_load_dwordx4 v7, s[36:39], s34 offen lds
    s_add_u32 m0, s31, 21504
    s_mov_b32 s34, 2949120
    buffer_load_dwordx4 v7, s[36:39], s34 offen lds
    s_add_u32 m0, s31, 22528
    s_mov_b32 s34, 3014656
    buffer_load_dwordx4 v7, s[36:39], s34 offen lds
    s_add_u32 m0, s31, 23552
    s_mov_b32 s34, 3080192
    buffer_load_dwordx4 v7, s[36:39], s34 offen lds
    s_waitcnt vmcnt(16)
    ds_read_b64_tr_b16 a[64:65], v8 offset:0
    ds_read_b64_tr_b16 a[66:67], v8 offset:512
    ds_read_b64_tr_b16 a[68:69], v9 offset:0
    ds_read_b64_tr_b16 a[70:71], v9 offset:512
    s_waitcnt lgkmcnt(0)
    v_mfma_f32_32x32x16_bf16 a[0:15], a[64:67], v[80:83], a[0:15]
    v_mfma_f32_32x32x16_bf16 a[16:31], a[64:67], v[192:195], a[16:31]
    v_mfma_f32_32x32x16_bf16 a[32:47], a[68:71], v[80:83], a[32:47]
    v_mfma_f32_32x32x16_bf16 a[48:63], a[68:71], v[192:195], a[48:63]
    ds_read_b64_tr_b16 a[72:73], v8 offset:2048
    ds_read_b64_tr_b16 a[74:75], v8 offset:2560
    ds_read_b64_tr_b16 a[76:77], v9 offset:2048
    ds_read_b64_tr_b16 a[78:79], v9 offset:2560
    s_waitcnt lgkmcnt(0)
    v_mfma_f32_32x32x16_bf16 a[0:15], a[72:75], v[84:87], a[0:15]
    v_mfma_f32_32x32x16_bf16 a[16:31], a[72:75], v[196:199], a[16:31]
    v_mfma_f32_32x32x16_bf16 a[32:47], a[76:79], v[84:87], a[32:47]
    v_mfma_f32_32x32x16_bf16 a[48:63], a[76:79], v[196:199], a[48:63]
    ds_read_b64_tr_b16 a[64:65], v8 offset:4096
    ds_read_b64_tr_b16 a[66:67], v8 offset:4608
    ds_read_b64_tr_b16 a[68:69], v9 offset:4096
    ds_read_b64_tr_b16 a[70:71], v9 offset:4608
    s_waitcnt lgkmcnt(0)
    v_mfma_f32_32x32x16_bf16 a[0:15], a[64:67], v[88:91], a[0:15]
    v_mfma_f32_32x32x16_bf16 a[16:31], a[64:67], v[200:203], a[16:31]
    v_mfma_f32_32x32x16_bf16 a[32:47], a[68:71], v[88:91], a[32:47]
    v_mfma_f32_32x32x16_bf16 a[48:63], a[68:71], v[200:203], a[48:63]
    ds_read_b64_tr_b16 a[72:73], v8 offset:6144
    ds_read_b64_tr_b16 a[74:75], v8 offset:6656
    ds_read_b64_tr_b16 a[76:77], v9 offset:6144
    ds_read_b64_tr_b16 a[78:79], v9 offset:6656
    s_waitcnt lgkmcnt(0)
    v_mfma_f32_32x32x16_bf16 a[0:15], a[72:75], v[92:95], a[0:15]
    v_mfma_f32_32x32x16_bf16 a[16:31], a[72:75], v[204:207], a[16:31]
    v_mfma_f32_32x32x16_bf16 a[32:47], a[76:79], v[92:95], a[32:47]
    v_mfma_f32_32x32x16_bf16 a[48:63], a[76:79], v[204:207], a[48:63]
    s_add_u32 m0, s31, 0
    s_mov_b32 s34, 3145728
    buffer_load_dwordx4 v7, s[36:39], s34 offen lds
    s_add_u32 m0, s31, 1024
    s_mov_b32 s34, 3211264
    buffer_load_dwordx4 v7, s[36:39], s34 offen lds
    s_add_u32 m0, s31, 2048
    s_mov_b32 s34, 3276800
    buffer_load_dwordx4 v7, s[36:39], s34 offen lds
    s_add_u32 m0, s31, 3072
    s_mov_b32 s34, 3342336
    buffer_load_dwordx4 v7, s[36:39], s34 offen lds
    s_add_u32 m0, s31, 4096
    s_mov_b32 s34, 3407872
    buffer_load_dwordx4 v7, s[36:39], s34 offen lds
    s_add_u32 m0, s31, 5120
    s_mov_b32 s34, 3473408
    buffer_load_dwordx4 v7, s[36:39], s34 offen lds
    s_add_u32 m0, s31, 6144
    s_mov_b32 s34, 3538944
    buffer_load_dwordx4 v7, s[36:39], s34 offen lds
    s_add_u32 m0, s31, 7168
    s_mov_b32 s34, 3604480
    buffer_load_dwordx4 v7, s[36:39], s34 offen lds
    s_waitcnt vmcnt(16)
    ds_read_b64_tr_b16 a[64:65], v8 offset:8192
    ds_read_b64_tr_b16 a[66:67], v8 offset:8704
    ds_read_b64_tr_b16 a[68:69], v9 offset:8192
    ds_read_b64_tr_b16 a[70:71], v9 offset:8704
    s_waitcnt lgkmcnt(0)
    v_mfma_f32_32x32x16_bf16 a[0:15], a[64:67], v[96:99], a[0:15]
    v_mfma_f32_32x32x16_bf16 a[16:31], a[64:67], v[208:211], a[16:31]
    v_mfma_f32_32x32x16_bf16 a[32:47], a[68:71], v[96:99], a[32:47]
    v_mfma_f32_32x32x16_bf16 a[48:63], a[68:71], v[208:211], a[48:63]
    ds_read_b64_tr_b16 a[72:73], v8 offset:10240
    ds_read_b64_tr_b16 a[74:75], v8 offset:10752
    ds_read_b64_tr_b16 a[76:77], v9 offset:10240
    ds_read_b64_tr_b16 a[78:79], v9 offset:10752
    s_waitcnt lgkmcnt(0)
    v_mfma_f32_32x32x16_bf16 a[0:15], a[72:75], v[100:103], a[0:15]
    v_mfma_f32_32x32x16_bf16 a[16:31], a[72:75], v[212:215], a[16:31]
    v_mfma_f32_32x32x16_bf16 a[32:47], a[76:79], v[100:103], a[32:47]
    v_mfma_f32_32x32x16_bf16 a[48:63], a[76:79], v[212:215], a[48:63]
    ds_read_b64_tr_b16 a[64:65], v8 offset:12288
    ds_read_b64_tr_b16 a[66:67], v8 offset:12800
    ds_read_b64_tr_b16 a[68:69], v9 offset:12288
    ds_read_b64_tr_b16 a[70:71], v9 offset:12800
    s_waitcnt lgkmcnt(0)
    v_mfma_f32_32x32x16_bf16 a[0:15], a[64:67], v[104:107], a[0:15]
    v_mfma_f32_32x32x16_bf16 a[16:31], a[64:67], v[216:219], a[16:31]
    v_mfma_f32_32x32x16_bf16 a[32:47], a[68:71], v[104:107], a[32:47]
    v_mfma_f32_32x32x16_bf16 a[48:63], a[68:71], v[216:219], a[48:63]
    ds_read_b64_tr_b16 a[72:73], v8 offset:14336
    ds_read_b64_tr_b16 a[74:75], v8 offset:14848
    ds_read_b64_tr_b16 a[76:77], v9 offset:14336
    ds_read_b64_tr_b16 a[78:79], v9 offset:14848
    s_waitcnt lgkmcnt(0)
    v_mfma_f32_32x32x16_bf16 a[0:15], a[72:75], v[108:111], a[0:15]
    v_mfma_f32_32x32x16_bf16 a[16:31], a[72:75], v[220:223], a[16:31]
    v_mfma_f32_32x32x16_bf16 a[32:47], a[76:79], v[108:111], a[32:47]
    v_mfma_f32_32x32x16_bf16 a[48:63], a[76:79], v[220:223], a[48:63]
    s_waitcnt vmcnt(8)
    ds_read_b64_tr_b16 a[64:65], v8 offset:16384
    ds_read_b64_tr_b16 a[66:67], v8 offset:16896
    ds_read_b64_tr_b16 a[68:69], v9 offset:16384
    ds_read_b64_tr_b16 a[70:71], v9 offset:16896
    s_waitcnt lgkmcnt(0)
    v_mfma_f32_32x32x16_bf16 a[0:15], a[64:67], v[112:115], a[0:15]
    v_mfma_f32_32x32x16_bf16 a[16:31], a[64:67], v[224:227], a[16:31]
    v_mfma_f32_32x32x16_bf16 a[32:47], a[68:71], v[112:115], a[32:47]
    v_mfma_f32_32x32x16_bf16 a[48:63], a[68:71], v[224:227], a[48:63]
    ds_read_b64_tr_b16 a[72:73], v8 offset:18432
    ds_read_b64_tr_b16 a[74:75], v8 offset:18944
    ds_read_b64_tr_b16 a[76:77], v9 offset:18432
    ds_read_b64_tr_b16 a[78:79], v9 offset:18944
    s_waitcnt lgkmcnt(0)
    v_mfma_f32_32x32x16_bf16 a[0:15], a[72:75], v[116:119], a[0:15]
    v_mfma_f32_32x32x16_bf16 a[16:31], a[72:75], v[228:231], a[16:31]
    v_mfma_f32_32x32x16_bf16 a[32:47], a[76:79], v[116:119], a[32:47]
    v_mfma_f32_32x32x16_bf16 a[48:63], a[76:79], v[228:231], a[48:63]
    ds_read_b64_tr_b16 a[64:65], v8 offset:20480
    ds_read_b64_tr_b16 a[66:67], v8 offset:20992
    ds_read_b64_tr_b16 a[68:69], v9 offset:20480
    ds_read_b64_tr_b16 a[70:71], v9 offset:20992
    s_waitcnt lgkmcnt(0)
    v_mfma_f32_32x32x16_bf16 a[0:15], a[64:67], v[120:123], a[0:15]
    v_mfma_f32_32x32x16_bf16 a[16:31], a[64:67], v[232:235], a[16:31]
    v_mfma_f32_32x32x16_bf16 a[32:47], a[68:71], v[120:123], a[32:47]
    v_mfma_f32_32x32x16_bf16 a[48:63], a[68:71], v[232:235], a[48:63]
    ds_read_b64_tr_b16 a[72:73], v8 offset:22528
    ds_read_b64_tr_b16 a[74:75], v8 offset:23040
    ds_read_b64_tr_b16 a[76:77], v9 offset:22528
    ds_read_b64_tr_b16 a[78:79], v9 offset:23040
    s_waitcnt lgkmcnt(0)
    v_mfma_f32_32x32x16_bf16 a[0:15], a[72:75], v[124:127], a[0:15]
    v_mfma_f32_32x32x16_bf16 a[16:31], a[72:75], v[236:239], a[16:31]
    v_mfma_f32_32x32x16_bf16 a[32:47], a[76:79], v[124:127], a[32:47]
    v_mfma_f32_32x32x16_bf16 a[48:63], a[76:79], v[236:239], a[48:63]
    s_waitcnt vmcnt(0)
    ds_read_b64_tr_b16 a[64:65], v8 offset:0
    ds_read_b64_tr_b16 a[66:67], v8 offset:512
    ds_read_b64_tr_b16 a[68:69], v9 offset:0
    ds_read_b64_tr_b16 a[70:71], v9 offset:512
    s_waitcnt lgkmcnt(0)
    v_mfma_f32_32x32x16_bf16 a[0:15], a[64:67], v[128:131], a[0:15]
    v_mfma_f32_32x32x16_bf16 a[16:31], a[64:67], v[240:243], a[16:31]
    v_mfma_f32_32x32x16_bf16 a[32:47], a[68:71], v[128:131], a[32:47]
    v_mfma_f32_32x32x16_bf16 a[48:63], a[68:71], v[240:243], a[48:63]
    ds_read_b64_tr_b16 a[72:73], v8 offset:2048
    ds_read_b64_tr_b16 a[74:75], v8 offset:2560
    ds_read_b64_tr_b16 a[76:77], v9 offset:2048
    ds_read_b64_tr_b16 a[78:79], v9 offset:2560
    s_waitcnt lgkmcnt(0)
    v_mfma_f32_32x32x16_bf16 a[0:15], a[72:75], v[132:135], a[0:15]
    v_mfma_f32_32x32x16_bf16 a[16:31], a[72:75], v[244:247], a[16:31]
    v_mfma_f32_32x32x16_bf16 a[32:47], a[76:79], v[132:135], a[32:47]
    v_mfma_f32_32x32x16_bf16 a[48:63], a[76:79], v[244:247], a[48:63]
    ds_read_b64_tr_b16 a[64:65], v8 offset:4096
    ds_read_b64_tr_b16 a[66:67], v8 offset:4608
    ds_read_b64_tr_b16 a[68:69], v9 offset:4096
    ds_read_b64_tr_b16 a[70:71], v9 offset:4608
    s_waitcnt lgkmcnt(0)
    v_mfma_f32_32x32x16_bf16 a[0:15], a[64:67], v[136:139], a[0:15]
    v_mfma_f32_32x32x16_bf16 a[16:31], a[64:67], v[248:251], a[16:31]
    v_mfma_f32_32x32x16_bf16 a[32:47], a[68:71], v[136:139], a[32:47]
    v_mfma_f32_32x32x16_bf16 a[48:63], a[68:71], v[248:251], a[48:63]
    ds_read_b64_tr_b16 a[72:73], v8 offset:6144
    ds_read_b64_tr_b16 a[74:75], v8 offset:6656
    ds_read_b64_tr_b16 a[76:77], v9 offset:6144
    ds_read_b64_tr_b16 a[78:79], v9 offset:6656
    s_waitcnt lgkmcnt(0)
    v_mfma_f32_32x32x16_bf16 a[0:15], a[72:75], v[140:143], a[0:15]
    v_mfma_f32_32x32x16_bf16 a[16:31], a[72:75], v[252:255], a[16:31]
    v_mfma_f32_32x32x16_bf16 a[32:47], a[76:79], v[140:143], a[32:47]
    v_mfma_f32_32x32x16_bf16 a[48:63], a[76:79], v[252:255], a[48:63]
    s_nop 15
    s_barrier
    v_lshlrev_b32 v5, 9, v3
    v_lshlrev_b32 v6, 3, v4
    v_add_u32 v5, v5, v6
    v_and_b32 v6, 7, v3
    s_lshl_b32 s34, s26, 3
    s_add_u32 s34, s34, 0
    v_xor_b32 v9, s34, v6
    v_lshlrev_b32 v9, 4, v9
    v_add_u32 v9, v9, v5
    v_accvgpr_read_b32 v24, a0
    v_accvgpr_read_b32 v25, a1
    v_accvgpr_read_b32 v26, a2
    v_accvgpr_read_b32 v27, a3
    s_nop 0
    v_cvt_pk_bf16_f32 v28, v24, v25
    v_cvt_pk_bf16_f32 v29, v26, v27
    ds_write_b64 v9, v[28:29] offset:0
    v_accvgpr_read_b32 v24, a16
    v_accvgpr_read_b32 v25, a17
    v_accvgpr_read_b32 v26, a18
    v_accvgpr_read_b32 v27, a19
    s_nop 0
    v_cvt_pk_bf16_f32 v28, v24, v25
    v_cvt_pk_bf16_f32 v29, v26, v27
    ds_write_b64 v9, v[28:29] offset:16384
    s_lshl_b32 s34, s26, 3
    s_add_u32 s34, s34, 1
    v_xor_b32 v9, s34, v6
    v_lshlrev_b32 v9, 4, v9
    v_add_u32 v9, v9, v5
    v_accvgpr_read_b32 v24, a4
    v_accvgpr_read_b32 v25, a5
    v_accvgpr_read_b32 v26, a6
    v_accvgpr_read_b32 v27, a7
    s_nop 0
    v_cvt_pk_bf16_f32 v28, v24, v25
    v_cvt_pk_bf16_f32 v29, v26, v27
    ds_write_b64 v9, v[28:29] offset:0
    v_accvgpr_read_b32 v24, a20
    v_accvgpr_read_b32 v25, a21
    v_accvgpr_read_b32 v26, a22
    v_accvgpr_read_b32 v27, a23
    s_nop 0
    v_cvt_pk_bf16_f32 v28, v24, v25
    v_cvt_pk_bf16_f32 v29, v26, v27
    ds_write_b64 v9, v[28:29] offset:16384
    s_lshl_b32 s34, s26, 3
    s_add_u32 s34, s34, 2
    v_xor_b32 v9, s34, v6
    v_lshlrev_b32 v9, 4, v9
    v_add_u32 v9, v9, v5
    v_accvgpr_read_b32 v24, a8
    v_accvgpr_read_b32 v25, a9
    v_accvgpr_read_b32 v26, a10
    v_accvgpr_read_b32 v27, a11
    s_nop 0
    v_cvt_pk_bf16_f32 v28, v24, v25
    v_cvt_pk_bf16_f32 v29, v26, v27
    ds_write_b64 v9, v[28:29] offset:0
    v_accvgpr_read_b32 v24, a24
    v_accvgpr_read_b32 v25, a25
    v_accvgpr_read_b32 v26, a26
    v_accvgpr_read_b32 v27, a27
    s_nop 0
    v_cvt_pk_bf16_f32 v28, v24, v25
    v_cvt_pk_bf16_f32 v29, v26, v27
    ds_write_b64 v9, v[28:29] offset:16384
    s_lshl_b32 s34, s26, 3
    s_add_u32 s34, s34, 3
    v_xor_b32 v9, s34, v6
    v_lshlrev_b32 v9, 4, v9
    v_add_u32 v9, v9, v5
    v_accvgpr_read_b32 v24, a12
    v_accvgpr_read_b32 v25, a13
    v_accvgpr_read_b32 v26, a14
    v_accvgpr_read_b32 v27, a15
    s_nop 0
    v_cvt_pk_bf16_f32 v28, v24, v25
    v_cvt_pk_bf16_f32 v29, v26, v27
    ds_write_b64 v9, v[28:29] offset:0
    v_accvgpr_read_b32 v24, a28
    v_accvgpr_read_b32 v25, a29
    v_accvgpr_read_b32 v26, a30
    v_accvgpr_read_b32 v27, a31
    s_nop 0
    v_cvt_pk_bf16_f32 v28, v24, v25
    v_cvt_pk_bf16_f32 v29, v26, v27
    ds_write_b64 v9, v[28:29] offset:16384
    s_lshl_b32 s34, s26, 3
    s_add_u32 s34, s34, 4
    v_xor_b32 v9, s34, v6
    v_lshlrev_b32 v9, 4, v9
    v_add_u32 v9, v9, v5
    v_accvgpr_read_b32 v24, a32
    v_accvgpr_read_b32 v25, a33
    v_accvgpr_read_b32 v26, a34
    v_accvgpr_read_b32 v27, a35
    s_nop 0
    v_cvt_pk_bf16_f32 v28, v24, v25
    v_cvt_pk_bf16_f32 v29, v26, v27
    ds_write_b64 v9, v[28:29] offset:0
    v_accvgpr_read_b32 v24, a48
    v_accvgpr_read_b32 v25, a49
    v_accvgpr_read_b32 v26, a50
    v_accvgpr_read_b32 v27, a51
    s_nop 0
    v_cvt_pk_bf16_f32 v28, v24, v25
    v_cvt_pk_bf16_f32 v29, v26, v27
    ds_write_b64 v9, v[28:29] offset:16384
    s_lshl_b32 s34, s26, 3
    s_add_u32 s34, s34, 5
    v_xor_b32 v9, s34, v6
    v_lshlrev_b32 v9, 4, v9
    v_add_u32 v9, v9, v5
    v_accvgpr_read_b32 v24, a36
    v_accvgpr_read_b32 v25, a37
    v_accvgpr_read_b32 v26, a38
    v_accvgpr_read_b32 v27, a39
    s_nop 0
    v_cvt_pk_bf16_f32 v28, v24, v25
    v_cvt_pk_bf16_f32 v29, v26, v27
    ds_write_b64 v9, v[28:29] offset:0
    v_accvgpr_read_b32 v24, a52
    v_accvgpr_read_b32 v25, a53
    v_accvgpr_read_b32 v26, a54
    v_accvgpr_read_b32 v27, a55
    s_nop 0
    v_cvt_pk_bf16_f32 v28, v24, v25
    v_cvt_pk_bf16_f32 v29, v26, v27
    ds_write_b64 v9, v[28:29] offset:16384
    s_lshl_b32 s34, s26, 3
    s_add_u32 s34, s34, 6
    v_xor_b32 v9, s34, v6
    v_lshlrev_b32 v9, 4, v9
    v_add_u32 v9, v9, v5
    v_accvgpr_read_b32 v24, a40
    v_accvgpr_read_b32 v25, a41
    v_accvgpr_read_b32 v26, a42
    v_accvgpr_read_b32 v27, a43
    s_nop 0
    v_cvt_pk_bf16_f32 v28, v24, v25
    v_cvt_pk_bf16_f32 v29, v26, v27
    ds_write_b64 v9, v[28:29] offset:0
    v_accvgpr_read_b32 v24, a56
    v_accvgpr_read_b32 v25, a57
    v_accvgpr_read_b32 v26, a58
    v_accvgpr_read_b32 v27, a59
    s_nop 0
    v_cvt_pk_bf16_f32 v28, v24, v25
    v_cvt_pk_bf16_f32 v29, v26, v27
    ds_write_b64 v9, v[28:29] offset:16384
    s_lshl_b32 s34, s26, 3
    s_add_u32 s34, s34, 7
    v_xor_b32 v9, s34, v6
    v_lshlrev_b32 v9, 4, v9
    v_add_u32 v9, v9, v5
    v_accvgpr_read_b32 v24, a44
    v_accvgpr_read_b32 v25, a45
    v_accvgpr_read_b32 v26, a46
    v_accvgpr_read_b32 v27, a47
    s_nop 0
    v_cvt_pk_bf16_f32 v28, v24, v25
    v_cvt_pk_bf16_f32 v29, v26, v27
    ds_write_b64 v9, v[28:29] offset:0
    v_accvgpr_read_b32 v24, a60
    v_accvgpr_read_b32 v25, a61
    v_accvgpr_read_b32 v26, a62
    v_accvgpr_read_b32 v27, a63
    s_nop 0
    v_cvt_pk_bf16_f32 v28, v24, v25
    v_cvt_pk_bf16_f32 v29, v26, v27
    ds_write_b64 v9, v[28:29] offset:16384
    s_waitcnt lgkmcnt(0)
    s_barrier
    v_lshlrev_b32 v5, 9, v3
    v_add_u32 v24, 0, v4
    v_xor_b32 v24, v24, v6
    v_lshlrev_b32 v24, 4, v24
    v_add_u32 v8, v24, v5
    v_add_u32 v24, 2, v4
    v_xor_b32 v24, v24, v6
    v_lshlrev_b32 v24, 4, v24
    v_add_u32 v9, v24, v5
    v_add_u32 v24, 4, v4
    v_xor_b32 v24, v24, v6
    v_lshlrev_b32 v24, 4, v24
    v_add_u32 v10, v24, v5
    v_add_u32 v24, 6, v4
    v_xor_b32 v24, v24, v6
    v_lshlrev_b32 v24, 4, v24
    v_add_u32 v11, v24, v5
    ds_read_b128 v[128:131], v8 offset:0
    ds_read_b128 v[132:135], v9 offset:0
    ds_read_b128 v[136:139], v10 offset:0
    ds_read_b128 v[140:143], v11 offset:0
    ds_read_b128 v[144:147], v8 offset:128
    ds_read_b128 v[148:151], v9 offset:128
    ds_read_b128 v[152:155], v10 offset:128
    ds_read_b128 v[156:159], v11 offset:128
    ds_read_b128 v[160:163], v8 offset:256
    ds_read_b128 v[164:167], v9 offset:256
    ds_read_b128 v[168:171], v10 offset:256
    ds_read_b128 v[172:175], v11 offset:256
    ds_read_b128 v[176:179], v8 offset:384
    ds_read_b128 v[180:183], v9 offset:384
    ds_read_b128 v[184:187], v10 offset:384
    ds_read_b128 v[188:191], v11 offset:384
    ds_read_b128 v[192:195], v8 offset:16384
    ds_read_b128 v[196:199], v9 offset:16384
    ds_read_b128 v[200:203], v10 offset:16384
    ds_read_b128 v[204:207], v11 offset:16384
    ds_read_b128 v[208:211], v8 offset:16512
    ds_read_b128 v[212:215], v9 offset:16512
    ds_read_b128 v[216:219], v10 offset:16512
    ds_read_b128 v[220:223], v11 offset:16512
    ds_read_b128 v[224:227], v8 offset:16640
    ds_read_b128 v[228:231], v9 offset:16640
    ds_read_b128 v[232:235], v10 offset:16640
    ds_read_b128 v[236:239], v11 offset:16640
    ds_read_b128 v[240:243], v8 offset:16768
    ds_read_b128 v[244:247], v9 offset:16768
    ds_read_b128 v[248:251], v10 offset:16768
    ds_read_b128 v[252:255], v11 offset:16768
    s_waitcnt lgkmcnt(0)
    s_barrier
    s_mul_i32 s31, s26, 40960
    v_mov_b32 v30, v3
    v_mov_b32 v31, v4
    v_and_b32 v24, 31, v1
    v_add_u32 v25, 0, v31
    v_xor_b32 v25, v25, v24
    v_lshlrev_b32 v25, 4, v25
    v_lshlrev_b32 v26, 9, v31
    v_add_u32 v2, v25, v26
    v_add_u32 v25, 2, v31
    v_xor_b32 v25, v25, v24
    v_lshlrev_b32 v25, 4, v25
    v_lshlrev_b32 v26, 9, v31
    v_add_u32 v3, v25, v26
    v_add_u32 v25, 4, v31
    v_xor_b32 v25, v25, v24
    v_lshlrev_b32 v25, 4, v25
    v_lshlrev_b32 v26, 9, v31
    v_add_u32 v4, v25, v26
    v_add_u32 v25, 6, v31
    v_xor_b32 v25, v25, v24
    v_lshlrev_b32 v25, 4, v25
    v_lshlrev_b32 v26, 9, v31
    v_add_u32 v5, v25, v26
    v_add_u32 v25, 0, v31
    v_lshlrev_b32 v25, 2, v25
    v_xor_b32 v25, v25, v24
    v_lshlrev_b32 v25, 4, v25
    v_lshlrev_b32 v26, 9, v31
    v_add_u32 v6, v25, v26
    v_add_u32 v25, 2, v31
    v_lshlrev_b32 v25, 2, v25
    v_xor_b32 v25, v25, v24
    v_lshlrev_b32 v25, 4, v25
    v_lshlrev_b32 v26, 9, v31
    v_add_u32 v7, v25, v26
    s_add_u32 m0, s31, 0
    s_add_u32 s34, s30, 0
    buffer_load_dwordx4 v2, s[12:15], s34 offen offset:0 lds
    buffer_load_dwordx4 v3, s[12:15], s34 offen offset:1024 lds
    buffer_load_dwordx4 v4, s[12:15], s34 offen offset:2048 lds
    buffer_load_dwordx4 v5, s[12:15], s34 offen offset:3072 lds
    s_add_u32 m0, s31, 4096
    s_add_u32 s34, s30, 4096
    buffer_load_dwordx4 v2, s[12:15], s34 offen offset:0 lds
    buffer_load_dwordx4 v3, s[12:15], s34 offen offset:1024 lds
    buffer_load_dwordx4 v4, s[12:15], s34 offen offset:2048 lds
    buffer_load_dwordx4 v5, s[12:15], s34 offen offset:3072 lds
    s_add_u32 m0, s31, 8192
    s_add_u32 s34, s30, 8192
    buffer_load_dwordx4 v2, s[12:15], s34 offen offset:0 lds
    buffer_load_dwordx4 v3, s[12:15], s34 offen offset:1024 lds
    buffer_load_dwordx4 v4, s[12:15], s34 offen offset:2048 lds
    buffer_load_dwordx4 v5, s[12:15], s34 offen offset:3072 lds
    s_add_u32 m0, s31, 12288
    s_add_u32 s34, s30, 12288
    buffer_load_dwordx4 v2, s[12:15], s34 offen offset:0 lds
    buffer_load_dwordx4 v3, s[12:15], s34 offen offset:1024 lds
    buffer_load_dwordx4 v4, s[12:15], s34 offen offset:2048 lds
    buffer_load_dwordx4 v5, s[12:15], s34 offen offset:3072 lds
    s_add_u32 m0, s31, 16384
    s_add_u32 s34, s30, 16384
    buffer_load_dwordx4 v2, s[12:15], s34 offen offset:0 lds
    buffer_load_dwordx4 v3, s[12:15], s34 offen offset:1024 lds
    buffer_load_dwordx4 v4, s[12:15], s34 offen offset:2048 lds
    buffer_load_dwordx4 v5, s[12:15], s34 offen offset:3072 lds
    s_add_u32 m0, s31, 20480
    s_add_u32 s34, s30, 20480
    buffer_load_dwordx4 v2, s[12:15], s34 offen offset:0 lds
    buffer_load_dwordx4 v3, s[12:15], s34 offen offset:1024 lds
    buffer_load_dwordx4 v4, s[12:15], s34 offen offset:2048 lds
    buffer_load_dwordx4 v5, s[12:15], s34 offen offset:3072 lds
    s_add_u32 m0, s31, 24576
    s_add_u32 s34, s30, 24576
    buffer_load_dwordx4 v2, s[12:15], s34 offen offset:0 lds
    buffer_load_dwordx4 v3, s[12:15], s34 offen offset:1024 lds
    buffer_load_dwordx4 v4, s[12:15], s34 offen offset:2048 lds
    buffer_load_dwordx4 v5, s[12:15], s34 offen offset:3072 lds
    s_add_u32 m0, s31, 28672
    s_add_u32 s34, s30, 28672
    buffer_load_dwordx4 v2, s[12:15], s34 offen offset:0 lds
    buffer_load_dwordx4 v3, s[12:15], s34 offen offset:1024 lds
    buffer_load_dwordx4 v4, s[12:15], s34 offen offset:2048 lds
    buffer_load_dwordx4 v5, s[12:15], s34 offen offset:3072 lds
    s_add_u32 m0, s31, 32768
    s_add_u32 s34, s30, 0
    buffer_load_dwordx4 v6, s[16:19], s34 offen offset:0 lds
    buffer_load_dwordx4 v7, s[16:19], s34 offen offset:1024 lds
    buffer_load_dwordx4 v6, s[16:19], s34 offen offset:2048 lds
    buffer_load_dwordx4 v7, s[16:19], s34 offen offset:3072 lds
    s_add_u32 m0, s31, 36864
    s_add_u32 s34, s30, 4096
    buffer_load_dwordx4 v6, s[16:19], s34 offen offset:0 lds
    buffer_load_dwordx4 v7, s[16:19], s34 offen offset:1024 lds
    buffer_load_dwordx4 v6, s[16:19], s34 offen offset:2048 lds
    buffer_load_dwordx4 v7, s[16:19], s34 offen offset:3072 lds
    v_cmp_lt_u32 vcc, 15, v30
    v_mov_b32 v24, 32768
    v_mov_b32 v25, -8192
    s_nop 1
    v_cndmask_b32 v24, v24, v25, vcc
    v_add_u32 v8, s31, v8
    v_add_u32 v12, v8, v24
    v_add_u32 v9, s31, v9
    v_add_u32 v13, v9, v24
    v_add_u32 v10, s31, v10
    v_add_u32 v14, v10, v24
    v_add_u32 v11, s31, v11
    v_add_u32 v15, v11, v24
    v_and_b32 v27, 15, v1
    v_lshrrev_b32 v27, 2, v27
    v_lshlrev_b32 v28, 2, v31
    v_add_u32 v28, v28, v27
    v_lshlrev_b32 v28, 9, v28
    v_add_u32 v28, s31, v28
    v_lshrrev_b32 v29, 4, v1
    v_and_b32 v29, 1, v29
    v_lshlrev_b32 v29, 5, v29
    v_add_u32 v24, v28, v29
    v_and_b32 v29, 3, v1
    v_lshlrev_b32 v29, 3, v29
    v_add_u32 v24, v24, v29
    v_xor_b32 v25, 0, v27
    v_lshlrev_b32 v25, 6, v25
    v_add_u32 v16, v24, v25
    v_xor_b32 v25, 1, v27
    v_lshlrev_b32 v25, 6, v25
    v_add_u32 v17, v24, v25
    v_xor_b32 v25, 2, v27
    v_lshlrev_b32 v25, 6, v25
    v_add_u32 v18, v24, v25
    v_xor_b32 v25, 3, v27
    v_lshlrev_b32 v25, 6, v25
    v_add_u32 v19, v24, v25
    v_accvgpr_write_b32 a0, 0
    v_accvgpr_write_b32 a1, 0
    v_accvgpr_write_b32 a2, 0
    v_accvgpr_write_b32 a3, 0
    v_accvgpr_write_b32 a4, 0
    v_accvgpr_write_b32 a5, 0
    v_accvgpr_write_b32 a6, 0
    v_accvgpr_write_b32 a7, 0
    v_accvgpr_write_b32 a8, 0
    v_accvgpr_write_b32 a9, 0
    v_accvgpr_write_b32 a10, 0
    v_accvgpr_write_b32 a11, 0
    v_accvgpr_write_b32 a12, 0
    v_accvgpr_write_b32 a13, 0
    v_accvgpr_write_b32 a14, 0
    v_accvgpr_write_b32 a15, 0
    v_accvgpr_write_b32 a16, 0
    v_accvgpr_write_b32 a17, 0
    v_accvgpr_write_b32 a18, 0
    v_accvgpr_write_b32 a19, 0
    v_accvgpr_write_b32 a20, 0
    v_accvgpr_write_b32 a21, 0
    v_accvgpr_write_b32 a22, 0
    v_accvgpr_write_b32 a23, 0
    v_accvgpr_write_b32 a24, 0
    v_accvgpr_write_b32 a25, 0
    v_accvgpr_write_b32 a26, 0
    v_accvgpr_write_b32 a27, 0
    v_accvgpr_write_b32 a28, 0
    v_accvgpr_write_b32 a29, 0
    v_accvgpr_write_b32 a30, 0
    v_accvgpr_write_b32 a31, 0
    v_accvgpr_write_b32 a32, 0
    v_accvgpr_write_b32 a33, 0
    v_accvgpr_write_b32 a34, 0
    v_accvgpr_write_b32 a35, 0
    v_accvgpr_write_b32 a36, 0
    v_accvgpr_write_b32 a37, 0
    v_accvgpr_write_b32 a38, 0
    v_accvgpr_write_b32 a39, 0
    v_accvgpr_write_b32 a40, 0
    v_accvgpr_write_b32 a41, 0
    v_accvgpr_write_b32 a42, 0
    v_accvgpr_write_b32 a43, 0
    v_accvgpr_write_b32 a44, 0
    v_accvgpr_write_b32 a45, 0
    v_accvgpr_write_b32 a46, 0
    v_accvgpr_write_b32 a47, 0
    v_accvgpr_write_b32 a48, 0
    v_accvgpr_write_b32 a49, 0
    v_accvgpr_write_b32 a50, 0
    v_accvgpr_write_b32 a51, 0
    v_accvgpr_write_b32 a52, 0
    v_accvgpr_write_b32 a53, 0
    v_accvgpr_write_b32 a54, 0
    v_accvgpr_write_b32 a55, 0
    v_accvgpr_write_b32 a56, 0
    v_accvgpr_write_b32 a57, 0
    v_accvgpr_write_b32 a58, 0
    v_accvgpr_write_b32 a59, 0
    v_accvgpr_write_b32 a60, 0
    v_accvgpr_write_b32 a61, 0
    v_accvgpr_write_b32 a62, 0
    v_accvgpr_write_b32 a63, 0
    v_accvgpr_write_b32 a64, 0
    v_accvgpr_write_b32 a65, 0
    v_accvgpr_write_b32 a66, 0
    v_accvgpr_write_b32 a67, 0
    v_accvgpr_write_b32 a68, 0
    v_accvgpr_write_b32 a69, 0
    v_accvgpr_write_b32 a70, 0
    v_accvgpr_write_b32 a71, 0
    v_accvgpr_write_b32 a72, 0
    v_accvgpr_write_b32 a73, 0
    v_accvgpr_write_b32 a74, 0
    v_accvgpr_write_b32 a75, 0
    v_accvgpr_write_b32 a76, 0
    v_accvgpr_write_b32 a77, 0
    v_accvgpr_write_b32 a78, 0
    v_accvgpr_write_b32 a79, 0
    v_accvgpr_write_b32 a80, 0
    v_accvgpr_write_b32 a81, 0
    v_accvgpr_write_b32 a82, 0
    v_accvgpr_write_b32 a83, 0
    v_accvgpr_write_b32 a84, 0
    v_accvgpr_write_b32 a85, 0
    v_accvgpr_write_b32 a86, 0
    v_accvgpr_write_b32 a87, 0
    v_accvgpr_write_b32 a88, 0
    v_accvgpr_write_b32 a89, 0
    v_accvgpr_write_b32 a90, 0
    v_accvgpr_write_b32 a91, 0
    v_accvgpr_write_b32 a92, 0
    v_accvgpr_write_b32 a93, 0
    v_accvgpr_write_b32 a94, 0
    v_accvgpr_write_b32 a95, 0
    v_accvgpr_write_b32 a96, 0
    v_accvgpr_write_b32 a97, 0
    v_accvgpr_write_b32 a98, 0
    v_accvgpr_write_b32 a99, 0
    v_accvgpr_write_b32 a100, 0
    v_accvgpr_write_b32 a101, 0
    v_accvgpr_write_b32 a102, 0
    v_accvgpr_write_b32 a103, 0
    v_accvgpr_write_b32 a104, 0
    v_accvgpr_write_b32 a105, 0
    v_accvgpr_write_b32 a106, 0
    v_accvgpr_write_b32 a107, 0
    v_accvgpr_write_b32 a108, 0
    v_accvgpr_write_b32 a109, 0
    v_accvgpr_write_b32 a110, 0
    v_accvgpr_write_b32 a111, 0
    v_accvgpr_write_b32 a112, 0
    v_accvgpr_write_b32 a113, 0
    v_accvgpr_write_b32 a114, 0
    v_accvgpr_write_b32 a115, 0
    v_accvgpr_write_b32 a116, 0
    v_accvgpr_write_b32 a117, 0
    v_accvgpr_write_b32 a118, 0
    v_accvgpr_write_b32 a119, 0
    v_accvgpr_write_b32 a120, 0
    v_accvgpr_write_b32 a121, 0
    v_accvgpr_write_b32 a122, 0
    v_accvgpr_write_b32 a123, 0
    v_accvgpr_write_b32 a124, 0
    v_accvgpr_write_b32 a125, 0
    v_accvgpr_write_b32 a126, 0
    v_accvgpr_write_b32 a127, 0
    v_accvgpr_write_b32 a128, 0
    v_accvgpr_write_b32 a129, 0
    v_accvgpr_write_b32 a130, 0
    v_accvgpr_write_b32 a131, 0
    v_accvgpr_write_b32 a132, 0
    v_accvgpr_write_b32 a133, 0
    v_accvgpr_write_b32 a134, 0
    v_accvgpr_write_b32 a135, 0
    v_accvgpr_write_b32 a136, 0
    v_accvgpr_write_b32 a137, 0
    v_accvgpr_write_b32 a138, 0
    v_accvgpr_write_b32 a139, 0
    v_accvgpr_write_b32 a140, 0
    v_accvgpr_write_b32 a141, 0
    v_accvgpr_write_b32 a142, 0
    v_accvgpr_write_b32 a143, 0
    v_accvgpr_write_b32 a144, 0
    v_accvgpr_write_b32 a145, 0
    v_accvgpr_write_b32 a146, 0
    v_accvgpr_write_b32 a147, 0
    v_accvgpr_write_b32 a148, 0
    v_accvgpr_write_b32 a149, 0
    v_accvgpr_write_b32 a150, 0
    v_accvgpr_write_b32 a151, 0
    v_accvgpr_write_b32 a152, 0
    v_accvgpr_write_b32 a153, 0
    v_accvgpr_write_b32 a154, 0
    v_accvgpr_write_b32 a155, 0
    v_accvgpr_write_b32 a156, 0
    v_accvgpr_write_b32 a157, 0
    v_accvgpr_write_b32 a158, 0
    v_accvgpr_write_b32 a159, 0
    v_accvgpr_write_b32 a160, 0
    v_accvgpr_write_b32 a161, 0
    v_accvgpr_write_b32 a162, 0
    v_accvgpr_write_b32 a163, 0
    v_accvgpr_write_b32 a164, 0
    v_accvgpr_write_b32 a165, 0
    v_accvgpr_write_b32 a166, 0
    v_accvgpr_write_b32 a167, 0
    v_accvgpr_write_b32 a168, 0
    v_accvgpr_write_b32 a169, 0
    v_accvgpr_write_b32 a170, 0
    v_accvgpr_write_b32 a171, 0
    v_accvgpr_write_b32 a172, 0
    v_accvgpr_write_b32 a173, 0
    v_accvgpr_write_b32 a174, 0
    v_accvgpr_write_b32 a175, 0
    v_accvgpr_write_b32 a176, 0
    v_accvgpr_write_b32 a177, 0
    v_accvgpr_write_b32 a178, 0
    v_accvgpr_write_b32 a179, 0
    v_accvgpr_write_b32 a180, 0
    v_accvgpr_write_b32 a181, 0
    v_accvgpr_write_b32 a182, 0
    v_accvgpr_write_b32 a183, 0
    v_accvgpr_write_b32 a184, 0
    v_accvgpr_write_b32 a185, 0
    v_accvgpr_write_b32 a186, 0
    v_accvgpr_write_b32 a187, 0
    v_accvgpr_write_b32 a188, 0
    v_accvgpr_write_b32 a189, 0
    v_accvgpr_write_b32 a190, 0
    v_accvgpr_write_b32 a191, 0
    v_accvgpr_write_b32 a192, 0
    v_accvgpr_write_b32 a193, 0
    v_accvgpr_write_b32 a194, 0
    v_accvgpr_write_b32 a195, 0
    v_accvgpr_write_b32 a196, 0
    v_accvgpr_write_b32 a197, 0
    v_accvgpr_write_b32 a198, 0
    v_accvgpr_write_b32 a199, 0
    v_accvgpr_write_b32 a200, 0
    v_accvgpr_write_b32 a201, 0
    v_accvgpr_write_b32 a202, 0
    v_accvgpr_write_b32 a203, 0
    v_accvgpr_write_b32 a204, 0
    v_accvgpr_write_b32 a205, 0
    v_accvgpr_write_b32 a206, 0
    v_accvgpr_write_b32 a207, 0
    v_accvgpr_write_b32 a208, 0
    v_accvgpr_write_b32 a209, 0
    v_accvgpr_write_b32 a210, 0
    v_accvgpr_write_b32 a211, 0
    v_accvgpr_write_b32 a212, 0
    v_accvgpr_write_b32 a213, 0
    v_accvgpr_write_b32 a214, 0
    v_accvgpr_write_b32 a215, 0
    v_accvgpr_write_b32 a216, 0
    v_accvgpr_write_b32 a217, 0
    v_accvgpr_write_b32 a218, 0
    v_accvgpr_write_b32 a219, 0
    v_accvgpr_write_b32 a220, 0
    v_accvgpr_write_b32 a221, 0
    v_accvgpr_write_b32 a222, 0
    v_accvgpr_write_b32 a223, 0
    v_accvgpr_write_b32 a224, 0
    v_accvgpr_write_b32 a225, 0
    v_accvgpr_write_b32 a226, 0
    v_accvgpr_write_b32 a227, 0
    v_accvgpr_write_b32 a228, 0
    v_accvgpr_write_b32 a229, 0
    v_accvgpr_write_b32 a230, 0
    v_accvgpr_write_b32 a231, 0
    v_accvgpr_write_b32 a232, 0
    v_accvgpr_write_b32 a233, 0
    v_accvgpr_write_b32 a234, 0
    v_accvgpr_write_b32 a235, 0
    v_accvgpr_write_b32 a236, 0
    v_accvgpr_write_b32 a237, 0
    v_accvgpr_write_b32 a238, 0
    v_accvgpr_write_b32 a239, 0
    v_accvgpr_write_b32 a240, 0
    v_accvgpr_write_b32 a241, 0
    v_accvgpr_write_b32 a242, 0
    v_accvgpr_write_b32 a243, 0
    v_accvgpr_write_b32 a244, 0
    v_accvgpr_write_b32 a245, 0
    v_accvgpr_write_b32 a246, 0
    v_accvgpr_write_b32 a247, 0
    v_accvgpr_write_b32 a248, 0
    v_accvgpr_write_b32 a249, 0
    v_accvgpr_write_b32 a250, 0
    v_accvgpr_write_b32 a251, 0
    v_accvgpr_write_b32 a252, 0
    v_accvgpr_write_b32 a253, 0
    v_accvgpr_write_b32 a254, 0
    v_accvgpr_write_b32 a255, 0
    v_mov_b32 v22, 0
    v_mov_b32 v23, 0
    s_waitcnt vmcnt(24)
    ds_read_b128 v[48:51], v8 offset:0
    ds_read_b128 v[52:55], v9 offset:0
    ds_read_b128 v[56:59], v10 offset:0
    s_waitcnt lgkmcnt(2)
    v_mfma_f32_32x32x16_bf16 v[64:79], v[48:51], v[128:131], 0
    v_mfma_f32_32x32x16_bf16 v[80:95], v[48:51], v[192:195], 0
    ds_read_b128 v[60:63], v11 offset:0
    s_waitcnt lgkmcnt(2)
    v_mfma_f32_32x32x16_bf16 v[64:79], v[52:55], v[132:135], v[64:79]
    v_mfma_f32_32x32x16_bf16 v[80:95], v[52:55], v[196:199], v[80:95]
    ds_read_b128 v[48:51], v8 offset:128
    s_waitcnt lgkmcnt(2)
    v_mfma_f32_32x32x16_bf16 v[64:79], v[56:59], v[136:139], v[64:79]
    v_mfma_f32_32x32x16_bf16 v[80:95], v[56:59], v[200:203], v[80:95]
    ds_read_b128 v[52:55], v9 offset:128
    s_waitcnt lgkmcnt(2)
    v_mfma_f32_32x32x16_bf16 v[64:79], v[60:63], v[140:143], v[64:79]
    v_mfma_f32_32x32x16_bf16 v[80:95], v[60:63], v[204:207], v[80:95]
    ds_read_b128 v[56:59], v10 offset:128
    s_waitcnt lgkmcnt(2)
    v_mfma_f32_32x32x16_bf16 v[64:79], v[48:51], v[144:147], v[64:79]
    v_mfma_f32_32x32x16_bf16 v[80:95], v[48:51], v[208:211], v[80:95]
    ds_read_b128 v[60:63], v11 offset:128
    s_waitcnt lgkmcnt(2)
    v_mfma_f32_32x32x16_bf16 v[64:79], v[52:55], v[148:151], v[64:79]
    v_mfma_f32_32x32x16_bf16 v[80:95], v[52:55], v[212:215], v[80:95]
    ds_read_b128 v[48:51], v8 offset:256
    s_waitcnt lgkmcnt(2)
    v_mfma_f32_32x32x16_bf16 v[64:79], v[56:59], v[152:155], v[64:79]
    v_mfma_f32_32x32x16_bf16 v[80:95], v[56:59], v[216:219], v[80:95]
    ds_read_b128 v[52:55], v9 offset:256
    s_waitcnt lgkmcnt(2)
    v_mfma_f32_32x32x16_bf16 v[64:79], v[60:63], v[156:159], v[64:79]
    v_mfma_f32_32x32x16_bf16 v[80:95], v[60:63], v[220:223], v[80:95]
    ds_read_b128 v[56:59], v10 offset:256
    s_waitcnt lgkmcnt(2)
    v_mfma_f32_32x32x16_bf16 v[64:79], v[48:51], v[160:163], v[64:79]
    v_mfma_f32_32x32x16_bf16 v[80:95], v[48:51], v[224:227], v[80:95]
    ds_read_b128 v[60:63], v11 offset:256
    s_waitcnt lgkmcnt(2)
    v_mfma_f32_32x32x16_bf16 v[64:79], v[52:55], v[164:167], v[64:79]
    v_mfma_f32_32x32x16_bf16 v[80:95], v[52:55], v[228:231], v[80:95]
    ds_read_b128 v[48:51], v8 offset:384
    s_waitcnt lgkmcnt(2)
    v_mfma_f32_32x32x16_bf16 v[64:79], v[56:59], v[168:171], v[64:79]
    v_mfma_f32_32x32x16_bf16 v[80:95], v[56:59], v[232:235], v[80:95]
    ds_read_b128 v[52:55], v9 offset:384
    s_waitcnt lgkmcnt(2)
    v_mfma_f32_32x32x16_bf16 v[64:79], v[60:63], v[172:175], v[64:79]
    v_mfma_f32_32x32x16_bf16 v[80:95], v[60:63], v[236:239], v[80:95]
    ds_read_b128 v[56:59], v10 offset:384
    s_waitcnt lgkmcnt(2)
    v_mfma_f32_32x32x16_bf16 v[64:79], v[48:51], v[176:179], v[64:79]
    v_mfma_f32_32x32x16_bf16 v[80:95], v[48:51], v[240:243], v[80:95]
    ds_read_b128 v[60:63], v11 offset:384
    s_waitcnt lgkmcnt(2)
    v_mfma_f32_32x32x16_bf16 v[64:79], v[52:55], v[180:183], v[64:79]
    v_mfma_f32_32x32x16_bf16 v[80:95], v[52:55], v[244:247], v[80:95]
    s_waitcnt lgkmcnt(1)
    v_mfma_f32_32x32x16_bf16 v[64:79], v[56:59], v[184:187], v[64:79]
    v_mfma_f32_32x32x16_bf16 v[80:95], v[56:59], v[248:251], v[80:95]
    s_waitcnt lgkmcnt(0)
    v_mfma_f32_32x32x16_bf16 v[64:79], v[60:63], v[188:191], v[64:79]
    v_mfma_f32_32x32x16_bf16 v[80:95], v[60:63], v[252:255], v[80:95]
    s_add_u32 m0, s31, 0
    s_add_u32 s34, s30, 8192
    buffer_load_dwordx4 v6, s[16:19], s34 offen offset:0 lds
    buffer_load_dwordx4 v7, s[16:19], s34 offen offset:1024 lds
    buffer_load_dwordx4 v6, s[16:19], s34 offen offset:2048 lds
    buffer_load_dwordx4 v7, s[16:19], s34 offen offset:3072 lds
    s_add_u32 m0, s31, 4096
    s_add_u32 s34, s30, 12288
    buffer_load_dwordx4 v6, s[16:19], s34 offen offset:0 lds
    buffer_load_dwordx4 v7, s[16:19], s34 offen offset:1024 lds
    buffer_load_dwordx4 v6, s[16:19], s34 offen offset:2048 lds
    buffer_load_dwordx4 v7, s[16:19], s34 offen offset:3072 lds
    s_add_u32 m0, s31, 8192
    s_add_u32 s34, s30, 32768
    buffer_load_dwordx4 v2, s[12:15], s34 offen offset:0 lds
    buffer_load_dwordx4 v3, s[12:15], s34 offen offset:1024 lds
    buffer_load_dwordx4 v4, s[12:15], s34 offen offset:2048 lds
    buffer_load_dwordx4 v5, s[12:15], s34 offen offset:3072 lds
    s_add_u32 m0, s31, 12288
    s_add_u32 s34, s30, 36864
    buffer_load_dwordx4 v2, s[12:15], s34 offen offset:0 lds
    buffer_load_dwordx4 v3, s[12:15], s34 offen offset:1024 lds
    buffer_load_dwordx4 v4, s[12:15], s34 offen offset:2048 lds
    buffer_load_dwordx4 v5, s[12:15], s34 offen offset:3072 lds
    s_nop 15
    s_waitcnt vmcnt(24)
    ds_read_b128 v[48:51], v8 offset:16384
    ds_read_b128 v[52:55], v9 offset:16384
    ds_read_b128 v[56:59], v10 offset:16384
    s_waitcnt lgkmcnt(2)
    v_mfma_f32_32x32x16_bf16 v[96:111], v[48:51], v[128:131], 0
    v_mfma_f32_32x32x16_bf16 v[112:127], v[48:51], v[192:195], 0
    ds_read_b128 v[60:63], v11 offset:16384
    v_max3_f32 v24, v64, v65, v66
    v_max3_f32 v24, v24, v67, v68
    v_max3_f32 v24, v24, v69, v70
    v_max3_f32 v24, v24, v71, v72
    v_max3_f32 v24, v24, v73, v74
    v_max3_f32 v24, v24, v75, v76
    v_max3_f32 v24, v24, v77, v78
    v_max_f32 v24, v24, v79
    v_mov_b32 v25, v24
    s_waitcnt lgkmcnt(2)
    v_mfma_f32_32x32x16_bf16 v[96:111], v[52:55], v[132:135], v[96:111]
    v_mfma_f32_32x32x16_bf16 v[112:127], v[52:55], v[196:199], v[112:127]
    ds_read_b128 v[48:51], v8 offset:16512
    v_mov_b32 v26, v24
    s_nop 1
    v_permlane32_swap_b32 v25, v26
    v_max_f32 v24, v25, v26
    v_mul_f32 v24, s33, v24
    v_mov_b32 v20, v24
    v_fma_f32 v64, v64, s33, -v20
    v_exp_f32 v64, v64
    v_fma_f32 v65, v65, s33, -v20
    s_waitcnt lgkmcnt(2)
    v_mfma_f32_32x32x16_bf16 v[96:111], v[56:59], v[136:139], v[96:111]
    v_mfma_f32_32x32x16_bf16 v[112:127], v[56:59], v[200:203], v[112:127]
    ds_read_b128 v[52:55], v9 offset:16512
    v_exp_f32 v65, v65
    v_fma_f32 v66, v66, s33, -v20
    v_exp_f32 v66, v66
    v_fma_f32 v67, v67, s33, -v20
    v_exp_f32 v67, v67
    v_fma_f32 v68, v68, s33, -v20
    v_exp_f32 v68, v68
    v_fma_f32 v69, v69, s33, -v20
    v_exp_f32 v69, v69
    s_waitcnt lgkmcnt(2)
    v_mfma_f32_32x32x16_bf16 v[96:111], v[60:63], v[140:143], v[96:111]
    v_mfma_f32_32x32x16_bf16 v[112:127], v[60:63], v[204:207], v[112:127]
    ds_read_b128 v[56:59], v10 offset:16512
    v_fma_f32 v70, v70, s33, -v20
    v_exp_f32 v70, v70
    v_fma_f32 v71, v71, s33, -v20
    v_exp_f32 v71, v71
    v_fma_f32 v72, v72, s33, -v20
    v_exp_f32 v72, v72
    v_fma_f32 v73, v73, s33, -v20
    v_exp_f32 v73, v73
    v_fma_f32 v74, v74, s33, -v20
    s_waitcnt lgkmcnt(2)
    v_mfma_f32_32x32x16_bf16 v[96:111], v[48:51], v[144:147], v[96:111]
    v_mfma_f32_32x32x16_bf16 v[112:127], v[48:51], v[208:211], v[112:127]
    ds_read_b128 v[60:63], v11 offset:16512
    v_exp_f32 v74, v74
    v_fma_f32 v75, v75, s33, -v20
    v_exp_f32 v75, v75
    v_fma_f32 v76, v76, s33, -v20
    v_exp_f32 v76, v76
    v_fma_f32 v77, v77, s33, -v20
    v_exp_f32 v77, v77
    v_fma_f32 v78, v78, s33, -v20
    v_exp_f32 v78, v78
    s_waitcnt lgkmcnt(2)
    v_mfma_f32_32x32x16_bf16 v[96:111], v[52:55], v[148:151], v[96:111]
    v_mfma_f32_32x32x16_bf16 v[112:127], v[52:55], v[212:215], v[112:127]
    ds_read_b128 v[48:51], v8 offset:16640
    v_fma_f32 v79, v79, s33, -v20
    v_exp_f32 v79, v79
    v_add_f32 v22, v22, v64
    v_add_f32 v22, v22, v65
    v_add_f32 v22, v22, v66
    v_add_f32 v22, v22, v67
    v_add_f32 v22, v22, v68
    v_add_f32 v22, v22, v69
    v_add_f32 v22, v22, v70
    s_waitcnt lgkmcnt(2)
    v_mfma_f32_32x32x16_bf16 v[96:111], v[56:59], v[152:155], v[96:111]
    v_mfma_f32_32x32x16_bf16 v[112:127], v[56:59], v[216:219], v[112:127]
    ds_read_b128 v[52:55], v9 offset:16640
    v_add_f32 v22, v22, v71
    v_add_f32 v22, v22, v72
    v_add_f32 v22, v22, v73
    v_add_f32 v22, v22, v74
    v_add_f32 v22, v22, v75
    v_add_f32 v22, v22, v76
    v_add_f32 v22, v22, v77
    v_add_f32 v22, v22, v78
    v_add_f32 v22, v22, v79
    s_waitcnt lgkmcnt(2)
    v_mfma_f32_32x32x16_bf16 v[96:111], v[60:63], v[156:159], v[96:111]
    v_mfma_f32_32x32x16_bf16 v[112:127], v[60:63], v[220:223], v[112:127]
    ds_read_b128 v[56:59], v10 offset:16640
    v_cvt_pk_bf16_f32 v64, v64, v65
    v_cvt_pk_bf16_f32 v65, v66, v67
    v_cvt_pk_bf16_f32 v66, v68, v69
    v_cvt_pk_bf16_f32 v67, v70, v71
    v_cvt_pk_bf16_f32 v68, v72, v73
    v_cvt_pk_bf16_f32 v69, v74, v75
    v_cvt_pk_bf16_f32 v70, v76, v77
    v_cvt_pk_bf16_f32 v71, v78, v79
    v_max3_f32 v27, v80, v81, v82
    s_waitcnt lgkmcnt(2)
    v_mfma_f32_32x32x16_bf16 v[96:111], v[48:51], v[160:163], v[96:111]
    v_mfma_f32_32x32x16_bf16 v[112:127], v[48:51], v[224:227], v[112:127]
    ds_read_b128 v[60:63], v11 offset:16640
    v_max3_f32 v27, v27, v83, v84
    v_max3_f32 v27, v27, v85, v86
    v_max3_f32 v27, v27, v87, v88
    v_max3_f32 v27, v27, v89, v90
    v_max3_f32 v27, v27, v91, v92
    v_max3_f32 v27, v27, v93, v94
    v_max_f32 v27, v27, v95
    v_mov_b32 v28, v27
    v_mov_b32 v29, v27
    s_waitcnt lgkmcnt(2)
    v_mfma_f32_32x32x16_bf16 v[96:111], v[52:55], v[164:167], v[96:111]
    v_mfma_f32_32x32x16_bf16 v[112:127], v[52:55], v[228:231], v[112:127]
    ds_read_b128 v[48:51], v8 offset:16768
    s_nop 1
    v_permlane32_swap_b32 v28, v29
    v_max_f32 v27, v28, v29
    v_mul_f32 v27, s33, v27
    v_mov_b32 v21, v27
    v_fma_f32 v80, v80, s33, -v21
    v_exp_f32 v80, v80
    v_fma_f32 v81, v81, s33, -v21
    v_exp_f32 v81, v81
    s_waitcnt lgkmcnt(2)
    v_mfma_f32_32x32x16_bf16 v[96:111], v[56:59], v[168:171], v[96:111]
    v_mfma_f32_32x32x16_bf16 v[112:127], v[56:59], v[232:235], v[112:127]
    ds_read_b128 v[52:55], v9 offset:16768
    v_fma_f32 v82, v82, s33, -v21
    v_exp_f32 v82, v82
    v_fma_f32 v83, v83, s33, -v21
    v_exp_f32 v83, v83
    v_fma_f32 v84, v84, s33, -v21
    v_exp_f32 v84, v84
    v_fma_f32 v85, v85, s33, -v21
    v_exp_f32 v85, v85
    v_fma_f32 v86, v86, s33, -v21
    s_waitcnt lgkmcnt(2)
    v_mfma_f32_32x32x16_bf16 v[96:111], v[60:63], v[172:175], v[96:111]
    v_mfma_f32_32x32x16_bf16 v[112:127], v[60:63], v[236:239], v[112:127]
    ds_read_b128 v[56:59], v10 offset:16768
    v_exp_f32 v86, v86
    v_fma_f32 v87, v87, s33, -v21
    v_exp_f32 v87, v87
    v_fma_f32 v88, v88, s33, -v21
    v_exp_f32 v88, v88
    v_fma_f32 v89, v89, s33, -v21
    v_exp_f32 v89, v89
    v_fma_f32 v90, v90, s33, -v21
    v_exp_f32 v90, v90
    s_waitcnt lgkmcnt(2)
    v_mfma_f32_32x32x16_bf16 v[96:111], v[48:51], v[176:179], v[96:111]
    v_mfma_f32_32x32x16_bf16 v[112:127], v[48:51], v[240:243], v[112:127]
    ds_read_b128 v[60:63], v11 offset:16768
    v_fma_f32 v91, v91, s33, -v21
    v_exp_f32 v91, v91
    v_fma_f32 v92, v92, s33, -v21
    v_exp_f32 v92, v92
    v_fma_f32 v93, v93, s33, -v21
    v_exp_f32 v93, v93
    v_fma_f32 v94, v94, s33, -v21
    v_exp_f32 v94, v94
    v_fma_f32 v95, v95, s33, -v21
    s_waitcnt lgkmcnt(2)
    v_mfma_f32_32x32x16_bf16 v[96:111], v[52:55], v[180:183], v[96:111]
    v_mfma_f32_32x32x16_bf16 v[112:127], v[52:55], v[244:247], v[112:127]
    v_exp_f32 v95, v95
    v_add_f32 v23, v23, v80
    v_add_f32 v23, v23, v81
    v_add_f32 v23, v23, v82
    v_add_f32 v23, v23, v83
    v_add_f32 v23, v23, v84
    v_add_f32 v23, v23, v85
    v_add_f32 v23, v23, v86
    v_add_f32 v23, v23, v87
    s_waitcnt lgkmcnt(1)
    v_mfma_f32_32x32x16_bf16 v[96:111], v[56:59], v[184:187], v[96:111]
    v_mfma_f32_32x32x16_bf16 v[112:127], v[56:59], v[248:251], v[112:127]
    v_add_f32 v23, v23, v88
    v_add_f32 v23, v23, v89
    v_add_f32 v23, v23, v90
    v_add_f32 v23, v23, v91
    v_add_f32 v23, v23, v92
    v_add_f32 v23, v23, v93
    v_add_f32 v23, v23, v94
    v_add_f32 v23, v23, v95
    v_cvt_pk_bf16_f32 v80, v80, v81
    s_waitcnt lgkmcnt(0)
    v_mfma_f32_32x32x16_bf16 v[96:111], v[60:63], v[188:191], v[96:111]
    v_mfma_f32_32x32x16_bf16 v[112:127], v[60:63], v[252:255], v[112:127]
    v_cvt_pk_bf16_f32 v81, v82, v83
    v_cvt_pk_bf16_f32 v82, v84, v85
    v_cvt_pk_bf16_f32 v83, v86, v87
    v_cvt_pk_bf16_f32 v84, v88, v89
    v_cvt_pk_bf16_f32 v85, v90, v91
    v_cvt_pk_bf16_f32 v86, v92, v93
    v_cvt_pk_bf16_f32 v87, v94, v95
    s_add_u32 m0, s31, 16384
    s_add_u32 s34, s30, 40960
    buffer_load_dwordx4 v2, s[12:15], s34 offen offset:0 lds
    buffer_load_dwordx4 v3, s[12:15], s34 offen offset:1024 lds
    buffer_load_dwordx4 v4, s[12:15], s34 offen offset:2048 lds
    buffer_load_dwordx4 v5, s[12:15], s34 offen offset:3072 lds
    s_add_u32 m0, s31, 20480
    s_add_u32 s34, s30, 45056
    buffer_load_dwordx4 v2, s[12:15], s34 offen offset:0 lds
    buffer_load_dwordx4 v3, s[12:15], s34 offen offset:1024 lds
    buffer_load_dwordx4 v4, s[12:15], s34 offen offset:2048 lds
    buffer_load_dwordx4 v5, s[12:15], s34 offen offset:3072 lds
    s_add_u32 m0, s31, 24576
    s_add_u32 s34, s30, 16384
    buffer_load_dwordx4 v6, s[16:19], s34 offen offset:0 lds
    buffer_load_dwordx4 v7, s[16:19], s34 offen offset:1024 lds
    buffer_load_dwordx4 v6, s[16:19], s34 offen offset:2048 lds
    buffer_load_dwordx4 v7, s[16:19], s34 offen offset:3072 lds
    s_add_u32 m0, s31, 28672
    s_add_u32 s34, s30, 20480
    buffer_load_dwordx4 v6, s[16:19], s34 offen offset:0 lds
    buffer_load_dwordx4 v7, s[16:19], s34 offen offset:1024 lds
    buffer_load_dwordx4 v6, s[16:19], s34 offen offset:2048 lds
    buffer_load_dwordx4 v7, s[16:19], s34 offen offset:3072 lds
    s_nop 1
    s_waitcnt vmcnt(32)
    ds_read_b64_tr_b16 v[32:33], v16 offset:32768
    ds_read_b64_tr_b16 v[34:35], v16 offset:36864
    ds_read_b64_tr_b16 v[36:37], v17 offset:32768
    ds_read_b64_tr_b16 v[38:39], v17 offset:36864
    ds_read_b64_tr_b16 v[40:41], v18 offset:32768
    ds_read_b64_tr_b16 v[42:43], v18 offset:36864
    s_waitcnt lgkmcnt(4)
    v_mfma_f32_32x32x16_bf16 a[0:15], v[32:35], v[64:67], a[0:15]
    v_mfma_f32_32x32x16_bf16 a[128:143], v[32:35], v[80:83], a[128:143]
    ds_read_b64_tr_b16 v[44:45], v19 offset:32768
    ds_read_b64_tr_b16 v[46:47], v19 offset:36864
    s_waitcnt lgkmcnt(4)
    v_mfma_f32_32x32x16_bf16 a[16:31], v[36:39], v[64:67], a[16:31]
    v_mfma_f32_32x32x16_bf16 a[144:159], v[36:39], v[80:83], a[144:159]
    ds_read_b64_tr_b16 v[32:33], v16 offset:33024
    ds_read_b64_tr_b16 v[34:35], v16 offset:37120
    s_waitcnt lgkmcnt(4)
    v_mfma_f32_32x32x16_bf16 a[32:47], v[40:43], v[64:67], a[32:47]
    v_mfma_f32_32x32x16_bf16 a[160:175], v[40:43], v[80:83], a[160:175]
    ds_read_b64_tr_b16 v[36:37], v17 offset:33024
    ds_read_b64_tr_b16 v[38:39], v17 offset:37120
    s_waitcnt lgkmcnt(4)
    v_mfma_f32_32x32x16_bf16 a[48:63], v[44:47], v[64:67], a[48:63]
    v_mfma_f32_32x32x16_bf16 a[176:191], v[44:47], v[80:83], a[176:191]
    ds_read_b64_tr_b16 v[40:41], v18 offset:33024
    ds_read_b64_tr_b16 v[42:43], v18 offset:37120
    s_waitcnt lgkmcnt(4)
    v_mfma_f32_32x32x16_bf16 a[64:79], v[32:35], v[64:67], a[64:79]
    v_mfma_f32_32x32x16_bf16 a[192:207], v[32:35], v[80:83], a[192:207]
    ds_read_b64_tr_b16 v[44:45], v19 offset:33024
    ds_read_b64_tr_b16 v[46:47], v19 offset:37120
    s_waitcnt lgkmcnt(4)
    v_mfma_f32_32x32x16_bf16 a[80:95], v[36:39], v[64:67], a[80:95]
    v_mfma_f32_32x32x16_bf16 a[208:223], v[36:39], v[80:83], a[208:223]
    s_waitcnt vmcnt(24)
    ds_read_b64_tr_b16 v[32:33], v16 offset:0
    ds_read_b64_tr_b16 v[34:35], v16 offset:4096
    s_waitcnt lgkmcnt(4)
    v_mfma_f32_32x32x16_bf16 a[96:111], v[40:43], v[64:67], a[96:111]
    v_mfma_f32_32x32x16_bf16 a[224:239], v[40:43], v[80:83], a[224:239]
    ds_read_b64_tr_b16 v[36:37], v17 offset:0
    ds_read_b64_tr_b16 v[38:39], v17 offset:4096
    s_waitcnt lgkmcnt(4)
    v_mfma_f32_32x32x16_bf16 a[112:127], v[44:47], v[64:67], a[112:127]
    v_mfma_f32_32x32x16_bf16 a[240:255], v[44:47], v[80:83], a[240:255]
    ds_read_b64_tr_b16 v[40:41], v18 offset:0
    ds_read_b64_tr_b16 v[42:43], v18 offset:4096
    s_waitcnt lgkmcnt(4)
    v_mfma_f32_32x32x16_bf16 a[0:15], v[32:35], v[68:71], a[0:15]
    v_mfma_f32_32x32x16_bf16 a[128:143], v[32:35], v[84:87], a[128:143]
    ds_read_b64_tr_b16 v[44:45], v19 offset:0
    ds_read_b64_tr_b16 v[46:47], v19 offset:4096
    s_add_u32 m0, s31, 32768
    s_add_u32 s34, s30, 24576
    buffer_load_dwordx4 v6, s[16:19], s34 offen offset:0 lds
    buffer_load_dwordx4 v7, s[16:19], s34 offen offset:1024 lds
    buffer_load_dwordx4 v6, s[16:19], s34 offen offset:2048 lds
    buffer_load_dwordx4 v7, s[16:19], s34 offen offset:3072 lds
    s_add_u32 m0, s31, 36864
    s_add_u32 s34, s30, 28672
    buffer_load_dwordx4 v6, s[16:19], s34 offen offset:0 lds
    buffer_load_dwordx4 v7, s[16:19], s34 offen offset:1024 lds
    buffer_load_dwordx4 v6, s[16:19], s34 offen offset:2048 lds
    buffer_load_dwordx4 v7, s[16:19], s34 offen offset:3072 lds
    s_waitcnt lgkmcnt(4)
    v_mfma_f32_32x32x16_bf16 a[16:31], v[36:39], v[68:71], a[16:31]
    v_mfma_f32_32x32x16_bf16 a[144:159], v[36:39], v[84:87], a[144:159]
    ds_read_b64_tr_b16 v[32:33], v16 offset:256
    ds_read_b64_tr_b16 v[34:35], v16 offset:4352
    s_waitcnt lgkmcnt(4)
    v_mfma_f32_32x32x16_bf16 a[32:47], v[40:43], v[68:71], a[32:47]
    v_mfma_f32_32x32x16_bf16 a[160:175], v[40:43], v[84:87], a[160:175]
    ds_read_b64_tr_b16 v[36:37], v17 offset:256
    ds_read_b64_tr_b16 v[38:39], v17 offset:4352
    s_waitcnt lgkmcnt(4)
    v_mfma_f32_32x32x16_bf16 a[48:63], v[44:47], v[68:71], a[48:63]
    v_mfma_f32_32x32x16_bf16 a[176:191], v[44:47], v[84:87], a[176:191]
    ds_read_b64_tr_b16 v[40:41], v18 offset:256
    ds_read_b64_tr_b16 v[42:43], v18 offset:4352
    s_waitcnt lgkmcnt(4)
    v_mfma_f32_32x32x16_bf16 a[64:79], v[32:35], v[68:71], a[64:79]
    v_mfma_f32_32x32x16_bf16 a[192:207], v[32:35], v[84:87], a[192:207]
    ds_read_b64_tr_b16 v[44:45], v19 offset:256
    ds_read_b64_tr_b16 v[46:47], v19 offset:4352
    s_waitcnt lgkmcnt(4)
    v_mfma_f32_32x32x16_bf16 a[80:95], v[36:39], v[68:71], a[80:95]
    v_mfma_f32_32x32x16_bf16 a[208:223], v[36:39], v[84:87], a[208:223]
    s_waitcnt lgkmcnt(2)
    v_mfma_f32_32x32x16_bf16 a[96:111], v[40:43], v[68:71], a[96:111]
    v_mfma_f32_32x32x16_bf16 a[224:239], v[40:43], v[84:87], a[224:239]
    s_waitcnt lgkmcnt(0)
    v_mfma_f32_32x32x16_bf16 a[112:127], v[44:47], v[68:71], a[112:127]
    v_mfma_f32_32x32x16_bf16 a[240:255], v[44:47], v[84:87], a[240:255]
    s_add_u32 m0, s31, 0
    s_add_u32 s34, s30, 49152
    buffer_load_dwordx4 v2, s[12:15], s34 offen offset:0 lds
    buffer_load_dwordx4 v3, s[12:15], s34 offen offset:1024 lds
    buffer_load_dwordx4 v4, s[12:15], s34 offen offset:2048 lds
    buffer_load_dwordx4 v5, s[12:15], s34 offen offset:3072 lds
    s_add_u32 m0, s31, 4096
    s_add_u32 s34, s30, 53248
    buffer_load_dwordx4 v2, s[12:15], s34 offen offset:0 lds
    buffer_load_dwordx4 v3, s[12:15], s34 offen offset:1024 lds
    buffer_load_dwordx4 v4, s[12:15], s34 offen offset:2048 lds
    buffer_load_dwordx4 v5, s[12:15], s34 offen offset:3072 lds
    s_waitcnt vmcnt(24)
    ds_read_b128 v[48:51], v8 offset:8192
    ds_read_b128 v[52:55], v9 offset:8192
    ds_read_b128 v[56:59], v10 offset:8192
    s_waitcnt lgkmcnt(2)
    v_mfma_f32_32x32x16_bf16 v[64:79], v[48:51], v[128:131], 0
    v_mfma_f32_32x32x16_bf16 v[80:95], v[48:51], v[192:195], 0
    ds_read_b128 v[60:63], v11 offset:8192
    v_max3_f32 v24, v96, v97, v98
    v_max3_f32 v24, v24, v99, v100
    v_max3_f32 v24, v24, v101, v102
    v_max3_f32 v24, v24, v103, v104
    v_max3_f32 v24, v24, v105, v106
    v_max3_f32 v24, v24, v107, v108
    v_max3_f32 v24, v24, v109, v110
    v_max_f32 v24, v24, v111
    v_mov_b32 v25, v24
    v_mov_b32 v26, v24
    s_waitcnt lgkmcnt(2)
    v_mfma_f32_32x32x16_bf16 v[64:79], v[52:55], v[132:135], v[64:79]
    v_mfma_f32_32x32x16_bf16 v[80:95], v[52:55], v[196:199], v[80:95]
    ds_read_b128 v[48:51], v8 offset:8320
    s_nop 1
    v_permlane32_swap_b32 v25, v26
    v_max_f32 v24, v25, v26
    v_mul_f32 v24, s33, v24
    v_add_f32 v25, 0x41000000, v20
    v_cmp_gt_f32 vcc, v24, v25
    s_cbranch_vccz fused_kernel_rs1_0
    s_swappc_b64 s[44:45], s[46:47]
fused_kernel_rs1_0:
    v_fma_f32 v96, v96, s33, -v20
    v_exp_f32 v96, v96
    v_fma_f32 v97, v97, s33, -v20
    s_waitcnt lgkmcnt(2)
    v_mfma_f32_32x32x16_bf16 v[64:79], v[56:59], v[136:139], v[64:79]
    v_mfma_f32_32x32x16_bf16 v[80:95], v[56:59], v[200:203], v[80:95]
    ds_read_b128 v[52:55], v9 offset:8320
    v_exp_f32 v97, v97
    v_fma_f32 v98, v98, s33, -v20
    v_exp_f32 v98, v98
    v_fma_f32 v99, v99, s33, -v20
    v_exp_f32 v99, v99
    v_fma_f32 v100, v100, s33, -v20
    v_exp_f32 v100, v100
    v_fma_f32 v101, v101, s33, -v20
    v_exp_f32 v101, v101
    v_fma_f32 v102, v102, s33, -v20
    s_waitcnt lgkmcnt(2)
    v_mfma_f32_32x32x16_bf16 v[64:79], v[60:63], v[140:143], v[64:79]
    v_mfma_f32_32x32x16_bf16 v[80:95], v[60:63], v[204:207], v[80:95]
    ds_read_b128 v[56:59], v10 offset:8320
    v_exp_f32 v102, v102
    v_fma_f32 v103, v103, s33, -v20
    v_exp_f32 v103, v103
    v_fma_f32 v104, v104, s33, -v20
    v_exp_f32 v104, v104
    v_fma_f32 v105, v105, s33, -v20
    v_exp_f32 v105, v105
    v_fma_f32 v106, v106, s33, -v20
    v_exp_f32 v106, v106
    v_fma_f32 v107, v107, s33, -v20
    s_waitcnt lgkmcnt(2)
    v_mfma_f32_32x32x16_bf16 v[64:79], v[48:51], v[144:147], v[64:79]
    v_mfma_f32_32x32x16_bf16 v[80:95], v[48:51], v[208:211], v[80:95]
    ds_read_b128 v[60:63], v11 offset:8320
    v_exp_f32 v107, v107
    v_fma_f32 v108, v108, s33, -v20
    v_exp_f32 v108, v108
    v_fma_f32 v109, v109, s33, -v20
    v_exp_f32 v109, v109
    v_fma_f32 v110, v110, s33, -v20
    v_exp_f32 v110, v110
    v_fma_f32 v111, v111, s33, -v20
    v_exp_f32 v111, v111
    v_add_f32 v22, v22, v96
    s_waitcnt lgkmcnt(2)
    v_mfma_f32_32x32x16_bf16 v[64:79], v[52:55], v[148:151], v[64:79]
    v_mfma_f32_32x32x16_bf16 v[80:95], v[52:55], v[212:215], v[80:95]
    ds_read_b128 v[48:51], v8 offset:8448
    v_add_f32 v22, v22, v97
    v_add_f32 v22, v22, v98
    v_add_f32 v22, v22, v99
    v_add_f32 v22, v22, v100
    v_add_f32 v22, v22, v101
    v_add_f32 v22, v22, v102
    v_add_f32 v22, v22, v103
    v_add_f32 v22, v22, v104
    v_add_f32 v22, v22, v105
    v_add_f32 v22, v22, v106
    s_waitcnt lgkmcnt(2)
    v_mfma_f32_32x32x16_bf16 v[64:79], v[56:59], v[152:155], v[64:79]
    v_mfma_f32_32x32x16_bf16 v[80:95], v[56:59], v[216:219], v[80:95]
    ds_read_b128 v[52:55], v9 offset:8448
    v_add_f32 v22, v22, v107
    v_add_f32 v22, v22, v108
    v_add_f32 v22, v22, v109
    v_add_f32 v22, v22, v110
    v_add_f32 v22, v22, v111
    v_cvt_pk_bf16_f32 v96, v96, v97
    v_cvt_pk_bf16_f32 v97, v98, v99
    v_cvt_pk_bf16_f32 v98, v100, v101
    v_cvt_pk_bf16_f32 v99, v102, v103
    v_cvt_pk_bf16_f32 v100, v104, v105
    s_waitcnt lgkmcnt(2)
    v_mfma_f32_32x32x16_bf16 v[64:79], v[60:63], v[156:159], v[64:79]
    v_mfma_f32_32x32x16_bf16 v[80:95], v[60:63], v[220:223], v[80:95]
    ds_read_b128 v[56:59], v10 offset:8448
    v_cvt_pk_bf16_f32 v101, v106, v107
    v_cvt_pk_bf16_f32 v102, v108, v109
    v_cvt_pk_bf16_f32 v103, v110, v111
    v_max3_f32 v27, v112, v113, v114
    v_max3_f32 v27, v27, v115, v116
    v_max3_f32 v27, v27, v117, v118
    v_max3_f32 v27, v27, v119, v120
    v_max3_f32 v27, v27, v121, v122
    v_max3_f32 v27, v27, v123, v124
    v_max3_f32 v27, v27, v125, v126
    s_waitcnt lgkmcnt(2)
    v_mfma_f32_32x32x16_bf16 v[64:79], v[48:51], v[160:163], v[64:79]
    v_mfma_f32_32x32x16_bf16 v[80:95], v[48:51], v[224:227], v[80:95]
    ds_read_b128 v[60:63], v11 offset:8448
    v_max_f32 v27, v27, v127
    v_mov_b32 v28, v27
    v_mov_b32 v29, v27
    s_nop 1
    v_permlane32_swap_b32 v28, v29
    v_max_f32 v27, v28, v29
    v_mul_f32 v27, s33, v27
    v_add_f32 v28, 0x41000000, v21
    v_cmp_gt_f32 vcc, v27, v28
    s_cbranch_vccz fused_kernel_rs1_1
    s_swappc_b64 s[44:45], s[48:49]
fused_kernel_rs1_1:
    s_waitcnt lgkmcnt(2)
    v_mfma_f32_32x32x16_bf16 v[64:79], v[52:55], v[164:167], v[64:79]
    v_mfma_f32_32x32x16_bf16 v[80:95], v[52:55], v[228:231], v[80:95]
    ds_read_b128 v[48:51], v8 offset:8576
    v_fma_f32 v112, v112, s33, -v21
    v_exp_f32 v112, v112
    v_fma_f32 v113, v113, s33, -v21
    v_exp_f32 v113, v113
    v_fma_f32 v114, v114, s33, -v21
    v_exp_f32 v114, v114
    v_fma_f32 v115, v115, s33, -v21
    v_exp_f32 v115, v115
    v_fma_f32 v116, v116, s33, -v21
    v_exp_f32 v116, v116
    s_waitcnt lgkmcnt(2)
    v_mfma_f32_32x32x16_bf16 v[64:79], v[56:59], v[168:171], v[64:79]
    v_mfma_f32_32x32x16_bf16 v[80:95], v[56:59], v[232:235], v[80:95]
    ds_read_b128 v[52:55], v9 offset:8576
    v_fma_f32 v117, v117, s33, -v21
    v_exp_f32 v117, v117
    v_fma_f32 v118, v118, s33, -v21
    v_exp_f32 v118, v118
    v_fma_f32 v119, v119, s33, -v21
    v_exp_f32 v119, v119
    v_fma_f32 v120, v120, s33, -v21
    v_exp_f32 v120, v120
    v_fma_f32 v121, v121, s33, -v21
    v_exp_f32 v121, v121
    s_waitcnt lgkmcnt(2)
    v_mfma_f32_32x32x16_bf16 v[64:79], v[60:63], v[172:175], v[64:79]
    v_mfma_f32_32x32x16_bf16 v[80:95], v[60:63], v[236:239], v[80:95]
    ds_read_b128 v[56:59], v10 offset:8576
    v_fma_f32 v122, v122, s33, -v21
    v_exp_f32 v122, v122
    v_fma_f32 v123, v123, s33, -v21
    v_exp_f32 v123, v123
    v_fma_f32 v124, v124, s33, -v21
    v_exp_f32 v124, v124
    v_fma_f32 v125, v125, s33, -v21
    v_exp_f32 v125, v125
    v_fma_f32 v126, v126, s33, -v21
    v_exp_f32 v126, v126
    s_waitcnt lgkmcnt(2)
    v_mfma_f32_32x32x16_bf16 v[64:79], v[48:51], v[176:179], v[64:79]
    v_mfma_f32_32x32x16_bf16 v[80:95], v[48:51], v[240:243], v[80:95]
    ds_read_b128 v[60:63], v11 offset:8576
    v_fma_f32 v127, v127, s33, -v21
    v_exp_f32 v127, v127
    v_add_f32 v23, v23, v112
    v_add_f32 v23, v23, v113
    v_add_f32 v23, v23, v114
    v_add_f32 v23, v23, v115
    v_add_f32 v23, v23, v116
    v_add_f32 v23, v23, v117
    v_add_f32 v23, v23, v118
    v_add_f32 v23, v23, v119
    s_waitcnt lgkmcnt(2)
    v_mfma_f32_32x32x16_bf16 v[64:79], v[52:55], v[180:183], v[64:79]
    v_mfma_f32_32x32x16_bf16 v[80:95], v[52:55], v[244:247], v[80:95]
    v_add_f32 v23, v23, v120
    v_add_f32 v23, v23, v121
    v_add_f32 v23, v23, v122
    v_add_f32 v23, v23, v123
    v_add_f32 v23, v23, v124
    v_add_f32 v23, v23, v125
    v_add_f32 v23, v23, v126
    v_add_f32 v23, v23, v127
    v_cvt_pk_bf16_f32 v112, v112, v113
    v_cvt_pk_bf16_f32 v113, v114, v115
    s_waitcnt lgkmcnt(1)
    v_mfma_f32_32x32x16_bf16 v[64:79], v[56:59], v[184:187], v[64:79]
    v_mfma_f32_32x32x16_bf16 v[80:95], v[56:59], v[248:251], v[80:95]
    v_cvt_pk_bf16_f32 v114, v116, v117
    v_cvt_pk_bf16_f32 v115, v118, v119
    v_cvt_pk_bf16_f32 v116, v120, v121
    v_cvt_pk_bf16_f32 v117, v122, v123
    v_cvt_pk_bf16_f32 v118, v124, v125
    v_cvt_pk_bf16_f32 v119, v126, v127
    s_waitcnt lgkmcnt(0)
    v_mfma_f32_32x32x16_bf16 v[64:79], v[60:63], v[188:191], v[64:79]
    v_mfma_f32_32x32x16_bf16 v[80:95], v[60:63], v[252:255], v[80:95]
    s_add_u32 m0, s31, 8192
    s_add_u32 s34, s30, 57344
    buffer_load_dwordx4 v2, s[12:15], s34 offen offset:0 lds
    buffer_load_dwordx4 v3, s[12:15], s34 offen offset:1024 lds
    buffer_load_dwordx4 v4, s[12:15], s34 offen offset:2048 lds
    buffer_load_dwordx4 v5, s[12:15], s34 offen offset:3072 lds
    s_add_u32 m0, s31, 12288
    s_add_u32 s34, s30, 61440
    buffer_load_dwordx4 v2, s[12:15], s34 offen offset:0 lds
    buffer_load_dwordx4 v3, s[12:15], s34 offen offset:1024 lds
    buffer_load_dwordx4 v4, s[12:15], s34 offen offset:2048 lds
    buffer_load_dwordx4 v5, s[12:15], s34 offen offset:3072 lds
    s_add_u32 m0, s31, 16384
    s_add_u32 s34, s30, 32768
    buffer_load_dwordx4 v6, s[16:19], s34 offen offset:0 lds
    buffer_load_dwordx4 v7, s[16:19], s34 offen offset:1024 lds
    buffer_load_dwordx4 v6, s[16:19], s34 offen offset:2048 lds
    buffer_load_dwordx4 v7, s[16:19], s34 offen offset:3072 lds
    s_add_u32 m0, s31, 20480
    s_add_u32 s34, s30, 36864
    buffer_load_dwordx4 v6, s[16:19], s34 offen offset:0 lds
    buffer_load_dwordx4 v7, s[16:19], s34 offen offset:1024 lds
    buffer_load_dwordx4 v6, s[16:19], s34 offen offset:2048 lds
    buffer_load_dwordx4 v7, s[16:19], s34 offen offset:3072 lds
    s_nop 1
    s_waitcnt vmcnt(32)
    ds_read_b64_tr_b16 v[32:33], v16 offset:24576
    ds_read_b64_tr_b16 v[34:35], v16 offset:28672
    ds_read_b64_tr_b16 v[36:37], v17 offset:24576
    ds_read_b64_tr_b16 v[38:39], v17 offset:28672
    ds_read_b64_tr_b16 v[40:41], v18 offset:24576
    ds_read_b64_tr_b16 v[42:43], v18 offset:28672
    s_waitcnt lgkmcnt(4)
    v_mfma_f32_32x32x16_bf16 a[0:15], v[32:35], v[96:99], a[0:15]
    v_mfma_f32_32x32x16_bf16 a[128:143], v[32:35], v[112:115], a[128:143]
    ds_read_b64_tr_b16 v[44:45], v19 offset:24576
    ds_read_b64_tr_b16 v[46:47], v19 offset:28672
    s_waitcnt lgkmcnt(4)
    v_mfma_f32_32x32x16_bf16 a[16:31], v[36:39], v[96:99], a[16:31]
    v_mfma_f32_32x32x16_bf16 a[144:159], v[36:39], v[112:115], a[144:159]
    ds_read_b64_tr_b16 v[32:33], v16 offset:24832
    ds_read_b64_tr_b16 v[34:35], v16 offset:28928
    s_waitcnt lgkmcnt(4)
    v_mfma_f32_32x32x16_bf16 a[32:47], v[40:43], v[96:99], a[32:47]
    v_mfma_f32_32x32x16_bf16 a[160:175], v[40:43], v[112:115], a[160:175]
    ds_read_b64_tr_b16 v[36:37], v17 offset:24832
    ds_read_b64_tr_b16 v[38:39], v17 offset:28928
    s_waitcnt lgkmcnt(4)
    v_mfma_f32_32x32x16_bf16 a[48:63], v[44:47], v[96:99], a[48:63]
    v_mfma_f32_32x32x16_bf16 a[176:191], v[44:47], v[112:115], a[176:191]
    ds_read_b64_tr_b16 v[40:41], v18 offset:24832
    ds_read_b64_tr_b16 v[42:43], v18 offset:28928
    s_waitcnt lgkmcnt(4)
    v_mfma_f32_32x32x16_bf16 a[64:79], v[32:35], v[96:99], a[64:79]
    v_mfma_f32_32x32x16_bf16 a[192:207], v[32:35], v[112:115], a[192:207]
    ds_read_b64_tr_b16 v[44:45], v19 offset:24832
    ds_read_b64_tr_b16 v[46:47], v19 offset:28928
    s_waitcnt lgkmcnt(4)
    v_mfma_f32_32x32x16_bf16 a[80:95], v[36:39], v[96:99], a[80:95]
    v_mfma_f32_32x32x16_bf16 a[208:223], v[36:39], v[112:115], a[208:223]
    s_waitcnt vmcnt(24)
    ds_read_b64_tr_b16 v[32:33], v16 offset:32768
    ds_read_b64_tr_b16 v[34:35], v16 offset:36864
    s_waitcnt lgkmcnt(4)
    v_mfma_f32_32x32x16_bf16 a[96:111], v[40:43], v[96:99], a[96:111]
    v_mfma_f32_32x32x16_bf16 a[224:239], v[40:43], v[112:115], a[224:239]
    ds_read_b64_tr_b16 v[36:37], v17 offset:32768
    ds_read_b64_tr_b16 v[38:39], v17 offset:36864
    s_waitcnt lgkmcnt(4)
    v_mfma_f32_32x32x16_bf16 a[112:127], v[44:47], v[96:99], a[112:127]
    v_mfma_f32_32x32x16_bf16 a[240:255], v[44:47], v[112:115], a[240:255]
    ds_read_b64_tr_b16 v[40:41], v18 offset:32768
    ds_read_b64_tr_b16 v[42:43], v18 offset:36864
    s_waitcnt lgkmcnt(4)
    v_mfma_f32_32x32x16_bf16 a[0:15], v[32:35], v[100:103], a[0:15]
    v_mfma_f32_32x32x16_bf16 a[128:143], v[32:35], v[116:119], a[128:143]
    ds_read_b64_tr_b16 v[44:45], v19 offset:32768
    ds_read_b64_tr_b16 v[46:47], v19 offset:36864
    s_add_u32 m0, s31, 24576
    s_add_u32 s34, s30, 40960
    buffer_load_dwordx4 v6, s[16:19], s34 offen offset:0 lds
    buffer_load_dwordx4 v7, s[16:19], s34 offen offset:1024 lds
    buffer_load_dwordx4 v6, s[16:19], s34 offen offset:2048 lds
    buffer_load_dwordx4 v7, s[16:19], s34 offen offset:3072 lds
    s_add_u32 m0, s31, 28672
    s_add_u32 s34, s30, 45056
    buffer_load_dwordx4 v6, s[16:19], s34 offen offset:0 lds
    buffer_load_dwordx4 v7, s[16:19], s34 offen offset:1024 lds
    buffer_load_dwordx4 v6, s[16:19], s34 offen offset:2048 lds
    buffer_load_dwordx4 v7, s[16:19], s34 offen offset:3072 lds
    s_waitcnt lgkmcnt(4)
    v_mfma_f32_32x32x16_bf16 a[16:31], v[36:39], v[100:103], a[16:31]
    v_mfma_f32_32x32x16_bf16 a[144:159], v[36:39], v[116:119], a[144:159]
    ds_read_b64_tr_b16 v[32:33], v16 offset:33024
    ds_read_b64_tr_b16 v[34:35], v16 offset:37120
    s_waitcnt lgkmcnt(4)
    v_mfma_f32_32x32x16_bf16 a[32:47], v[40:43], v[100:103], a[32:47]
    v_mfma_f32_32x32x16_bf16 a[160:175], v[40:43], v[116:119], a[160:175]
    ds_read_b64_tr_b16 v[36:37], v17 offset:33024
    ds_read_b64_tr_b16 v[38:39], v17 offset:37120
    s_waitcnt lgkmcnt(4)
    v_mfma_f32_32x32x16_bf16 a[48:63], v[44:47], v[100:103], a[48:63]
    v_mfma_f32_32x32x16_bf16 a[176:191], v[44:47], v[116:119], a[176:191]
    ds_read_b64_tr_b16 v[40:41], v18 offset:33024
    ds_read_b64_tr_b16 v[42:43], v18 offset:37120
    s_waitcnt lgkmcnt(4)
    v_mfma_f32_32x32x16_bf16 a[64:79], v[32:35], v[100:103], a[64:79]
    v_mfma_f32_32x32x16_bf16 a[192:207], v[32:35], v[116:119], a[192:207]
    ds_read_b64_tr_b16 v[44:45], v19 offset:33024
    ds_read_b64_tr_b16 v[46:47], v19 offset:37120
    s_waitcnt lgkmcnt(4)
    v_mfma_f32_32x32x16_bf16 a[80:95], v[36:39], v[100:103], a[80:95]
    v_mfma_f32_32x32x16_bf16 a[208:223], v[36:39], v[116:119], a[208:223]
    s_waitcnt lgkmcnt(2)
    v_mfma_f32_32x32x16_bf16 a[96:111], v[40:43], v[100:103], a[96:111]
    v_mfma_f32_32x32x16_bf16 a[224:239], v[40:43], v[116:119], a[224:239]
    s_waitcnt lgkmcnt(0)
    v_mfma_f32_32x32x16_bf16 a[112:127], v[44:47], v[100:103], a[112:127]
    v_mfma_f32_32x32x16_bf16 a[240:255], v[44:47], v[116:119], a[240:255]
    s_add_u32 m0, s31, 32768
    s_add_u32 s34, s30, 65536
    buffer_load_dwordx4 v2, s[12:15], s34 offen offset:0 lds
    buffer_load_dwordx4 v3, s[12:15], s34 offen offset:1024 lds
    buffer_load_dwordx4 v4, s[12:15], s34 offen offset:2048 lds
    buffer_load_dwordx4 v5, s[12:15], s34 offen offset:3072 lds
    s_add_u32 m0, s31, 36864
    s_add_u32 s34, s30, 69632
    buffer_load_dwordx4 v2, s[12:15], s34 offen offset:0 lds
    buffer_load_dwordx4 v3, s[12:15], s34 offen offset:1024 lds
    buffer_load_dwordx4 v4, s[12:15], s34 offen offset:2048 lds
    buffer_load_dwordx4 v5, s[12:15], s34 offen offset:3072 lds
    s_waitcnt vmcnt(24)
    ds_read_b128 v[48:51], v8 offset:0
    ds_read_b128 v[52:55], v9 offset:0
    ds_read_b128 v[56:59], v10 offset:0
    s_waitcnt lgkmcnt(2)
    v_mfma_f32_32x32x16_bf16 v[96:111], v[48:51], v[128:131], 0
    v_mfma_f32_32x32x16_bf16 v[112:127], v[48:51], v[192:195], 0
    ds_read_b128 v[60:63], v11 offset:0
    v_max3_f32 v24, v64, v65, v66
    v_max3_f32 v24, v24, v67, v68
    v_max3_f32 v24, v24, v69, v70
    v_max3_f32 v24, v24, v71, v72
    v_max3_f32 v24, v24, v73, v74
    v_max3_f32 v24, v24, v75, v76
    v_max3_f32 v24, v24, v77, v78
    v_max_f32 v24, v24, v79
    v_mov_b32 v25, v24
    v_mov_b32 v26, v24
    s_waitcnt lgkmcnt(2)
    v_mfma_f32_32x32x16_bf16 v[96:111], v[52:55], v[132:135], v[96:111]
    v_mfma_f32_32x32x16_bf16 v[112:127], v[52:55], v[196:199], v[112:127]
    ds_read_b128 v[48:51], v8 offset:128
    s_nop 1
    v_permlane32_swap_b32 v25, v26
    v_max_f32 v24, v25, v26
    v_mul_f32 v24, s33, v24
    v_add_f32 v25, 0x41000000, v20
    v_cmp_gt_f32 vcc, v24, v25
    s_cbranch_vccz fused_kernel_rs2_0
    s_swappc_b64 s[44:45], s[46:47]
fused_kernel_rs2_0:
    v_fma_f32 v64, v64, s33, -v20
    v_exp_f32 v64, v64
    v_fma_f32 v65, v65, s33, -v20
    s_waitcnt lgkmcnt(2)
    v_mfma_f32_32x32x16_bf16 v[96:111], v[56:59], v[136:139], v[96:111]
    v_mfma_f32_32x32x16_bf16 v[112:127], v[56:59], v[200:203], v[112:127]
    ds_read_b128 v[52:55], v9 offset:128
    v_exp_f32 v65, v65
    v_fma_f32 v66, v66, s33, -v20
    v_exp_f32 v66, v66
    v_fma_f32 v67, v67, s33, -v20
    v_exp_f32 v67, v67
    v_fma_f32 v68, v68, s33, -v20
    v_exp_f32 v68, v68
    v_fma_f32 v69, v69, s33, -v20
    v_exp_f32 v69, v69
    v_fma_f32 v70, v70, s33, -v20
    s_waitcnt lgkmcnt(2)
    v_mfma_f32_32x32x16_bf16 v[96:111], v[60:63], v[140:143], v[96:111]
    v_mfma_f32_32x32x16_bf16 v[112:127], v[60:63], v[204:207], v[112:127]
    ds_read_b128 v[56:59], v10 offset:128
    v_exp_f32 v70, v70
    v_fma_f32 v71, v71, s33, -v20
    v_exp_f32 v71, v71
    v_fma_f32 v72, v72, s33, -v20
    v_exp_f32 v72, v72
    v_fma_f32 v73, v73, s33, -v20
    v_exp_f32 v73, v73
    v_fma_f32 v74, v74, s33, -v20
    v_exp_f32 v74, v74
    v_fma_f32 v75, v75, s33, -v20
    s_waitcnt lgkmcnt(2)
    v_mfma_f32_32x32x16_bf16 v[96:111], v[48:51], v[144:147], v[96:111]
    v_mfma_f32_32x32x16_bf16 v[112:127], v[48:51], v[208:211], v[112:127]
    ds_read_b128 v[60:63], v11 offset:128
    v_exp_f32 v75, v75
    v_fma_f32 v76, v76, s33, -v20
    v_exp_f32 v76, v76
    v_fma_f32 v77, v77, s33, -v20
    v_exp_f32 v77, v77
    v_fma_f32 v78, v78, s33, -v20
    v_exp_f32 v78, v78
    v_fma_f32 v79, v79, s33, -v20
    v_exp_f32 v79, v79
    v_add_f32 v22, v22, v64
    s_waitcnt lgkmcnt(2)
    v_mfma_f32_32x32x16_bf16 v[96:111], v[52:55], v[148:151], v[96:111]
    v_mfma_f32_32x32x16_bf16 v[112:127], v[52:55], v[212:215], v[112:127]
    ds_read_b128 v[48:51], v8 offset:256
    v_add_f32 v22, v22, v65
    v_add_f32 v22, v22, v66
    v_add_f32 v22, v22, v67
    v_add_f32 v22, v22, v68
    v_add_f32 v22, v22, v69
    v_add_f32 v22, v22, v70
    v_add_f32 v22, v22, v71
    v_add_f32 v22, v22, v72
    v_add_f32 v22, v22, v73
    v_add_f32 v22, v22, v74
    s_waitcnt lgkmcnt(2)
    v_mfma_f32_32x32x16_bf16 v[96:111], v[56:59], v[152:155], v[96:111]
    v_mfma_f32_32x32x16_bf16 v[112:127], v[56:59], v[216:219], v[112:127]
    ds_read_b128 v[52:55], v9 offset:256
    v_add_f32 v22, v22, v75
    v_add_f32 v22, v22, v76
    v_add_f32 v22, v22, v77
    v_add_f32 v22, v22, v78
    v_add_f32 v22, v22, v79
    v_cvt_pk_bf16_f32 v64, v64, v65
    v_cvt_pk_bf16_f32 v65, v66, v67
    v_cvt_pk_bf16_f32 v66, v68, v69
    v_cvt_pk_bf16_f32 v67, v70, v71
    v_cvt_pk_bf16_f32 v68, v72, v73
    s_waitcnt lgkmcnt(2)
    v_mfma_f32_32x32x16_bf16 v[96:111], v[60:63], v[156:159], v[96:111]
    v_mfma_f32_32x32x16_bf16 v[112:127], v[60:63], v[220:223], v[112:127]
    ds_read_b128 v[56:59], v10 offset:256
    v_cvt_pk_bf16_f32 v69, v74, v75
    v_cvt_pk_bf16_f32 v70, v76, v77
    v_cvt_pk_bf16_f32 v71, v78, v79
    v_max3_f32 v27, v80, v81, v82
    v_max3_f32 v27, v27, v83, v84
    v_max3_f32 v27, v27, v85, v86
    v_max3_f32 v27, v27, v87, v88
    v_max3_f32 v27, v27, v89, v90
    v_max3_f32 v27, v27, v91, v92
    v_max3_f32 v27, v27, v93, v94
    s_waitcnt lgkmcnt(2)
    v_mfma_f32_32x32x16_bf16 v[96:111], v[48:51], v[160:163], v[96:111]
    v_mfma_f32_32x32x16_bf16 v[112:127], v[48:51], v[224:227], v[112:127]
    ds_read_b128 v[60:63], v11 offset:256
    v_max_f32 v27, v27, v95
    v_mov_b32 v28, v27
    v_mov_b32 v29, v27
    s_nop 1
    v_permlane32_swap_b32 v28, v29
    v_max_f32 v27, v28, v29
    v_mul_f32 v27, s33, v27
    v_add_f32 v28, 0x41000000, v21
    v_cmp_gt_f32 vcc, v27, v28
    s_cbranch_vccz fused_kernel_rs2_1
    s_swappc_b64 s[44:45], s[48:49]
fused_kernel_rs2_1:
    s_waitcnt lgkmcnt(2)
    v_mfma_f32_32x32x16_bf16 v[96:111], v[52:55], v[164:167], v[96:111]
    v_mfma_f32_32x32x16_bf16 v[112:127], v[52:55], v[228:231], v[112:127]
    ds_read_b128 v[48:51], v8 offset:384
    v_fma_f32 v80, v80, s33, -v21
    v_exp_f32 v80, v80
    v_fma_f32 v81, v81, s33, -v21
    v_exp_f32 v81, v81
    v_fma_f32 v82, v82, s33, -v21
    v_exp_f32 v82, v82
    v_fma_f32 v83, v83, s33, -v21
    v_exp_f32 v83, v83
    v_fma_f32 v84, v84, s33, -v21
    v_exp_f32 v84, v84
    s_waitcnt lgkmcnt(2)
    v_mfma_f32_32x32x16_bf16 v[96:111], v[56:59], v[168:171], v[96:111]
    v_mfma_f32_32x32x16_bf16 v[112:127], v[56:59], v[232:235], v[112:127]
    ds_read_b128 v[52:55], v9 offset:384
    v_fma_f32 v85, v85, s33, -v21
    v_exp_f32 v85, v85
    v_fma_f32 v86, v86, s33, -v21
    v_exp_f32 v86, v86
    v_fma_f32 v87, v87, s33, -v21
    v_exp_f32 v87, v87
    v_fma_f32 v88, v88, s33, -v21
    v_exp_f32 v88, v88
    v_fma_f32 v89, v89, s33, -v21
    v_exp_f32 v89, v89
    s_waitcnt lgkmcnt(2)
    v_mfma_f32_32x32x16_bf16 v[96:111], v[60:63], v[172:175], v[96:111]
    v_mfma_f32_32x32x16_bf16 v[112:127], v[60:63], v[236:239], v[112:127]
    ds_read_b128 v[56:59], v10 offset:384
    v_fma_f32 v90, v90, s33, -v21
    v_exp_f32 v90, v90
    v_fma_f32 v91, v91, s33, -v21
    v_exp_f32 v91, v91
    v_fma_f32 v92, v92, s33, -v21
    v_exp_f32 v92, v92
    v_fma_f32 v93, v93, s33, -v21
    v_exp_f32 v93, v93
    v_fma_f32 v94, v94, s33, -v21
    v_exp_f32 v94, v94
    s_waitcnt lgkmcnt(2)
    v_mfma_f32_32x32x16_bf16 v[96:111], v[48:51], v[176:179], v[96:111]
    v_mfma_f32_32x32x16_bf16 v[112:127], v[48:51], v[240:243], v[112:127]
    ds_read_b128 v[60:63], v11 offset:384
    v_fma_f32 v95, v95, s33, -v21
    v_exp_f32 v95, v95
    v_add_f32 v23, v23, v80
    v_add_f32 v23, v23, v81
    v_add_f32 v23, v23, v82
    v_add_f32 v23, v23, v83
    v_add_f32 v23, v23, v84
    v_add_f32 v23, v23, v85
    v_add_f32 v23, v23, v86
    v_add_f32 v23, v23, v87
    s_waitcnt lgkmcnt(2)
    v_mfma_f32_32x32x16_bf16 v[96:111], v[52:55], v[180:183], v[96:111]
    v_mfma_f32_32x32x16_bf16 v[112:127], v[52:55], v[244:247], v[112:127]
    v_add_f32 v23, v23, v88
    v_add_f32 v23, v23, v89
    v_add_f32 v23, v23, v90
    v_add_f32 v23, v23, v91
    v_add_f32 v23, v23, v92
    v_add_f32 v23, v23, v93
    v_add_f32 v23, v23, v94
    v_add_f32 v23, v23, v95
    v_cvt_pk_bf16_f32 v80, v80, v81
    v_cvt_pk_bf16_f32 v81, v82, v83
    s_waitcnt lgkmcnt(1)
    v_mfma_f32_32x32x16_bf16 v[96:111], v[56:59], v[184:187], v[96:111]
    v_mfma_f32_32x32x16_bf16 v[112:127], v[56:59], v[248:251], v[112:127]
    v_cvt_pk_bf16_f32 v82, v84, v85
    v_cvt_pk_bf16_f32 v83, v86, v87
    v_cvt_pk_bf16_f32 v84, v88, v89
    v_cvt_pk_bf16_f32 v85, v90, v91
    v_cvt_pk_bf16_f32 v86, v92, v93
    v_cvt_pk_bf16_f32 v87, v94, v95
    s_waitcnt lgkmcnt(0)
    v_mfma_f32_32x32x16_bf16 v[96:111], v[60:63], v[188:191], v[96:111]
    v_mfma_f32_32x32x16_bf16 v[112:127], v[60:63], v[252:255], v[112:127]
    s_add_u32 m0, s31, 0
    s_add_u32 s34, s30, 73728
    buffer_load_dwordx4 v2, s[12:15], s34 offen offset:0 lds
    buffer_load_dwordx4 v3, s[12:15], s34 offen offset:1024 lds
    buffer_load_dwordx4 v4, s[12:15], s34 offen offset:2048 lds
    buffer_load_dwordx4 v5, s[12:15], s34 offen offset:3072 lds
    s_add_u32 m0, s31, 4096
    s_add_u32 s34, s30, 77824
    buffer_load_dwordx4 v2, s[12:15], s34 offen offset:0 lds
    buffer_load_dwordx4 v3, s[12:15], s34 offen offset:1024 lds
    buffer_load_dwordx4 v4, s[12:15], s34 offen offset:2048 lds
    buffer_load_dwordx4 v5, s[12:15], s34 offen offset:3072 lds
    s_add_u32 m0, s31, 8192
    s_add_u32 s34, s30, 49152
    buffer_load_dwordx4 v6, s[16:19], s34 offen offset:0 lds
    buffer_load_dwordx4 v7, s[16:19], s34 offen offset:1024 lds
    buffer_load_dwordx4 v6, s[16:19], s34 offen offset:2048 lds
    buffer_load_dwordx4 v7, s[16:19], s34 offen offset:3072 lds
    s_add_u32 m0, s31, 12288
    s_add_u32 s34, s30, 53248
    buffer_load_dwordx4 v6, s[16:19], s34 offen offset:0 lds
    buffer_load_dwordx4 v7, s[16:19], s34 offen offset:1024 lds
    buffer_load_dwordx4 v6, s[16:19], s34 offen offset:2048 lds
    buffer_load_dwordx4 v7, s[16:19], s34 offen offset:3072 lds
    s_nop 1
    s_waitcnt vmcnt(32)
    ds_read_b64_tr_b16 v[32:33], v16 offset:16384
    ds_read_b64_tr_b16 v[34:35], v16 offset:20480
    ds_read_b64_tr_b16 v[36:37], v17 offset:16384
    ds_read_b64_tr_b16 v[38:39], v17 offset:20480
    ds_read_b64_tr_b16 v[40:41], v18 offset:16384
    ds_read_b64_tr_b16 v[42:43], v18 offset:20480
    s_waitcnt lgkmcnt(4)
    v_mfma_f32_32x32x16_bf16 a[0:15], v[32:35], v[64:67], a[0:15]
    v_mfma_f32_32x32x16_bf16 a[128:143], v[32:35], v[80:83], a[128:143]
    ds_read_b64_tr_b16 v[44:45], v19 offset:16384
    ds_read_b64_tr_b16 v[46:47], v19 offset:20480
    s_waitcnt lgkmcnt(4)
    v_mfma_f32_32x32x16_bf16 a[16:31], v[36:39], v[64:67], a[16:31]
    v_mfma_f32_32x32x16_bf16 a[144:159], v[36:39], v[80:83], a[144:159]
    ds_read_b64_tr_b16 v[32:33], v16 offset:16640
    ds_read_b64_tr_b16 v[34:35], v16 offset:20736
    s_waitcnt lgkmcnt(4)
    v_mfma_f32_32x32x16_bf16 a[32:47], v[40:43], v[64:67], a[32:47]
    v_mfma_f32_32x32x16_bf16 a[160:175], v[40:43], v[80:83], a[160:175]
    ds_read_b64_tr_b16 v[36:37], v17 offset:16640
    ds_read_b64_tr_b16 v[38:39], v17 offset:20736
    s_waitcnt lgkmcnt(4)
    v_mfma_f32_32x32x16_bf16 a[48:63], v[44:47], v[64:67], a[48:63]
    v_mfma_f32_32x32x16_bf16 a[176:191], v[44:47], v[80:83], a[176:191]
    ds_read_b64_tr_b16 v[40:41], v18 offset:16640
    ds_read_b64_tr_b16 v[42:43], v18 offset:20736
    s_waitcnt lgkmcnt(4)
    v_mfma_f32_32x32x16_bf16 a[64:79], v[32:35], v[64:67], a[64:79]
    v_mfma_f32_32x32x16_bf16 a[192:207], v[32:35], v[80:83], a[192:207]
    ds_read_b64_tr_b16 v[44:45], v19 offset:16640
    ds_read_b64_tr_b16 v[46:47], v19 offset:20736
    s_waitcnt lgkmcnt(4)
    v_mfma_f32_32x32x16_bf16 a[80:95], v[36:39], v[64:67], a[80:95]
    v_mfma_f32_32x32x16_bf16 a[208:223], v[36:39], v[80:83], a[208:223]
    s_waitcnt vmcnt(24)
    ds_read_b64_tr_b16 v[32:33], v16 offset:24576
    ds_read_b64_tr_b16 v[34:35], v16 offset:28672
    s_waitcnt lgkmcnt(4)
    v_mfma_f32_32x32x16_bf16 a[96:111], v[40:43], v[64:67], a[96:111]
    v_mfma_f32_32x32x16_bf16 a[224:239], v[40:43], v[80:83], a[224:239]
    ds_read_b64_tr_b16 v[36:37], v17 offset:24576
    ds_read_b64_tr_b16 v[38:39], v17 offset:28672
    s_waitcnt lgkmcnt(4)
    v_mfma_f32_32x32x16_bf16 a[112:127], v[44:47], v[64:67], a[112:127]
    v_mfma_f32_32x32x16_bf16 a[240:255], v[44:47], v[80:83], a[240:255]
    ds_read_b64_tr_b16 v[40:41], v18 offset:24576
    ds_read_b64_tr_b16 v[42:43], v18 offset:28672
    s_waitcnt lgkmcnt(4)
    v_mfma_f32_32x32x16_bf16 a[0:15], v[32:35], v[68:71], a[0:15]
    v_mfma_f32_32x32x16_bf16 a[128:143], v[32:35], v[84:87], a[128:143]
    ds_read_b64_tr_b16 v[44:45], v19 offset:24576
    ds_read_b64_tr_b16 v[46:47], v19 offset:28672
    s_add_u32 m0, s31, 16384
    s_add_u32 s34, s30, 57344
    buffer_load_dwordx4 v6, s[16:19], s34 offen offset:0 lds
    buffer_load_dwordx4 v7, s[16:19], s34 offen offset:1024 lds
    buffer_load_dwordx4 v6, s[16:19], s34 offen offset:2048 lds
    buffer_load_dwordx4 v7, s[16:19], s34 offen offset:3072 lds
    s_add_u32 m0, s31, 20480
    s_add_u32 s34, s30, 61440
    buffer_load_dwordx4 v6, s[16:19], s34 offen offset:0 lds
    buffer_load_dwordx4 v7, s[16:19], s34 offen offset:1024 lds
    buffer_load_dwordx4 v6, s[16:19], s34 offen offset:2048 lds
    buffer_load_dwordx4 v7, s[16:19], s34 offen offset:3072 lds
    s_waitcnt lgkmcnt(4)
    v_mfma_f32_32x32x16_bf16 a[16:31], v[36:39], v[68:71], a[16:31]
    v_mfma_f32_32x32x16_bf16 a[144:159], v[36:39], v[84:87], a[144:159]
    ds_read_b64_tr_b16 v[32:33], v16 offset:24832
    ds_read_b64_tr_b16 v[34:35], v16 offset:28928
    s_waitcnt lgkmcnt(4)
    v_mfma_f32_32x32x16_bf16 a[32:47], v[40:43], v[68:71], a[32:47]
    v_mfma_f32_32x32x16_bf16 a[160:175], v[40:43], v[84:87], a[160:175]
    ds_read_b64_tr_b16 v[36:37], v17 offset:24832
    ds_read_b64_tr_b16 v[38:39], v17 offset:28928
    s_waitcnt lgkmcnt(4)
    v_mfma_f32_32x32x16_bf16 a[48:63], v[44:47], v[68:71], a[48:63]
    v_mfma_f32_32x32x16_bf16 a[176:191], v[44:47], v[84:87], a[176:191]
    ds_read_b64_tr_b16 v[40:41], v18 offset:24832
    ds_read_b64_tr_b16 v[42:43], v18 offset:28928
    s_waitcnt lgkmcnt(4)
    v_mfma_f32_32x32x16_bf16 a[64:79], v[32:35], v[68:71], a[64:79]
    v_mfma_f32_32x32x16_bf16 a[192:207], v[32:35], v[84:87], a[192:207]
    ds_read_b64_tr_b16 v[44:45], v19 offset:24832
    ds_read_b64_tr_b16 v[46:47], v19 offset:28928
    s_waitcnt lgkmcnt(4)
    v_mfma_f32_32x32x16_bf16 a[80:95], v[36:39], v[68:71], a[80:95]
    v_mfma_f32_32x32x16_bf16 a[208:223], v[36:39], v[84:87], a[208:223]
    s_waitcnt lgkmcnt(2)
    v_mfma_f32_32x32x16_bf16 a[96:111], v[40:43], v[68:71], a[96:111]
    v_mfma_f32_32x32x16_bf16 a[224:239], v[40:43], v[84:87], a[224:239]
    s_waitcnt lgkmcnt(0)
    v_mfma_f32_32x32x16_bf16 a[112:127], v[44:47], v[68:71], a[112:127]
    v_mfma_f32_32x32x16_bf16 a[240:255], v[44:47], v[84:87], a[240:255]
    s_add_u32 m0, s31, 24576
    s_add_u32 s34, s30, 81920
    buffer_load_dwordx4 v2, s[12:15], s34 offen offset:0 lds
    buffer_load_dwordx4 v3, s[12:15], s34 offen offset:1024 lds
    buffer_load_dwordx4 v4, s[12:15], s34 offen offset:2048 lds
    buffer_load_dwordx4 v5, s[12:15], s34 offen offset:3072 lds
    s_add_u32 m0, s31, 28672
    s_add_u32 s34, s30, 86016
    buffer_load_dwordx4 v2, s[12:15], s34 offen offset:0 lds
    buffer_load_dwordx4 v3, s[12:15], s34 offen offset:1024 lds
    buffer_load_dwordx4 v4, s[12:15], s34 offen offset:2048 lds
    buffer_load_dwordx4 v5, s[12:15], s34 offen offset:3072 lds
    s_waitcnt vmcnt(24)
    ds_read_b128 v[48:51], v12 offset:0
    ds_read_b128 v[52:55], v13 offset:0
    ds_read_b128 v[56:59], v14 offset:0
    s_waitcnt lgkmcnt(2)
    v_mfma_f32_32x32x16_bf16 v[64:79], v[48:51], v[128:131], 0
    v_mfma_f32_32x32x16_bf16 v[80:95], v[48:51], v[192:195], 0
    ds_read_b128 v[60:63], v15 offset:0
    v_max3_f32 v24, v96, v97, v98
    v_max3_f32 v24, v24, v99, v100
    v_max3_f32 v24, v24, v101, v102
    v_max3_f32 v24, v24, v103, v104
    v_max3_f32 v24, v24, v105, v106
    v_max3_f32 v24, v24, v107, v108
    v_max3_f32 v24, v24, v109, v110
    v_max_f32 v24, v24, v111
    v_mov_b32 v25, v24
    v_mov_b32 v26, v24
    s_waitcnt lgkmcnt(2)
    v_mfma_f32_32x32x16_bf16 v[64:79], v[52:55], v[132:135], v[64:79]
    v_mfma_f32_32x32x16_bf16 v[80:95], v[52:55], v[196:199], v[80:95]
    ds_read_b128 v[48:51], v12 offset:128
    s_nop 1
    v_permlane32_swap_b32 v25, v26
    v_max_f32 v24, v25, v26
    v_mul_f32 v24, s33, v24
    v_add_f32 v25, 0x41000000, v20
    v_cmp_gt_f32 vcc, v24, v25
    s_cbranch_vccz fused_kernel_rs3_0
    s_swappc_b64 s[44:45], s[46:47]
fused_kernel_rs3_0:
    v_fma_f32 v96, v96, s33, -v20
    v_exp_f32 v96, v96
    v_fma_f32 v97, v97, s33, -v20
    s_waitcnt lgkmcnt(2)
    v_mfma_f32_32x32x16_bf16 v[64:79], v[56:59], v[136:139], v[64:79]
    v_mfma_f32_32x32x16_bf16 v[80:95], v[56:59], v[200:203], v[80:95]
    ds_read_b128 v[52:55], v13 offset:128
    v_exp_f32 v97, v97
    v_fma_f32 v98, v98, s33, -v20
    v_exp_f32 v98, v98
    v_fma_f32 v99, v99, s33, -v20
    v_exp_f32 v99, v99
    v_fma_f32 v100, v100, s33, -v20
    v_exp_f32 v100, v100
    v_fma_f32 v101, v101, s33, -v20
    v_exp_f32 v101, v101
    v_fma_f32 v102, v102, s33, -v20
    s_waitcnt lgkmcnt(2)
    v_mfma_f32_32x32x16_bf16 v[64:79], v[60:63], v[140:143], v[64:79]
    v_mfma_f32_32x32x16_bf16 v[80:95], v[60:63], v[204:207], v[80:95]
    ds_read_b128 v[56:59], v14 offset:128
    v_exp_f32 v102, v102
    v_fma_f32 v103, v103, s33, -v20
    v_exp_f32 v103, v103
    v_fma_f32 v104, v104, s33, -v20
    v_exp_f32 v104, v104
    v_fma_f32 v105, v105, s33, -v20
    v_exp_f32 v105, v105
    v_fma_f32 v106, v106, s33, -v20
    v_exp_f32 v106, v106
    v_fma_f32 v107, v107, s33, -v20
    s_waitcnt lgkmcnt(2)
    v_mfma_f32_32x32x16_bf16 v[64:79], v[48:51], v[144:147], v[64:79]
    v_mfma_f32_32x32x16_bf16 v[80:95], v[48:51], v[208:211], v[80:95]
    ds_read_b128 v[60:63], v15 offset:128
    v_exp_f32 v107, v107
    v_fma_f32 v108, v108, s33, -v20
    v_exp_f32 v108, v108
    v_fma_f32 v109, v109, s33, -v20
    v_exp_f32 v109, v109
    v_fma_f32 v110, v110, s33, -v20
    v_exp_f32 v110, v110
    v_fma_f32 v111, v111, s33, -v20
    v_exp_f32 v111, v111
    v_add_f32 v22, v22, v96
    s_waitcnt lgkmcnt(2)
    v_mfma_f32_32x32x16_bf16 v[64:79], v[52:55], v[148:151], v[64:79]
    v_mfma_f32_32x32x16_bf16 v[80:95], v[52:55], v[212:215], v[80:95]
    ds_read_b128 v[48:51], v12 offset:256
    v_add_f32 v22, v22, v97
    v_add_f32 v22, v22, v98
    v_add_f32 v22, v22, v99
    v_add_f32 v22, v22, v100
    v_add_f32 v22, v22, v101
    v_add_f32 v22, v22, v102
    v_add_f32 v22, v22, v103
    v_add_f32 v22, v22, v104
    v_add_f32 v22, v22, v105
    v_add_f32 v22, v22, v106
    s_waitcnt lgkmcnt(2)
    v_mfma_f32_32x32x16_bf16 v[64:79], v[56:59], v[152:155], v[64:79]
    v_mfma_f32_32x32x16_bf16 v[80:95], v[56:59], v[216:219], v[80:95]
    ds_read_b128 v[52:55], v13 offset:256
    v_add_f32 v22, v22, v107
    v_add_f32 v22, v22, v108
    v_add_f32 v22, v22, v109
    v_add_f32 v22, v22, v110
    v_add_f32 v22, v22, v111
    v_cvt_pk_bf16_f32 v96, v96, v97
    v_cvt_pk_bf16_f32 v97, v98, v99
    v_cvt_pk_bf16_f32 v98, v100, v101
    v_cvt_pk_bf16_f32 v99, v102, v103
    v_cvt_pk_bf16_f32 v100, v104, v105
    s_waitcnt lgkmcnt(2)
    v_mfma_f32_32x32x16_bf16 v[64:79], v[60:63], v[156:159], v[64:79]
    v_mfma_f32_32x32x16_bf16 v[80:95], v[60:63], v[220:223], v[80:95]
    ds_read_b128 v[56:59], v14 offset:256
    v_cvt_pk_bf16_f32 v101, v106, v107
    v_cvt_pk_bf16_f32 v102, v108, v109
    v_cvt_pk_bf16_f32 v103, v110, v111
    v_max3_f32 v27, v112, v113, v114
    v_max3_f32 v27, v27, v115, v116
    v_max3_f32 v27, v27, v117, v118
    v_max3_f32 v27, v27, v119, v120
    v_max3_f32 v27, v27, v121, v122
    v_max3_f32 v27, v27, v123, v124
    v_max3_f32 v27, v27, v125, v126
    s_waitcnt lgkmcnt(2)
    v_mfma_f32_32x32x16_bf16 v[64:79], v[48:51], v[160:163], v[64:79]
    v_mfma_f32_32x32x16_bf16 v[80:95], v[48:51], v[224:227], v[80:95]
    ds_read_b128 v[60:63], v15 offset:256
    v_max_f32 v27, v27, v127
    v_mov_b32 v28, v27
    v_mov_b32 v29, v27
    s_nop 1
    v_permlane32_swap_b32 v28, v29
    v_max_f32 v27, v28, v29
    v_mul_f32 v27, s33, v27
    v_add_f32 v28, 0x41000000, v21
    v_cmp_gt_f32 vcc, v27, v28
    s_cbranch_vccz fused_kernel_rs3_1
    s_swappc_b64 s[44:45], s[48:49]
fused_kernel_rs3_1:
    s_waitcnt lgkmcnt(2)
    v_mfma_f32_32x32x16_bf16 v[64:79], v[52:55], v[164:167], v[64:79]
    v_mfma_f32_32x32x16_bf16 v[80:95], v[52:55], v[228:231], v[80:95]
    ds_read_b128 v[48:51], v12 offset:384
    v_fma_f32 v112, v112, s33, -v21
    v_exp_f32 v112, v112
    v_fma_f32 v113, v113, s33, -v21
    v_exp_f32 v113, v113
    v_fma_f32 v114, v114, s33, -v21
    v_exp_f32 v114, v114
    v_fma_f32 v115, v115, s33, -v21
    v_exp_f32 v115, v115
    v_fma_f32 v116, v116, s33, -v21
    v_exp_f32 v116, v116
    s_waitcnt lgkmcnt(2)
    v_mfma_f32_32x32x16_bf16 v[64:79], v[56:59], v[168:171], v[64:79]
    v_mfma_f32_32x32x16_bf16 v[80:95], v[56:59], v[232:235], v[80:95]
    ds_read_b128 v[52:55], v13 offset:384
    v_fma_f32 v117, v117, s33, -v21
    v_exp_f32 v117, v117
    v_fma_f32 v118, v118, s33, -v21
    v_exp_f32 v118, v118
    v_fma_f32 v119, v119, s33, -v21
    v_exp_f32 v119, v119
    v_fma_f32 v120, v120, s33, -v21
    v_exp_f32 v120, v120
    v_fma_f32 v121, v121, s33, -v21
    v_exp_f32 v121, v121
    s_waitcnt lgkmcnt(2)
    v_mfma_f32_32x32x16_bf16 v[64:79], v[60:63], v[172:175], v[64:79]
    v_mfma_f32_32x32x16_bf16 v[80:95], v[60:63], v[236:239], v[80:95]
    ds_read_b128 v[56:59], v14 offset:384
    v_fma_f32 v122, v122, s33, -v21
    v_exp_f32 v122, v122
    v_fma_f32 v123, v123, s33, -v21
    v_exp_f32 v123, v123
    v_fma_f32 v124, v124, s33, -v21
    v_exp_f32 v124, v124
    v_fma_f32 v125, v125, s33, -v21
    v_exp_f32 v125, v125
    v_fma_f32 v126, v126, s33, -v21
    v_exp_f32 v126, v126
    s_waitcnt lgkmcnt(2)
    v_mfma_f32_32x32x16_bf16 v[64:79], v[48:51], v[176:179], v[64:79]
    v_mfma_f32_32x32x16_bf16 v[80:95], v[48:51], v[240:243], v[80:95]
    ds_read_b128 v[60:63], v15 offset:384
    v_fma_f32 v127, v127, s33, -v21
    v_exp_f32 v127, v127
    v_add_f32 v23, v23, v112
    v_add_f32 v23, v23, v113
    v_add_f32 v23, v23, v114
    v_add_f32 v23, v23, v115
    v_add_f32 v23, v23, v116
    v_add_f32 v23, v23, v117
    v_add_f32 v23, v23, v118
    v_add_f32 v23, v23, v119
    s_waitcnt lgkmcnt(2)
    v_mfma_f32_32x32x16_bf16 v[64:79], v[52:55], v[180:183], v[64:79]
    v_mfma_f32_32x32x16_bf16 v[80:95], v[52:55], v[244:247], v[80:95]
    v_add_f32 v23, v23, v120
    v_add_f32 v23, v23, v121
    v_add_f32 v23, v23, v122
    v_add_f32 v23, v23, v123
    v_add_f32 v23, v23, v124
    v_add_f32 v23, v23, v125
    v_add_f32 v23, v23, v126
    v_add_f32 v23, v23, v127
    v_cvt_pk_bf16_f32 v112, v112, v113
    v_cvt_pk_bf16_f32 v113, v114, v115
    s_waitcnt lgkmcnt(1)
    v_mfma_f32_32x32x16_bf16 v[64:79], v[56:59], v[184:187], v[64:79]
    v_mfma_f32_32x32x16_bf16 v[80:95], v[56:59], v[248:251], v[80:95]
    v_cvt_pk_bf16_f32 v114, v116, v117
    v_cvt_pk_bf16_f32 v115, v118, v119
    v_cvt_pk_bf16_f32 v116, v120, v121
    v_cvt_pk_bf16_f32 v117, v122, v123
    v_cvt_pk_bf16_f32 v118, v124, v125
    v_cvt_pk_bf16_f32 v119, v126, v127
    s_waitcnt lgkmcnt(0)
    v_mfma_f32_32x32x16_bf16 v[64:79], v[60:63], v[188:191], v[64:79]
    v_mfma_f32_32x32x16_bf16 v[80:95], v[60:63], v[252:255], v[80:95]
    s_add_u32 m0, s31, 32768
    s_add_u32 s34, s30, 90112
    buffer_load_dwordx4 v2, s[12:15], s34 offen offset:0 lds
    buffer_load_dwordx4 v3, s[12:15], s34 offen offset:1024 lds
    buffer_load_dwordx4 v4, s[12:15], s34 offen offset:2048 lds
    buffer_load_dwordx4 v5, s[12:15], s34 offen offset:3072 lds
    s_add_u32 m0, s31, 36864
    s_add_u32 s34, s30, 94208
    buffer_load_dwordx4 v2, s[12:15], s34 offen offset:0 lds
    buffer_load_dwordx4 v3, s[12:15], s34 offen offset:1024 lds
    buffer_load_dwordx4 v4, s[12:15], s34 offen offset:2048 lds
    buffer_load_dwordx4 v5, s[12:15], s34 offen offset:3072 lds
    s_add_u32 m0, s31, 0
    s_add_u32 s34, s30, 65536
    buffer_load_dwordx4 v6, s[16:19], s34 offen offset:0 lds
    buffer_load_dwordx4 v7, s[16:19], s34 offen offset:1024 lds
    buffer_load_dwordx4 v6, s[16:19], s34 offen offset:2048 lds
    buffer_load_dwordx4 v7, s[16:19], s34 offen offset:3072 lds
    s_add_u32 m0, s31, 4096
    s_add_u32 s34, s30, 69632
    buffer_load_dwordx4 v6, s[16:19], s34 offen offset:0 lds
    buffer_load_dwordx4 v7, s[16:19], s34 offen offset:1024 lds
    buffer_load_dwordx4 v6, s[16:19], s34 offen offset:2048 lds
    buffer_load_dwordx4 v7, s[16:19], s34 offen offset:3072 lds
    s_nop 1
    s_waitcnt vmcnt(32)
    ds_read_b64_tr_b16 v[32:33], v16 offset:8192
    ds_read_b64_tr_b16 v[34:35], v16 offset:12288
    ds_read_b64_tr_b16 v[36:37], v17 offset:8192
    ds_read_b64_tr_b16 v[38:39], v17 offset:12288
    ds_read_b64_tr_b16 v[40:41], v18 offset:8192
    ds_read_b64_tr_b16 v[42:43], v18 offset:12288
    s_waitcnt lgkmcnt(4)
    v_mfma_f32_32x32x16_bf16 a[0:15], v[32:35], v[96:99], a[0:15]
    v_mfma_f32_32x32x16_bf16 a[128:143], v[32:35], v[112:115], a[128:143]
    ds_read_b64_tr_b16 v[44:45], v19 offset:8192
    ds_read_b64_tr_b16 v[46:47], v19 offset:12288
    s_waitcnt lgkmcnt(4)
    v_mfma_f32_32x32x16_bf16 a[16:31], v[36:39], v[96:99], a[16:31]
    v_mfma_f32_32x32x16_bf16 a[144:159], v[36:39], v[112:115], a[144:159]
    ds_read_b64_tr_b16 v[32:33], v16 offset:8448
    ds_read_b64_tr_b16 v[34:35], v16 offset:12544
    s_waitcnt lgkmcnt(4)
    v_mfma_f32_32x32x16_bf16 a[32:47], v[40:43], v[96:99], a[32:47]
    v_mfma_f32_32x32x16_bf16 a[160:175], v[40:43], v[112:115], a[160:175]
    ds_read_b64_tr_b16 v[36:37], v17 offset:8448
    ds_read_b64_tr_b16 v[38:39], v17 offset:12544
    s_waitcnt lgkmcnt(4)
    v_mfma_f32_32x32x16_bf16 a[48:63], v[44:47], v[96:99], a[48:63]
    v_mfma_f32_32x32x16_bf16 a[176:191], v[44:47], v[112:115], a[176:191]
    ds_read_b64_tr_b16 v[40:41], v18 offset:8448
    ds_read_b64_tr_b16 v[42:43], v18 offset:12544
    s_waitcnt lgkmcnt(4)
    v_mfma_f32_32x32x16_bf16 a[64:79], v[32:35], v[96:99], a[64:79]
    v_mfma_f32_32x32x16_bf16 a[192:207], v[32:35], v[112:115], a[192:207]
    ds_read_b64_tr_b16 v[44:45], v19 offset:8448
    ds_read_b64_tr_b16 v[46:47], v19 offset:12544
    s_waitcnt lgkmcnt(4)
    v_mfma_f32_32x32x16_bf16 a[80:95], v[36:39], v[96:99], a[80:95]
    v_mfma_f32_32x32x16_bf16 a[208:223], v[36:39], v[112:115], a[208:223]
    s_waitcnt vmcnt(24)
    ds_read_b64_tr_b16 v[32:33], v16 offset:16384
    ds_read_b64_tr_b16 v[34:35], v16 offset:20480
    s_waitcnt lgkmcnt(4)
    v_mfma_f32_32x32x16_bf16 a[96:111], v[40:43], v[96:99], a[96:111]
    v_mfma_f32_32x32x16_bf16 a[224:239], v[40:43], v[112:115], a[224:239]
    ds_read_b64_tr_b16 v[36:37], v17 offset:16384
    ds_read_b64_tr_b16 v[38:39], v17 offset:20480
    s_waitcnt lgkmcnt(4)
    v_mfma_f32_32x32x16_bf16 a[112:127], v[44:47], v[96:99], a[112:127]
    v_mfma_f32_32x32x16_bf16 a[240:255], v[44:47], v[112:115], a[240:255]
    ds_read_b64_tr_b16 v[40:41], v18 offset:16384
    ds_read_b64_tr_b16 v[42:43], v18 offset:20480
    s_waitcnt lgkmcnt(4)
    v_mfma_f32_32x32x16_bf16 a[0:15], v[32:35], v[100:103], a[0:15]
    v_mfma_f32_32x32x16_bf16 a[128:143], v[32:35], v[116:119], a[128:143]
    ds_read_b64_tr_b16 v[44:45], v19 offset:16384
    ds_read_b64_tr_b16 v[46:47], v19 offset:20480
    s_add_u32 m0, s31, 8192
    s_add_u32 s34, s30, 73728
    buffer_load_dwordx4 v6, s[16:19], s34 offen offset:0 lds
    buffer_load_dwordx4 v7, s[16:19], s34 offen offset:1024 lds
    buffer_load_dwordx4 v6, s[16:19], s34 offen offset:2048 lds
    buffer_load_dwordx4 v7, s[16:19], s34 offen offset:3072 lds
    s_add_u32 m0, s31, 12288
    s_add_u32 s34, s30, 77824
    buffer_load_dwordx4 v6, s[16:19], s34 offen offset:0 lds
    buffer_load_dwordx4 v7, s[16:19], s34 offen offset:1024 lds
    buffer_load_dwordx4 v6, s[16:19], s34 offen offset:2048 lds
    buffer_load_dwordx4 v7, s[16:19], s34 offen offset:3072 lds
    s_waitcnt lgkmcnt(4)
    v_mfma_f32_32x32x16_bf16 a[16:31], v[36:39], v[100:103], a[16:31]
    v_mfma_f32_32x32x16_bf16 a[144:159], v[36:39], v[116:119], a[144:159]
    ds_read_b64_tr_b16 v[32:33], v16 offset:16640
    ds_read_b64_tr_b16 v[34:35], v16 offset:20736
    s_waitcnt lgkmcnt(4)
    v_mfma_f32_32x32x16_bf16 a[32:47], v[40:43], v[100:103], a[32:47]
    v_mfma_f32_32x32x16_bf16 a[160:175], v[40:43], v[116:119], a[160:175]
    ds_read_b64_tr_b16 v[36:37], v17 offset:16640
    ds_read_b64_tr_b16 v[38:39], v17 offset:20736
    s_waitcnt lgkmcnt(4)
    v_mfma_f32_32x32x16_bf16 a[48:63], v[44:47], v[100:103], a[48:63]
    v_mfma_f32_32x32x16_bf16 a[176:191], v[44:47], v[116:119], a[176:191]
    ds_read_b64_tr_b16 v[40:41], v18 offset:16640
    ds_read_b64_tr_b16 v[42:43], v18 offset:20736
    s_waitcnt lgkmcnt(4)
    v_mfma_f32_32x32x16_bf16 a[64:79], v[32:35], v[100:103], a[64:79]
    v_mfma_f32_32x32x16_bf16 a[192:207], v[32:35], v[116:119], a[192:207]
    ds_read_b64_tr_b16 v[44:45], v19 offset:16640
    ds_read_b64_tr_b16 v[46:47], v19 offset:20736
    s_waitcnt lgkmcnt(4)
    v_mfma_f32_32x32x16_bf16 a[80:95], v[36:39], v[100:103], a[80:95]
    v_mfma_f32_32x32x16_bf16 a[208:223], v[36:39], v[116:119], a[208:223]
    s_waitcnt lgkmcnt(2)
    v_mfma_f32_32x32x16_bf16 a[96:111], v[40:43], v[100:103], a[96:111]
    v_mfma_f32_32x32x16_bf16 a[224:239], v[40:43], v[116:119], a[224:239]
    s_waitcnt lgkmcnt(0)
    v_mfma_f32_32x32x16_bf16 a[112:127], v[44:47], v[100:103], a[112:127]
    v_mfma_f32_32x32x16_bf16 a[240:255], v[44:47], v[116:119], a[240:255]
    s_add_u32 m0, s31, 16384
    s_add_u32 s34, s30, 98304
    buffer_load_dwordx4 v2, s[12:15], s34 offen offset:0 lds
    buffer_load_dwordx4 v3, s[12:15], s34 offen offset:1024 lds
    buffer_load_dwordx4 v4, s[12:15], s34 offen offset:2048 lds
    buffer_load_dwordx4 v5, s[12:15], s34 offen offset:3072 lds
    s_add_u32 m0, s31, 20480
    s_add_u32 s34, s30, 102400
    buffer_load_dwordx4 v2, s[12:15], s34 offen offset:0 lds
    buffer_load_dwordx4 v3, s[12:15], s34 offen offset:1024 lds
    buffer_load_dwordx4 v4, s[12:15], s34 offen offset:2048 lds
    buffer_load_dwordx4 v5, s[12:15], s34 offen offset:3072 lds
    s_waitcnt vmcnt(24)
    ds_read_b128 v[48:51], v8 offset:24576
    ds_read_b128 v[52:55], v9 offset:24576
    ds_read_b128 v[56:59], v10 offset:24576
    s_waitcnt lgkmcnt(2)
    v_mfma_f32_32x32x16_bf16 v[96:111], v[48:51], v[128:131], 0
    v_mfma_f32_32x32x16_bf16 v[112:127], v[48:51], v[192:195], 0
    ds_read_b128 v[60:63], v11 offset:24576
    v_max3_f32 v24, v64, v65, v66
    v_max3_f32 v24, v24, v67, v68
    v_max3_f32 v24, v24, v69, v70
    v_max3_f32 v24, v24, v71, v72
    v_max3_f32 v24, v24, v73, v74
    v_max3_f32 v24, v24, v75, v76
    v_max3_f32 v24, v24, v77, v78
    v_max_f32 v24, v24, v79
    v_mov_b32 v25, v24
    v_mov_b32 v26, v24
    s_waitcnt lgkmcnt(2)
    v_mfma_f32_32x32x16_bf16 v[96:111], v[52:55], v[132:135], v[96:111]
    v_mfma_f32_32x32x16_bf16 v[112:127], v[52:55], v[196:199], v[112:127]
    ds_read_b128 v[48:51], v8 offset:24704
    s_nop 1
    v_permlane32_swap_b32 v25, v26
    v_max_f32 v24, v25, v26
    v_mul_f32 v24, s33, v24
    v_add_f32 v25, 0x41000000, v20
    v_cmp_gt_f32 vcc, v24, v25
    s_cbranch_vccz fused_kernel_rs4_0
    s_swappc_b64 s[44:45], s[46:47]
fused_kernel_rs4_0:
    v_fma_f32 v64, v64, s33, -v20
    v_exp_f32 v64, v64
    v_fma_f32 v65, v65, s33, -v20
    s_waitcnt lgkmcnt(2)
    v_mfma_f32_32x32x16_bf16 v[96:111], v[56:59], v[136:139], v[96:111]
    v_mfma_f32_32x32x16_bf16 v[112:127], v[56:59], v[200:203], v[112:127]
    ds_read_b128 v[52:55], v9 offset:24704
    v_exp_f32 v65, v65
    v_fma_f32 v66, v66, s33, -v20
    v_exp_f32 v66, v66
    v_fma_f32 v67, v67, s33, -v20
    v_exp_f32 v67, v67
    v_fma_f32 v68, v68, s33, -v20
    v_exp_f32 v68, v68
    v_fma_f32 v69, v69, s33, -v20
    v_exp_f32 v69, v69
    v_fma_f32 v70, v70, s33, -v20
    s_waitcnt lgkmcnt(2)
    v_mfma_f32_32x32x16_bf16 v[96:111], v[60:63], v[140:143], v[96:111]
    v_mfma_f32_32x32x16_bf16 v[112:127], v[60:63], v[204:207], v[112:127]
    ds_read_b128 v[56:59], v10 offset:24704
    v_exp_f32 v70, v70
    v_fma_f32 v71, v71, s33, -v20
    v_exp_f32 v71, v71
    v_fma_f32 v72, v72, s33, -v20
    v_exp_f32 v72, v72
    v_fma_f32 v73, v73, s33, -v20
    v_exp_f32 v73, v73
    v_fma_f32 v74, v74, s33, -v20
    v_exp_f32 v74, v74
    v_fma_f32 v75, v75, s33, -v20
    s_waitcnt lgkmcnt(2)
    v_mfma_f32_32x32x16_bf16 v[96:111], v[48:51], v[144:147], v[96:111]
    v_mfma_f32_32x32x16_bf16 v[112:127], v[48:51], v[208:211], v[112:127]
    ds_read_b128 v[60:63], v11 offset:24704
    v_exp_f32 v75, v75
    v_fma_f32 v76, v76, s33, -v20
    v_exp_f32 v76, v76
    v_fma_f32 v77, v77, s33, -v20
    v_exp_f32 v77, v77
    v_fma_f32 v78, v78, s33, -v20
    v_exp_f32 v78, v78
    v_fma_f32 v79, v79, s33, -v20
    v_exp_f32 v79, v79
    v_add_f32 v22, v22, v64
    s_waitcnt lgkmcnt(2)
    v_mfma_f32_32x32x16_bf16 v[96:111], v[52:55], v[148:151], v[96:111]
    v_mfma_f32_32x32x16_bf16 v[112:127], v[52:55], v[212:215], v[112:127]
    ds_read_b128 v[48:51], v8 offset:24832
    v_add_f32 v22, v22, v65
    v_add_f32 v22, v22, v66
    v_add_f32 v22, v22, v67
    v_add_f32 v22, v22, v68
    v_add_f32 v22, v22, v69
    v_add_f32 v22, v22, v70
    v_add_f32 v22, v22, v71
    v_add_f32 v22, v22, v72
    v_add_f32 v22, v22, v73
    v_add_f32 v22, v22, v74
    s_waitcnt lgkmcnt(2)
    v_mfma_f32_32x32x16_bf16 v[96:111], v[56:59], v[152:155], v[96:111]
    v_mfma_f32_32x32x16_bf16 v[112:127], v[56:59], v[216:219], v[112:127]
    ds_read_b128 v[52:55], v9 offset:24832
    v_add_f32 v22, v22, v75
    v_add_f32 v22, v22, v76
    v_add_f32 v22, v22, v77
    v_add_f32 v22, v22, v78
    v_add_f32 v22, v22, v79
    v_cvt_pk_bf16_f32 v64, v64, v65
    v_cvt_pk_bf16_f32 v65, v66, v67
    v_cvt_pk_bf16_f32 v66, v68, v69
    v_cvt_pk_bf16_f32 v67, v70, v71
    v_cvt_pk_bf16_f32 v68, v72, v73
    s_waitcnt lgkmcnt(2)
    v_mfma_f32_32x32x16_bf16 v[96:111], v[60:63], v[156:159], v[96:111]
    v_mfma_f32_32x32x16_bf16 v[112:127], v[60:63], v[220:223], v[112:127]
    ds_read_b128 v[56:59], v10 offset:24832
    v_cvt_pk_bf16_f32 v69, v74, v75
    v_cvt_pk_bf16_f32 v70, v76, v77
    v_cvt_pk_bf16_f32 v71, v78, v79
    v_max3_f32 v27, v80, v81, v82
    v_max3_f32 v27, v27, v83, v84
    v_max3_f32 v27, v27, v85, v86
    v_max3_f32 v27, v27, v87, v88
    v_max3_f32 v27, v27, v89, v90
    v_max3_f32 v27, v27, v91, v92
    v_max3_f32 v27, v27, v93, v94
    s_waitcnt lgkmcnt(2)
    v_mfma_f32_32x32x16_bf16 v[96:111], v[48:51], v[160:163], v[96:111]
    v_mfma_f32_32x32x16_bf16 v[112:127], v[48:51], v[224:227], v[112:127]
    ds_read_b128 v[60:63], v11 offset:24832
    v_max_f32 v27, v27, v95
    v_mov_b32 v28, v27
    v_mov_b32 v29, v27
    s_nop 1
    v_permlane32_swap_b32 v28, v29
    v_max_f32 v27, v28, v29
    v_mul_f32 v27, s33, v27
    v_add_f32 v28, 0x41000000, v21
    v_cmp_gt_f32 vcc, v27, v28
    s_cbranch_vccz fused_kernel_rs4_1
    s_swappc_b64 s[44:45], s[48:49]
fused_kernel_rs4_1:
    s_waitcnt lgkmcnt(2)
    v_mfma_f32_32x32x16_bf16 v[96:111], v[52:55], v[164:167], v[96:111]
    v_mfma_f32_32x32x16_bf16 v[112:127], v[52:55], v[228:231], v[112:127]
    ds_read_b128 v[48:51], v8 offset:24960
    v_fma_f32 v80, v80, s33, -v21
    v_exp_f32 v80, v80
    v_fma_f32 v81, v81, s33, -v21
    v_exp_f32 v81, v81
    v_fma_f32 v82, v82, s33, -v21
    v_exp_f32 v82, v82
    v_fma_f32 v83, v83, s33, -v21
    v_exp_f32 v83, v83
    v_fma_f32 v84, v84, s33, -v21
    v_exp_f32 v84, v84
    s_waitcnt lgkmcnt(2)
    v_mfma_f32_32x32x16_bf16 v[96:111], v[56:59], v[168:171], v[96:111]
    v_mfma_f32_32x32x16_bf16 v[112:127], v[56:59], v[232:235], v[112:127]
    ds_read_b128 v[52:55], v9 offset:24960
    v_fma_f32 v85, v85, s33, -v21
    v_exp_f32 v85, v85
    v_fma_f32 v86, v86, s33, -v21
    v_exp_f32 v86, v86
    v_fma_f32 v87, v87, s33, -v21
    v_exp_f32 v87, v87
    v_fma_f32 v88, v88, s33, -v21
    v_exp_f32 v88, v88
    v_fma_f32 v89, v89, s33, -v21
    v_exp_f32 v89, v89
    s_waitcnt lgkmcnt(2)
    v_mfma_f32_32x32x16_bf16 v[96:111], v[60:63], v[172:175], v[96:111]
    v_mfma_f32_32x32x16_bf16 v[112:127], v[60:63], v[236:239], v[112:127]
    ds_read_b128 v[56:59], v10 offset:24960
    v_fma_f32 v90, v90, s33, -v21
    v_exp_f32 v90, v90
    v_fma_f32 v91, v91, s33, -v21
    v_exp_f32 v91, v91
    v_fma_f32 v92, v92, s33, -v21
    v_exp_f32 v92, v92
    v_fma_f32 v93, v93, s33, -v21
    v_exp_f32 v93, v93
    v_fma_f32 v94, v94, s33, -v21
    v_exp_f32 v94, v94
    s_waitcnt lgkmcnt(2)
    v_mfma_f32_32x32x16_bf16 v[96:111], v[48:51], v[176:179], v[96:111]
    v_mfma_f32_32x32x16_bf16 v[112:127], v[48:51], v[240:243], v[112:127]
    ds_read_b128 v[60:63], v11 offset:24960
    v_fma_f32 v95, v95, s33, -v21
    v_exp_f32 v95, v95
    v_add_f32 v23, v23, v80
    v_add_f32 v23, v23, v81
    v_add_f32 v23, v23, v82
    v_add_f32 v23, v23, v83
    v_add_f32 v23, v23, v84
    v_add_f32 v23, v23, v85
    v_add_f32 v23, v23, v86
    v_add_f32 v23, v23, v87
    s_waitcnt lgkmcnt(2)
    v_mfma_f32_32x32x16_bf16 v[96:111], v[52:55], v[180:183], v[96:111]
    v_mfma_f32_32x32x16_bf16 v[112:127], v[52:55], v[244:247], v[112:127]
    v_add_f32 v23, v23, v88
    v_add_f32 v23, v23, v89
    v_add_f32 v23, v23, v90
    v_add_f32 v23, v23, v91
    v_add_f32 v23, v23, v92
    v_add_f32 v23, v23, v93
    v_add_f32 v23, v23, v94
    v_add_f32 v23, v23, v95
    v_cvt_pk_bf16_f32 v80, v80, v81
    v_cvt_pk_bf16_f32 v81, v82, v83
    s_waitcnt lgkmcnt(1)
    v_mfma_f32_32x32x16_bf16 v[96:111], v[56:59], v[184:187], v[96:111]
    v_mfma_f32_32x32x16_bf16 v[112:127], v[56:59], v[248:251], v[112:127]
    v_cvt_pk_bf16_f32 v82, v84, v85
    v_cvt_pk_bf16_f32 v83, v86, v87
    v_cvt_pk_bf16_f32 v84, v88, v89
    v_cvt_pk_bf16_f32 v85, v90, v91
    v_cvt_pk_bf16_f32 v86, v92, v93
    v_cvt_pk_bf16_f32 v87, v94, v95
    s_waitcnt lgkmcnt(0)
    v_mfma_f32_32x32x16_bf16 v[96:111], v[60:63], v[188:191], v[96:111]
    v_mfma_f32_32x32x16_bf16 v[112:127], v[60:63], v[252:255], v[112:127]
    s_add_u32 m0, s31, 24576
    s_add_u32 s34, s30, 106496
    buffer_load_dwordx4 v2, s[12:15], s34 offen offset:0 lds
    buffer_load_dwordx4 v3, s[12:15], s34 offen offset:1024 lds
    buffer_load_dwordx4 v4, s[12:15], s34 offen offset:2048 lds
    buffer_load_dwordx4 v5, s[12:15], s34 offen offset:3072 lds
    s_add_u32 m0, s31, 28672
    s_add_u32 s34, s30, 110592
    buffer_load_dwordx4 v2, s[12:15], s34 offen offset:0 lds
    buffer_load_dwordx4 v3, s[12:15], s34 offen offset:1024 lds
    buffer_load_dwordx4 v4, s[12:15], s34 offen offset:2048 lds
    buffer_load_dwordx4 v5, s[12:15], s34 offen offset:3072 lds
    s_add_u32 m0, s31, 32768
    s_add_u32 s34, s30, 81920
    buffer_load_dwordx4 v6, s[16:19], s34 offen offset:0 lds
    buffer_load_dwordx4 v7, s[16:19], s34 offen offset:1024 lds
    buffer_load_dwordx4 v6, s[16:19], s34 offen offset:2048 lds
    buffer_load_dwordx4 v7, s[16:19], s34 offen offset:3072 lds
    s_add_u32 m0, s31, 36864
    s_add_u32 s34, s30, 86016
    buffer_load_dwordx4 v6, s[16:19], s34 offen offset:0 lds
    buffer_load_dwordx4 v7, s[16:19], s34 offen offset:1024 lds
    buffer_load_dwordx4 v6, s[16:19], s34 offen offset:2048 lds
    buffer_load_dwordx4 v7, s[16:19], s34 offen offset:3072 lds
    s_nop 1
    s_waitcnt vmcnt(32)
    ds_read_b64_tr_b16 v[32:33], v16 offset:0
    ds_read_b64_tr_b16 v[34:35], v16 offset:4096
    ds_read_b64_tr_b16 v[36:37], v17 offset:0
    ds_read_b64_tr_b16 v[38:39], v17 offset:4096
    ds_read_b64_tr_b16 v[40:41], v18 offset:0
    ds_read_b64_tr_b16 v[42:43], v18 offset:4096
    s_waitcnt lgkmcnt(4)
    v_mfma_f32_32x32x16_bf16 a[0:15], v[32:35], v[64:67], a[0:15]
    v_mfma_f32_32x32x16_bf16 a[128:143], v[32:35], v[80:83], a[128:143]
    ds_read_b64_tr_b16 v[44:45], v19 offset:0
    ds_read_b64_tr_b16 v[46:47], v19 offset:4096
    s_waitcnt lgkmcnt(4)
    v_mfma_f32_32x32x16_bf16 a[16:31], v[36:39], v[64:67], a[16:31]
    v_mfma_f32_32x32x16_bf16 a[144:159], v[36:39], v[80:83], a[144:159]
    ds_read_b64_tr_b16 v[32:33], v16 offset:256
    ds_read_b64_tr_b16 v[34:35], v16 offset:4352
    s_waitcnt lgkmcnt(4)
    v_mfma_f32_32x32x16_bf16 a[32:47], v[40:43], v[64:67], a[32:47]
    v_mfma_f32_32x32x16_bf16 a[160:175], v[40:43], v[80:83], a[160:175]
    ds_read_b64_tr_b16 v[36:37], v17 offset:256
    ds_read_b64_tr_b16 v[38:39], v17 offset:4352
    s_waitcnt lgkmcnt(4)
    v_mfma_f32_32x32x16_bf16 a[48:63], v[44:47], v[64:67], a[48:63]
    v_mfma_f32_32x32x16_bf16 a[176:191], v[44:47], v[80:83], a[176:191]
    ds_read_b64_tr_b16 v[40:41], v18 offset:256
    ds_read_b64_tr_b16 v[42:43], v18 offset:4352
    s_waitcnt lgkmcnt(4)
    v_mfma_f32_32x32x16_bf16 a[64:79], v[32:35], v[64:67], a[64:79]
    v_mfma_f32_32x32x16_bf16 a[192:207], v[32:35], v[80:83], a[192:207]
    ds_read_b64_tr_b16 v[44:45], v19 offset:256
    ds_read_b64_tr_b16 v[46:47], v19 offset:4352
    s_waitcnt lgkmcnt(4)
    v_mfma_f32_32x32x16_bf16 a[80:95], v[36:39], v[64:67], a[80:95]
    v_mfma_f32_32x32x16_bf16 a[208:223], v[36:39], v[80:83], a[208:223]
    s_waitcnt vmcnt(24)
    ds_read_b64_tr_b16 v[32:33], v16 offset:8192
    ds_read_b64_tr_b16 v[34:35], v16 offset:12288
    s_waitcnt lgkmcnt(4)
    v_mfma_f32_32x32x16_bf16 a[96:111], v[40:43], v[64:67], a[96:111]
    v_mfma_f32_32x32x16_bf16 a[224:239], v[40:43], v[80:83], a[224:239]
    ds_read_b64_tr_b16 v[36:37], v17 offset:8192
    ds_read_b64_tr_b16 v[38:39], v17 offset:12288
    s_waitcnt lgkmcnt(4)
    v_mfma_f32_32x32x16_bf16 a[112:127], v[44:47], v[64:67], a[112:127]
    v_mfma_f32_32x32x16_bf16 a[240:255], v[44:47], v[80:83], a[240:255]
    ds_read_b64_tr_b16 v[40:41], v18 offset:8192
    ds_read_b64_tr_b16 v[42:43], v18 offset:12288
    s_waitcnt lgkmcnt(4)
    v_mfma_f32_32x32x16_bf16 a[0:15], v[32:35], v[68:71], a[0:15]
    v_mfma_f32_32x32x16_bf16 a[128:143], v[32:35], v[84:87], a[128:143]
    ds_read_b64_tr_b16 v[44:45], v19 offset:8192
    ds_read_b64_tr_b16 v[46:47], v19 offset:12288
    s_add_u32 m0, s31, 0
    s_add_u32 s34, s30, 90112
    buffer_load_dwordx4 v6, s[16:19], s34 offen offset:0 lds
    buffer_load_dwordx4 v7, s[16:19], s34 offen offset:1024 lds
    buffer_load_dwordx4 v6, s[16:19], s34 offen offset:2048 lds
    buffer_load_dwordx4 v7, s[16:19], s34 offen offset:3072 lds
    s_add_u32 m0, s31, 4096
    s_add_u32 s34, s30, 94208
    buffer_load_dwordx4 v6, s[16:19], s34 offen offset:0 lds
    buffer_load_dwordx4 v7, s[16:19], s34 offen offset:1024 lds
    buffer_load_dwordx4 v6, s[16:19], s34 offen offset:2048 lds
    buffer_load_dwordx4 v7, s[16:19], s34 offen offset:3072 lds
    s_waitcnt lgkmcnt(4)
    v_mfma_f32_32x32x16_bf16 a[16:31], v[36:39], v[68:71], a[16:31]
    v_mfma_f32_32x32x16_bf16 a[144:159], v[36:39], v[84:87], a[144:159]
    ds_read_b64_tr_b16 v[32:33], v16 offset:8448
    ds_read_b64_tr_b16 v[34:35], v16 offset:12544
    s_waitcnt lgkmcnt(4)
    v_mfma_f32_32x32x16_bf16 a[32:47], v[40:43], v[68:71], a[32:47]
    v_mfma_f32_32x32x16_bf16 a[160:175], v[40:43], v[84:87], a[160:175]
    ds_read_b64_tr_b16 v[36:37], v17 offset:8448
    ds_read_b64_tr_b16 v[38:39], v17 offset:12544
    s_waitcnt lgkmcnt(4)
    v_mfma_f32_32x32x16_bf16 a[48:63], v[44:47], v[68:71], a[48:63]
    v_mfma_f32_32x32x16_bf16 a[176:191], v[44:47], v[84:87], a[176:191]
    ds_read_b64_tr_b16 v[40:41], v18 offset:8448
    ds_read_b64_tr_b16 v[42:43], v18 offset:12544
    s_waitcnt lgkmcnt(4)
    v_mfma_f32_32x32x16_bf16 a[64:79], v[32:35], v[68:71], a[64:79]
    v_mfma_f32_32x32x16_bf16 a[192:207], v[32:35], v[84:87], a[192:207]
    ds_read_b64_tr_b16 v[44:45], v19 offset:8448
    ds_read_b64_tr_b16 v[46:47], v19 offset:12544
    s_waitcnt lgkmcnt(4)
    v_mfma_f32_32x32x16_bf16 a[80:95], v[36:39], v[68:71], a[80:95]
    v_mfma_f32_32x32x16_bf16 a[208:223], v[36:39], v[84:87], a[208:223]
    s_waitcnt lgkmcnt(2)
    v_mfma_f32_32x32x16_bf16 a[96:111], v[40:43], v[68:71], a[96:111]
    v_mfma_f32_32x32x16_bf16 a[224:239], v[40:43], v[84:87], a[224:239]
    s_waitcnt lgkmcnt(0)
    v_mfma_f32_32x32x16_bf16 a[112:127], v[44:47], v[68:71], a[112:127]
    v_mfma_f32_32x32x16_bf16 a[240:255], v[44:47], v[84:87], a[240:255]
    s_add_u32 m0, s31, 8192
    s_add_u32 s34, s30, 114688
    buffer_load_dwordx4 v2, s[12:15], s34 offen offset:0 lds
    buffer_load_dwordx4 v3, s[12:15], s34 offen offset:1024 lds
    buffer_load_dwordx4 v4, s[12:15], s34 offen offset:2048 lds
    buffer_load_dwordx4 v5, s[12:15], s34 offen offset:3072 lds
    s_add_u32 m0, s31, 12288
    s_add_u32 s34, s30, 118784
    buffer_load_dwordx4 v2, s[12:15], s34 offen offset:0 lds
    buffer_load_dwordx4 v3, s[12:15], s34 offen offset:1024 lds
    buffer_load_dwordx4 v4, s[12:15], s34 offen offset:2048 lds
    buffer_load_dwordx4 v5, s[12:15], s34 offen offset:3072 lds
    s_waitcnt vmcnt(24)
    ds_read_b128 v[48:51], v8 offset:16384
    ds_read_b128 v[52:55], v9 offset:16384
    ds_read_b128 v[56:59], v10 offset:16384
    s_waitcnt lgkmcnt(2)
    v_mfma_f32_32x32x16_bf16 v[64:79], v[48:51], v[128:131], 0
    v_mfma_f32_32x32x16_bf16 v[80:95], v[48:51], v[192:195], 0
    ds_read_b128 v[60:63], v11 offset:16384
    v_max3_f32 v24, v96, v97, v98
    v_max3_f32 v24, v24, v99, v100
    v_max3_f32 v24, v24, v101, v102
    v_max3_f32 v24, v24, v103, v104
    v_max3_f32 v24, v24, v105, v106
    v_max3_f32 v24, v24, v107, v108
    v_max3_f32 v24, v24, v109, v110
    v_max_f32 v24, v24, v111
    v_mov_b32 v25, v24
    v_mov_b32 v26, v24
    s_waitcnt lgkmcnt(2)
    v_mfma_f32_32x32x16_bf16 v[64:79], v[52:55], v[132:135], v[64:79]
    v_mfma_f32_32x32x16_bf16 v[80:95], v[52:55], v[196:199], v[80:95]
    ds_read_b128 v[48:51], v8 offset:16512
    s_nop 1
    v_permlane32_swap_b32 v25, v26
    v_max_f32 v24, v25, v26
    v_mul_f32 v24, s33, v24
    v_add_f32 v25, 0x41000000, v20
    v_cmp_gt_f32 vcc, v24, v25
    s_cbranch_vccz fused_kernel_rs5_0
    s_swappc_b64 s[44:45], s[46:47]
fused_kernel_rs5_0:
    v_fma_f32 v96, v96, s33, -v20
    v_exp_f32 v96, v96
    v_fma_f32 v97, v97, s33, -v20
    s_waitcnt lgkmcnt(2)
    v_mfma_f32_32x32x16_bf16 v[64:79], v[56:59], v[136:139], v[64:79]
    v_mfma_f32_32x32x16_bf16 v[80:95], v[56:59], v[200:203], v[80:95]
    ds_read_b128 v[52:55], v9 offset:16512
    v_exp_f32 v97, v97
    v_fma_f32 v98, v98, s33, -v20
    v_exp_f32 v98, v98
    v_fma_f32 v99, v99, s33, -v20
    v_exp_f32 v99, v99
    v_fma_f32 v100, v100, s33, -v20
    v_exp_f32 v100, v100
    v_fma_f32 v101, v101, s33, -v20
    v_exp_f32 v101, v101
    v_fma_f32 v102, v102, s33, -v20
    s_waitcnt lgkmcnt(2)
    v_mfma_f32_32x32x16_bf16 v[64:79], v[60:63], v[140:143], v[64:79]
    v_mfma_f32_32x32x16_bf16 v[80:95], v[60:63], v[204:207], v[80:95]
    ds_read_b128 v[56:59], v10 offset:16512
    v_exp_f32 v102, v102
    v_fma_f32 v103, v103, s33, -v20
    v_exp_f32 v103, v103
    v_fma_f32 v104, v104, s33, -v20
    v_exp_f32 v104, v104
    v_fma_f32 v105, v105, s33, -v20
    v_exp_f32 v105, v105
    v_fma_f32 v106, v106, s33, -v20
    v_exp_f32 v106, v106
    v_fma_f32 v107, v107, s33, -v20
    s_waitcnt lgkmcnt(2)
    v_mfma_f32_32x32x16_bf16 v[64:79], v[48:51], v[144:147], v[64:79]
    v_mfma_f32_32x32x16_bf16 v[80:95], v[48:51], v[208:211], v[80:95]
    ds_read_b128 v[60:63], v11 offset:16512
    v_exp_f32 v107, v107
    v_fma_f32 v108, v108, s33, -v20
    v_exp_f32 v108, v108
    v_fma_f32 v109, v109, s33, -v20
    v_exp_f32 v109, v109
    v_fma_f32 v110, v110, s33, -v20
    v_exp_f32 v110, v110
    v_fma_f32 v111, v111, s33, -v20
    v_exp_f32 v111, v111
    v_add_f32 v22, v22, v96
    s_waitcnt lgkmcnt(2)
    v_mfma_f32_32x32x16_bf16 v[64:79], v[52:55], v[148:151], v[64:79]
    v_mfma_f32_32x32x16_bf16 v[80:95], v[52:55], v[212:215], v[80:95]
    ds_read_b128 v[48:51], v8 offset:16640
    v_add_f32 v22, v22, v97
    v_add_f32 v22, v22, v98
    v_add_f32 v22, v22, v99
    v_add_f32 v22, v22, v100
    v_add_f32 v22, v22, v101
    v_add_f32 v22, v22, v102
    v_add_f32 v22, v22, v103
    v_add_f32 v22, v22, v104
    v_add_f32 v22, v22, v105
    v_add_f32 v22, v22, v106
    s_waitcnt lgkmcnt(2)
    v_mfma_f32_32x32x16_bf16 v[64:79], v[56:59], v[152:155], v[64:79]
    v_mfma_f32_32x32x16_bf16 v[80:95], v[56:59], v[216:219], v[80:95]
    ds_read_b128 v[52:55], v9 offset:16640
    v_add_f32 v22, v22, v107
    v_add_f32 v22, v22, v108
    v_add_f32 v22, v22, v109
    v_add_f32 v22, v22, v110
    v_add_f32 v22, v22, v111
    v_cvt_pk_bf16_f32 v96, v96, v97
    v_cvt_pk_bf16_f32 v97, v98, v99
    v_cvt_pk_bf16_f32 v98, v100, v101
    v_cvt_pk_bf16_f32 v99, v102, v103
    v_cvt_pk_bf16_f32 v100, v104, v105
    s_waitcnt lgkmcnt(2)
    v_mfma_f32_32x32x16_bf16 v[64:79], v[60:63], v[156:159], v[64:79]
    v_mfma_f32_32x32x16_bf16 v[80:95], v[60:63], v[220:223], v[80:95]
    ds_read_b128 v[56:59], v10 offset:16640
    v_cvt_pk_bf16_f32 v101, v106, v107
    v_cvt_pk_bf16_f32 v102, v108, v109
    v_cvt_pk_bf16_f32 v103, v110, v111
    v_max3_f32 v27, v112, v113, v114
    v_max3_f32 v27, v27, v115, v116
    v_max3_f32 v27, v27, v117, v118
    v_max3_f32 v27, v27, v119, v120
    v_max3_f32 v27, v27, v121, v122
    v_max3_f32 v27, v27, v123, v124
    v_max3_f32 v27, v27, v125, v126
    s_waitcnt lgkmcnt(2)
    v_mfma_f32_32x32x16_bf16 v[64:79], v[48:51], v[160:163], v[64:79]
    v_mfma_f32_32x32x16_bf16 v[80:95], v[48:51], v[224:227], v[80:95]
    ds_read_b128 v[60:63], v11 offset:16640
    v_max_f32 v27, v27, v127
    v_mov_b32 v28, v27
    v_mov_b32 v29, v27
    s_nop 1
    v_permlane32_swap_b32 v28, v29
    v_max_f32 v27, v28, v29
    v_mul_f32 v27, s33, v27
    v_add_f32 v28, 0x41000000, v21
    v_cmp_gt_f32 vcc, v27, v28
    s_cbranch_vccz fused_kernel_rs5_1
    s_swappc_b64 s[44:45], s[48:49]
fused_kernel_rs5_1:
    s_waitcnt lgkmcnt(2)
    v_mfma_f32_32x32x16_bf16 v[64:79], v[52:55], v[164:167], v[64:79]
    v_mfma_f32_32x32x16_bf16 v[80:95], v[52:55], v[228:231], v[80:95]
    ds_read_b128 v[48:51], v8 offset:16768
    v_fma_f32 v112, v112, s33, -v21
    v_exp_f32 v112, v112
    v_fma_f32 v113, v113, s33, -v21
    v_exp_f32 v113, v113
    v_fma_f32 v114, v114, s33, -v21
    v_exp_f32 v114, v114
    v_fma_f32 v115, v115, s33, -v21
    v_exp_f32 v115, v115
    v_fma_f32 v116, v116, s33, -v21
    v_exp_f32 v116, v116
    s_waitcnt lgkmcnt(2)
    v_mfma_f32_32x32x16_bf16 v[64:79], v[56:59], v[168:171], v[64:79]
    v_mfma_f32_32x32x16_bf16 v[80:95], v[56:59], v[232:235], v[80:95]
    ds_read_b128 v[52:55], v9 offset:16768
    v_fma_f32 v117, v117, s33, -v21
    v_exp_f32 v117, v117
    v_fma_f32 v118, v118, s33, -v21
    v_exp_f32 v118, v118
    v_fma_f32 v119, v119, s33, -v21
    v_exp_f32 v119, v119
    v_fma_f32 v120, v120, s33, -v21
    v_exp_f32 v120, v120
    v_fma_f32 v121, v121, s33, -v21
    v_exp_f32 v121, v121
    s_waitcnt lgkmcnt(2)
    v_mfma_f32_32x32x16_bf16 v[64:79], v[60:63], v[172:175], v[64:79]
    v_mfma_f32_32x32x16_bf16 v[80:95], v[60:63], v[236:239], v[80:95]
    ds_read_b128 v[56:59], v10 offset:16768
    v_fma_f32 v122, v122, s33, -v21
    v_exp_f32 v122, v122
    v_fma_f32 v123, v123, s33, -v21
    v_exp_f32 v123, v123
    v_fma_f32 v124, v124, s33, -v21
    v_exp_f32 v124, v124
    v_fma_f32 v125, v125, s33, -v21
    v_exp_f32 v125, v125
    v_fma_f32 v126, v126, s33, -v21
    v_exp_f32 v126, v126
    s_waitcnt lgkmcnt(2)
    v_mfma_f32_32x32x16_bf16 v[64:79], v[48:51], v[176:179], v[64:79]
    v_mfma_f32_32x32x16_bf16 v[80:95], v[48:51], v[240:243], v[80:95]
    ds_read_b128 v[60:63], v11 offset:16768
    v_fma_f32 v127, v127, s33, -v21
    v_exp_f32 v127, v127
    v_add_f32 v23, v23, v112
    v_add_f32 v23, v23, v113
    v_add_f32 v23, v23, v114
    v_add_f32 v23, v23, v115
    v_add_f32 v23, v23, v116
    v_add_f32 v23, v23, v117
    v_add_f32 v23, v23, v118
    v_add_f32 v23, v23, v119
    s_waitcnt lgkmcnt(2)
    v_mfma_f32_32x32x16_bf16 v[64:79], v[52:55], v[180:183], v[64:79]
    v_mfma_f32_32x32x16_bf16 v[80:95], v[52:55], v[244:247], v[80:95]
    v_add_f32 v23, v23, v120
    v_add_f32 v23, v23, v121
    v_add_f32 v23, v23, v122
    v_add_f32 v23, v23, v123
    v_add_f32 v23, v23, v124
    v_add_f32 v23, v23, v125
    v_add_f32 v23, v23, v126
    v_add_f32 v23, v23, v127
    v_cvt_pk_bf16_f32 v112, v112, v113
    v_cvt_pk_bf16_f32 v113, v114, v115
    s_waitcnt lgkmcnt(1)
    v_mfma_f32_32x32x16_bf16 v[64:79], v[56:59], v[184:187], v[64:79]
    v_mfma_f32_32x32x16_bf16 v[80:95], v[56:59], v[248:251], v[80:95]
    v_cvt_pk_bf16_f32 v114, v116, v117
    v_cvt_pk_bf16_f32 v115, v118, v119
    v_cvt_pk_bf16_f32 v116, v120, v121
    v_cvt_pk_bf16_f32 v117, v122, v123
    v_cvt_pk_bf16_f32 v118, v124, v125
    v_cvt_pk_bf16_f32 v119, v126, v127
    s_waitcnt lgkmcnt(0)
    v_mfma_f32_32x32x16_bf16 v[64:79], v[60:63], v[188:191], v[64:79]
    v_mfma_f32_32x32x16_bf16 v[80:95], v[60:63], v[252:255], v[80:95]
    s_add_u32 m0, s31, 16384
    s_add_u32 s34, s30, 122880
    buffer_load_dwordx4 v2, s[12:15], s34 offen offset:0 lds
    buffer_load_dwordx4 v3, s[12:15], s34 offen offset:1024 lds
    buffer_load_dwordx4 v4, s[12:15], s34 offen offset:2048 lds
    buffer_load_dwordx4 v5, s[12:15], s34 offen offset:3072 lds
    s_add_u32 m0, s31, 20480
    s_add_u32 s34, s30, 126976
    buffer_load_dwordx4 v2, s[12:15], s34 offen offset:0 lds
    buffer_load_dwordx4 v3, s[12:15], s34 offen offset:1024 lds
    buffer_load_dwordx4 v4, s[12:15], s34 offen offset:2048 lds
    buffer_load_dwordx4 v5, s[12:15], s34 offen offset:3072 lds
    s_add_u32 m0, s31, 24576
    s_add_u32 s34, s30, 98304
    buffer_load_dwordx4 v6, s[16:19], s34 offen offset:0 lds
    buffer_load_dwordx4 v7, s[16:19], s34 offen offset:1024 lds
    buffer_load_dwordx4 v6, s[16:19], s34 offen offset:2048 lds
    buffer_load_dwordx4 v7, s[16:19], s34 offen offset:3072 lds
    s_add_u32 m0, s31, 28672
    s_add_u32 s34, s30, 102400
    buffer_load_dwordx4 v6, s[16:19], s34 offen offset:0 lds
    buffer_load_dwordx4 v7, s[16:19], s34 offen offset:1024 lds
    buffer_load_dwordx4 v6, s[16:19], s34 offen offset:2048 lds
    buffer_load_dwordx4 v7, s[16:19], s34 offen offset:3072 lds
    s_nop 1
    s_waitcnt vmcnt(32)
    ds_read_b64_tr_b16 v[32:33], v16 offset:32768
    ds_read_b64_tr_b16 v[34:35], v16 offset:36864
    ds_read_b64_tr_b16 v[36:37], v17 offset:32768
    ds_read_b64_tr_b16 v[38:39], v17 offset:36864
    ds_read_b64_tr_b16 v[40:41], v18 offset:32768
    ds_read_b64_tr_b16 v[42:43], v18 offset:36864
    s_waitcnt lgkmcnt(4)
    v_mfma_f32_32x32x16_bf16 a[0:15], v[32:35], v[96:99], a[0:15]
    v_mfma_f32_32x32x16_bf16 a[128:143], v[32:35], v[112:115], a[128:143]
    ds_read_b64_tr_b16 v[44:45], v19 offset:32768
    ds_read_b64_tr_b16 v[46:47], v19 offset:36864
    s_waitcnt lgkmcnt(4)
    v_mfma_f32_32x32x16_bf16 a[16:31], v[36:39], v[96:99], a[16:31]
    v_mfma_f32_32x32x16_bf16 a[144:159], v[36:39], v[112:115], a[144:159]
    ds_read_b64_tr_b16 v[32:33], v16 offset:33024
    ds_read_b64_tr_b16 v[34:35], v16 offset:37120
    s_waitcnt lgkmcnt(4)
    v_mfma_f32_32x32x16_bf16 a[32:47], v[40:43], v[96:99], a[32:47]
    v_mfma_f32_32x32x16_bf16 a[160:175], v[40:43], v[112:115], a[160:175]
    ds_read_b64_tr_b16 v[36:37], v17 offset:33024
    ds_read_b64_tr_b16 v[38:39], v17 offset:37120
    s_waitcnt lgkmcnt(4)
    v_mfma_f32_32x32x16_bf16 a[48:63], v[44:47], v[96:99], a[48:63]
    v_mfma_f32_32x32x16_bf16 a[176:191], v[44:47], v[112:115], a[176:191]
    ds_read_b64_tr_b16 v[40:41], v18 offset:33024
    ds_read_b64_tr_b16 v[42:43], v18 offset:37120
    s_waitcnt lgkmcnt(4)
    v_mfma_f32_32x32x16_bf16 a[64:79], v[32:35], v[96:99], a[64:79]
    v_mfma_f32_32x32x16_bf16 a[192:207], v[32:35], v[112:115], a[192:207]
    ds_read_b64_tr_b16 v[44:45], v19 offset:33024
    ds_read_b64_tr_b16 v[46:47], v19 offset:37120
    s_waitcnt lgkmcnt(4)
    v_mfma_f32_32x32x16_bf16 a[80:95], v[36:39], v[96:99], a[80:95]
    v_mfma_f32_32x32x16_bf16 a[208:223], v[36:39], v[112:115], a[208:223]
    s_waitcnt vmcnt(24)
    ds_read_b64_tr_b16 v[32:33], v16 offset:0
    ds_read_b64_tr_b16 v[34:35], v16 offset:4096
    s_waitcnt lgkmcnt(4)
    v_mfma_f32_32x32x16_bf16 a[96:111], v[40:43], v[96:99], a[96:111]
    v_mfma_f32_32x32x16_bf16 a[224:239], v[40:43], v[112:115], a[224:239]
    ds_read_b64_tr_b16 v[36:37], v17 offset:0
    ds_read_b64_tr_b16 v[38:39], v17 offset:4096
    s_waitcnt lgkmcnt(4)
    v_mfma_f32_32x32x16_bf16 a[112:127], v[44:47], v[96:99], a[112:127]
    v_mfma_f32_32x32x16_bf16 a[240:255], v[44:47], v[112:115], a[240:255]
    ds_read_b64_tr_b16 v[40:41], v18 offset:0
    ds_read_b64_tr_b16 v[42:43], v18 offset:4096
    s_waitcnt lgkmcnt(4)
    v_mfma_f32_32x32x16_bf16 a[0:15], v[32:35], v[100:103], a[0:15]
    v_mfma_f32_32x32x16_bf16 a[128:143], v[32:35], v[116:119], a[128:143]
    ds_read_b64_tr_b16 v[44:45], v19 offset:0
    ds_read_b64_tr_b16 v[46:47], v19 offset:4096
    s_add_u32 m0, s31, 32768
    s_add_u32 s34, s30, 106496
    buffer_load_dwordx4 v6, s[16:19], s34 offen offset:0 lds
    buffer_load_dwordx4 v7, s[16:19], s34 offen offset:1024 lds
    buffer_load_dwordx4 v6, s[16:19], s34 offen offset:2048 lds
    buffer_load_dwordx4 v7, s[16:19], s34 offen offset:3072 lds
    s_add_u32 m0, s31, 36864
    s_add_u32 s34, s30, 110592
    buffer_load_dwordx4 v6, s[16:19], s34 offen offset:0 lds
    buffer_load_dwordx4 v7, s[16:19], s34 offen offset:1024 lds
    buffer_load_dwordx4 v6, s[16:19], s34 offen offset:2048 lds
    buffer_load_dwordx4 v7, s[16:19], s34 offen offset:3072 lds
    s_waitcnt lgkmcnt(4)
    v_mfma_f32_32x32x16_bf16 a[16:31], v[36:39], v[100:103], a[16:31]
    v_mfma_f32_32x32x16_bf16 a[144:159], v[36:39], v[116:119], a[144:159]
    ds_read_b64_tr_b16 v[32:33], v16 offset:256
    ds_read_b64_tr_b16 v[34:35], v16 offset:4352
    s_waitcnt lgkmcnt(4)
    v_mfma_f32_32x32x16_bf16 a[32:47], v[40:43], v[100:103], a[32:47]
    v_mfma_f32_32x32x16_bf16 a[160:175], v[40:43], v[116:119], a[160:175]
    ds_read_b64_tr_b16 v[36:37], v17 offset:256
    ds_read_b64_tr_b16 v[38:39], v17 offset:4352
    s_waitcnt lgkmcnt(4)
    v_mfma_f32_32x32x16_bf16 a[48:63], v[44:47], v[100:103], a[48:63]
    v_mfma_f32_32x32x16_bf16 a[176:191], v[44:47], v[116:119], a[176:191]
    ds_read_b64_tr_b16 v[40:41], v18 offset:256
    ds_read_b64_tr_b16 v[42:43], v18 offset:4352
    s_waitcnt lgkmcnt(4)
    v_mfma_f32_32x32x16_bf16 a[64:79], v[32:35], v[100:103], a[64:79]
    v_mfma_f32_32x32x16_bf16 a[192:207], v[32:35], v[116:119], a[192:207]
    ds_read_b64_tr_b16 v[44:45], v19 offset:256
    ds_read_b64_tr_b16 v[46:47], v19 offset:4352
    s_waitcnt lgkmcnt(4)
    v_mfma_f32_32x32x16_bf16 a[80:95], v[36:39], v[100:103], a[80:95]
    v_mfma_f32_32x32x16_bf16 a[208:223], v[36:39], v[116:119], a[208:223]
    s_waitcnt lgkmcnt(2)
    v_mfma_f32_32x32x16_bf16 a[96:111], v[40:43], v[100:103], a[96:111]
    v_mfma_f32_32x32x16_bf16 a[224:239], v[40:43], v[116:119], a[224:239]
    s_waitcnt lgkmcnt(0)
    v_mfma_f32_32x32x16_bf16 a[112:127], v[44:47], v[100:103], a[112:127]
    v_mfma_f32_32x32x16_bf16 a[240:255], v[44:47], v[116:119], a[240:255]
    s_add_u32 m0, s31, 0
    s_add_u32 s34, s30, 114688
    buffer_load_dwordx4 v6, s[16:19], s34 offen offset:0 lds
    buffer_load_dwordx4 v7, s[16:19], s34 offen offset:1024 lds
    buffer_load_dwordx4 v6, s[16:19], s34 offen offset:2048 lds
    buffer_load_dwordx4 v7, s[16:19], s34 offen offset:3072 lds
    s_add_u32 m0, s31, 4096
    s_add_u32 s34, s30, 118784
    buffer_load_dwordx4 v6, s[16:19], s34 offen offset:0 lds
    buffer_load_dwordx4 v7, s[16:19], s34 offen offset:1024 lds
    buffer_load_dwordx4 v6, s[16:19], s34 offen offset:2048 lds
    buffer_load_dwordx4 v7, s[16:19], s34 offen offset:3072 lds
    s_waitcnt vmcnt(24)
    ds_read_b128 v[48:51], v8 offset:8192
    ds_read_b128 v[52:55], v9 offset:8192
    ds_read_b128 v[56:59], v10 offset:8192
    s_waitcnt lgkmcnt(2)
    v_mfma_f32_32x32x16_bf16 v[96:111], v[48:51], v[128:131], 0
    v_mfma_f32_32x32x16_bf16 v[112:127], v[48:51], v[192:195], 0
    ds_read_b128 v[60:63], v11 offset:8192
    v_max3_f32 v24, v64, v65, v66
    v_max3_f32 v24, v24, v67, v68
    v_max3_f32 v24, v24, v69, v70
    v_max3_f32 v24, v24, v71, v72
    v_max3_f32 v24, v24, v73, v74
    v_max3_f32 v24, v24, v75, v76
    v_max3_f32 v24, v24, v77, v78
    v_max_f32 v24, v24, v79
    v_mov_b32 v25, v24
    v_mov_b32 v26, v24
    s_waitcnt lgkmcnt(2)
    v_mfma_f32_32x32x16_bf16 v[96:111], v[52:55], v[132:135], v[96:111]
    v_mfma_f32_32x32x16_bf16 v[112:127], v[52:55], v[196:199], v[112:127]
    ds_read_b128 v[48:51], v8 offset:8320
    s_nop 1
    v_permlane32_swap_b32 v25, v26
    v_max_f32 v24, v25, v26
    v_mul_f32 v24, s33, v24
    v_add_f32 v25, 0x41000000, v20
    v_cmp_gt_f32 vcc, v24, v25
    s_cbranch_vccz fused_kernel_rs6_0
    s_swappc_b64 s[44:45], s[46:47]
fused_kernel_rs6_0:
    v_fma_f32 v64, v64, s33, -v20
    v_exp_f32 v64, v64
    v_fma_f32 v65, v65, s33, -v20
    s_waitcnt lgkmcnt(2)
    v_mfma_f32_32x32x16_bf16 v[96:111], v[56:59], v[136:139], v[96:111]
    v_mfma_f32_32x32x16_bf16 v[112:127], v[56:59], v[200:203], v[112:127]
    ds_read_b128 v[52:55], v9 offset:8320
    v_exp_f32 v65, v65
    v_fma_f32 v66, v66, s33, -v20
    v_exp_f32 v66, v66
    v_fma_f32 v67, v67, s33, -v20
    v_exp_f32 v67, v67
    v_fma_f32 v68, v68, s33, -v20
    v_exp_f32 v68, v68
    v_fma_f32 v69, v69, s33, -v20
    v_exp_f32 v69, v69
    v_fma_f32 v70, v70, s33, -v20
    s_waitcnt lgkmcnt(2)
    v_mfma_f32_32x32x16_bf16 v[96:111], v[60:63], v[140:143], v[96:111]
    v_mfma_f32_32x32x16_bf16 v[112:127], v[60:63], v[204:207], v[112:127]
    ds_read_b128 v[56:59], v10 offset:8320
    v_exp_f32 v70, v70
    v_fma_f32 v71, v71, s33, -v20
    v_exp_f32 v71, v71
    v_fma_f32 v72, v72, s33, -v20
    v_exp_f32 v72, v72
    v_fma_f32 v73, v73, s33, -v20
    v_exp_f32 v73, v73
    v_fma_f32 v74, v74, s33, -v20
    v_exp_f32 v74, v74
    v_fma_f32 v75, v75, s33, -v20
    s_waitcnt lgkmcnt(2)
    v_mfma_f32_32x32x16_bf16 v[96:111], v[48:51], v[144:147], v[96:111]
    v_mfma_f32_32x32x16_bf16 v[112:127], v[48:51], v[208:211], v[112:127]
    ds_read_b128 v[60:63], v11 offset:8320
    v_exp_f32 v75, v75
    v_fma_f32 v76, v76, s33, -v20
    v_exp_f32 v76, v76
    v_fma_f32 v77, v77, s33, -v20
    v_exp_f32 v77, v77
    v_fma_f32 v78, v78, s33, -v20
    v_exp_f32 v78, v78
    v_fma_f32 v79, v79, s33, -v20
    v_exp_f32 v79, v79
    v_add_f32 v22, v22, v64
    s_waitcnt lgkmcnt(2)
    v_mfma_f32_32x32x16_bf16 v[96:111], v[52:55], v[148:151], v[96:111]
    v_mfma_f32_32x32x16_bf16 v[112:127], v[52:55], v[212:215], v[112:127]
    ds_read_b128 v[48:51], v8 offset:8448
    v_add_f32 v22, v22, v65
    v_add_f32 v22, v22, v66
    v_add_f32 v22, v22, v67
    v_add_f32 v22, v22, v68
    v_add_f32 v22, v22, v69
    v_add_f32 v22, v22, v70
    v_add_f32 v22, v22, v71
    v_add_f32 v22, v22, v72
    v_add_f32 v22, v22, v73
    v_add_f32 v22, v22, v74
    s_waitcnt lgkmcnt(2)
    v_mfma_f32_32x32x16_bf16 v[96:111], v[56:59], v[152:155], v[96:111]
    v_mfma_f32_32x32x16_bf16 v[112:127], v[56:59], v[216:219], v[112:127]
    ds_read_b128 v[52:55], v9 offset:8448
    v_add_f32 v22, v22, v75
    v_add_f32 v22, v22, v76
    v_add_f32 v22, v22, v77
    v_add_f32 v22, v22, v78
    v_add_f32 v22, v22, v79
    v_cvt_pk_bf16_f32 v64, v64, v65
    v_cvt_pk_bf16_f32 v65, v66, v67
    v_cvt_pk_bf16_f32 v66, v68, v69
    v_cvt_pk_bf16_f32 v67, v70, v71
    v_cvt_pk_bf16_f32 v68, v72, v73
    s_waitcnt lgkmcnt(2)
    v_mfma_f32_32x32x16_bf16 v[96:111], v[60:63], v[156:159], v[96:111]
    v_mfma_f32_32x32x16_bf16 v[112:127], v[60:63], v[220:223], v[112:127]
    ds_read_b128 v[56:59], v10 offset:8448
    v_cvt_pk_bf16_f32 v69, v74, v75
    v_cvt_pk_bf16_f32 v70, v76, v77
    v_cvt_pk_bf16_f32 v71, v78, v79
    v_max3_f32 v27, v80, v81, v82
    v_max3_f32 v27, v27, v83, v84
    v_max3_f32 v27, v27, v85, v86
    v_max3_f32 v27, v27, v87, v88
    v_max3_f32 v27, v27, v89, v90
    v_max3_f32 v27, v27, v91, v92
    v_max3_f32 v27, v27, v93, v94
    s_waitcnt lgkmcnt(2)
    v_mfma_f32_32x32x16_bf16 v[96:111], v[48:51], v[160:163], v[96:111]
    v_mfma_f32_32x32x16_bf16 v[112:127], v[48:51], v[224:227], v[112:127]
    ds_read_b128 v[60:63], v11 offset:8448
    v_max_f32 v27, v27, v95
    v_mov_b32 v28, v27
    v_mov_b32 v29, v27
    s_nop 1
    v_permlane32_swap_b32 v28, v29
    v_max_f32 v27, v28, v29
    v_mul_f32 v27, s33, v27
    v_add_f32 v28, 0x41000000, v21
    v_cmp_gt_f32 vcc, v27, v28
    s_cbranch_vccz fused_kernel_rs6_1
    s_swappc_b64 s[44:45], s[48:49]
fused_kernel_rs6_1:
    s_waitcnt lgkmcnt(2)
    v_mfma_f32_32x32x16_bf16 v[96:111], v[52:55], v[164:167], v[96:111]
    v_mfma_f32_32x32x16_bf16 v[112:127], v[52:55], v[228:231], v[112:127]
    ds_read_b128 v[48:51], v8 offset:8576
    v_fma_f32 v80, v80, s33, -v21
    v_exp_f32 v80, v80
    v_fma_f32 v81, v81, s33, -v21
    v_exp_f32 v81, v81
    v_fma_f32 v82, v82, s33, -v21
    v_exp_f32 v82, v82
    v_fma_f32 v83, v83, s33, -v21
    v_exp_f32 v83, v83
    v_fma_f32 v84, v84, s33, -v21
    v_exp_f32 v84, v84
    s_waitcnt lgkmcnt(2)
    v_mfma_f32_32x32x16_bf16 v[96:111], v[56:59], v[168:171], v[96:111]
    v_mfma_f32_32x32x16_bf16 v[112:127], v[56:59], v[232:235], v[112:127]
    ds_read_b128 v[52:55], v9 offset:8576
    v_fma_f32 v85, v85, s33, -v21
    v_exp_f32 v85, v85
    v_fma_f32 v86, v86, s33, -v21
    v_exp_f32 v86, v86
    v_fma_f32 v87, v87, s33, -v21
    v_exp_f32 v87, v87
    v_fma_f32 v88, v88, s33, -v21
    v_exp_f32 v88, v88
    v_fma_f32 v89, v89, s33, -v21
    v_exp_f32 v89, v89
    s_waitcnt lgkmcnt(2)
    v_mfma_f32_32x32x16_bf16 v[96:111], v[60:63], v[172:175], v[96:111]
    v_mfma_f32_32x32x16_bf16 v[112:127], v[60:63], v[236:239], v[112:127]
    ds_read_b128 v[56:59], v10 offset:8576
    v_fma_f32 v90, v90, s33, -v21
    v_exp_f32 v90, v90
    v_fma_f32 v91, v91, s33, -v21
    v_exp_f32 v91, v91
    v_fma_f32 v92, v92, s33, -v21
    v_exp_f32 v92, v92
    v_fma_f32 v93, v93, s33, -v21
    v_exp_f32 v93, v93
    v_fma_f32 v94, v94, s33, -v21
    v_exp_f32 v94, v94
    s_waitcnt lgkmcnt(2)
    v_mfma_f32_32x32x16_bf16 v[96:111], v[48:51], v[176:179], v[96:111]
    v_mfma_f32_32x32x16_bf16 v[112:127], v[48:51], v[240:243], v[112:127]
    ds_read_b128 v[60:63], v11 offset:8576
    v_fma_f32 v95, v95, s33, -v21
    v_exp_f32 v95, v95
    v_add_f32 v23, v23, v80
    v_add_f32 v23, v23, v81
    v_add_f32 v23, v23, v82
    v_add_f32 v23, v23, v83
    v_add_f32 v23, v23, v84
    v_add_f32 v23, v23, v85
    v_add_f32 v23, v23, v86
    v_add_f32 v23, v23, v87
    s_waitcnt lgkmcnt(2)
    v_mfma_f32_32x32x16_bf16 v[96:111], v[52:55], v[180:183], v[96:111]
    v_mfma_f32_32x32x16_bf16 v[112:127], v[52:55], v[244:247], v[112:127]
    v_add_f32 v23, v23, v88
    v_add_f32 v23, v23, v89
    v_add_f32 v23, v23, v90
    v_add_f32 v23, v23, v91
    v_add_f32 v23, v23, v92
    v_add_f32 v23, v23, v93
    v_add_f32 v23, v23, v94
    v_add_f32 v23, v23, v95
    v_cvt_pk_bf16_f32 v80, v80, v81
    v_cvt_pk_bf16_f32 v81, v82, v83
    s_waitcnt lgkmcnt(1)
    v_mfma_f32_32x32x16_bf16 v[96:111], v[56:59], v[184:187], v[96:111]
    v_mfma_f32_32x32x16_bf16 v[112:127], v[56:59], v[248:251], v[112:127]
    v_cvt_pk_bf16_f32 v82, v84, v85
    v_cvt_pk_bf16_f32 v83, v86, v87
    v_cvt_pk_bf16_f32 v84, v88, v89
    v_cvt_pk_bf16_f32 v85, v90, v91
    v_cvt_pk_bf16_f32 v86, v92, v93
    v_cvt_pk_bf16_f32 v87, v94, v95
    s_waitcnt lgkmcnt(0)
    v_mfma_f32_32x32x16_bf16 v[96:111], v[60:63], v[188:191], v[96:111]
    v_mfma_f32_32x32x16_bf16 v[112:127], v[60:63], v[252:255], v[112:127]
    s_add_u32 m0, s31, 8192
    s_add_u32 s34, s30, 122880
    buffer_load_dwordx4 v6, s[16:19], s34 offen offset:0 lds
    buffer_load_dwordx4 v7, s[16:19], s34 offen offset:1024 lds
    buffer_load_dwordx4 v6, s[16:19], s34 offen offset:2048 lds
    buffer_load_dwordx4 v7, s[16:19], s34 offen offset:3072 lds
    s_add_u32 m0, s31, 12288
    s_add_u32 s34, s30, 126976
    buffer_load_dwordx4 v6, s[16:19], s34 offen offset:0 lds
    buffer_load_dwordx4 v7, s[16:19], s34 offen offset:1024 lds
    buffer_load_dwordx4 v6, s[16:19], s34 offen offset:2048 lds
    buffer_load_dwordx4 v7, s[16:19], s34 offen offset:3072 lds
    s_nop 1
    s_waitcnt vmcnt(24)
    ds_read_b64_tr_b16 v[32:33], v16 offset:24576
    ds_read_b64_tr_b16 v[34:35], v16 offset:28672
    ds_read_b64_tr_b16 v[36:37], v17 offset:24576
    ds_read_b64_tr_b16 v[38:39], v17 offset:28672
    ds_read_b64_tr_b16 v[40:41], v18 offset:24576
    ds_read_b64_tr_b16 v[42:43], v18 offset:28672
    s_waitcnt lgkmcnt(4)
    v_mfma_f32_32x32x16_bf16 a[0:15], v[32:35], v[64:67], a[0:15]
    v_mfma_f32_32x32x16_bf16 a[128:143], v[32:35], v[80:83], a[128:143]
    ds_read_b64_tr_b16 v[44:45], v19 offset:24576
    ds_read_b64_tr_b16 v[46:47], v19 offset:28672
    s_waitcnt lgkmcnt(4)
    v_mfma_f32_32x32x16_bf16 a[16:31], v[36:39], v[64:67], a[16:31]
    v_mfma_f32_32x32x16_bf16 a[144:159], v[36:39], v[80:83], a[144:159]
    ds_read_b64_tr_b16 v[32:33], v16 offset:24832
    ds_read_b64_tr_b16 v[34:35], v16 offset:28928
    s_waitcnt lgkmcnt(4)
    v_mfma_f32_32x32x16_bf16 a[32:47], v[40:43], v[64:67], a[32:47]
    v_mfma_f32_32x32x16_bf16 a[160:175], v[40:43], v[80:83], a[160:175]
    ds_read_b64_tr_b16 v[36:37], v17 offset:24832
    ds_read_b64_tr_b16 v[38:39], v17 offset:28928
    s_waitcnt lgkmcnt(4)
    v_mfma_f32_32x32x16_bf16 a[48:63], v[44:47], v[64:67], a[48:63]
    v_mfma_f32_32x32x16_bf16 a[176:191], v[44:47], v[80:83], a[176:191]
    ds_read_b64_tr_b16 v[40:41], v18 offset:24832
    ds_read_b64_tr_b16 v[42:43], v18 offset:28928
    s_waitcnt lgkmcnt(4)
    v_mfma_f32_32x32x16_bf16 a[64:79], v[32:35], v[64:67], a[64:79]
    v_mfma_f32_32x32x16_bf16 a[192:207], v[32:35], v[80:83], a[192:207]
    ds_read_b64_tr_b16 v[44:45], v19 offset:24832
    ds_read_b64_tr_b16 v[46:47], v19 offset:28928
    s_waitcnt lgkmcnt(4)
    v_mfma_f32_32x32x16_bf16 a[80:95], v[36:39], v[64:67], a[80:95]
    v_mfma_f32_32x32x16_bf16 a[208:223], v[36:39], v[80:83], a[208:223]
    s_waitcnt vmcnt(16)
    ds_read_b64_tr_b16 v[32:33], v16 offset:32768
    ds_read_b64_tr_b16 v[34:35], v16 offset:36864
    s_waitcnt lgkmcnt(4)
    v_mfma_f32_32x32x16_bf16 a[96:111], v[40:43], v[64:67], a[96:111]
    v_mfma_f32_32x32x16_bf16 a[224:239], v[40:43], v[80:83], a[224:239]
    ds_read_b64_tr_b16 v[36:37], v17 offset:32768
    ds_read_b64_tr_b16 v[38:39], v17 offset:36864
    s_waitcnt lgkmcnt(4)
    v_mfma_f32_32x32x16_bf16 a[112:127], v[44:47], v[64:67], a[112:127]
    v_mfma_f32_32x32x16_bf16 a[240:255], v[44:47], v[80:83], a[240:255]
    ds_read_b64_tr_b16 v[40:41], v18 offset:32768
    ds_read_b64_tr_b16 v[42:43], v18 offset:36864
    s_waitcnt lgkmcnt(4)
    v_mfma_f32_32x32x16_bf16 a[0:15], v[32:35], v[68:71], a[0:15]
    v_mfma_f32_32x32x16_bf16 a[128:143], v[32:35], v[84:87], a[128:143]
    ds_read_b64_tr_b16 v[44:45], v19 offset:32768
    ds_read_b64_tr_b16 v[46:47], v19 offset:36864
    s_waitcnt lgkmcnt(4)
    v_mfma_f32_32x32x16_bf16 a[16:31], v[36:39], v[68:71], a[16:31]
    v_mfma_f32_32x32x16_bf16 a[144:159], v[36:39], v[84:87], a[144:159]
    ds_read_b64_tr_b16 v[32:33], v16 offset:33024
    ds_read_b64_tr_b16 v[34:35], v16 offset:37120
    s_waitcnt lgkmcnt(4)
    v_mfma_f32_32x32x16_bf16 a[32:47], v[40:43], v[68:71], a[32:47]
    v_mfma_f32_32x32x16_bf16 a[160:175], v[40:43], v[84:87], a[160:175]
    ds_read_b64_tr_b16 v[36:37], v17 offset:33024
    ds_read_b64_tr_b16 v[38:39], v17 offset:37120
    s_waitcnt lgkmcnt(4)
    v_mfma_f32_32x32x16_bf16 a[48:63], v[44:47], v[68:71], a[48:63]
    v_mfma_f32_32x32x16_bf16 a[176:191], v[44:47], v[84:87], a[176:191]
    ds_read_b64_tr_b16 v[40:41], v18 offset:33024
    ds_read_b64_tr_b16 v[42:43], v18 offset:37120
    s_waitcnt lgkmcnt(4)
    v_mfma_f32_32x32x16_bf16 a[64:79], v[32:35], v[68:71], a[64:79]
    v_mfma_f32_32x32x16_bf16 a[192:207], v[32:35], v[84:87], a[192:207]
    ds_read_b64_tr_b16 v[44:45], v19 offset:33024
    ds_read_b64_tr_b16 v[46:47], v19 offset:37120
    s_waitcnt lgkmcnt(4)
    v_mfma_f32_32x32x16_bf16 a[80:95], v[36:39], v[68:71], a[80:95]
    v_mfma_f32_32x32x16_bf16 a[208:223], v[36:39], v[84:87], a[208:223]
    s_waitcnt lgkmcnt(2)
    v_mfma_f32_32x32x16_bf16 a[96:111], v[40:43], v[68:71], a[96:111]
    v_mfma_f32_32x32x16_bf16 a[224:239], v[40:43], v[84:87], a[224:239]
    s_waitcnt lgkmcnt(0)
    v_mfma_f32_32x32x16_bf16 a[112:127], v[44:47], v[68:71], a[112:127]
    v_mfma_f32_32x32x16_bf16 a[240:255], v[44:47], v[84:87], a[240:255]
    v_max3_f32 v24, v96, v97, v98
    v_max3_f32 v24, v24, v99, v100
    v_max3_f32 v24, v24, v101, v102
    v_max3_f32 v24, v24, v103, v104
    v_max3_f32 v24, v24, v105, v106
    v_max3_f32 v24, v24, v107, v108
    v_max3_f32 v24, v24, v109, v110
    v_max_f32 v24, v24, v111
    v_mov_b32 v25, v24
    v_mov_b32 v26, v24
    s_nop 1
    v_permlane32_swap_b32 v25, v26
    v_max_f32 v24, v25, v26
    v_mul_f32 v24, s33, v24
    v_add_f32 v25, 0x41000000, v20
    v_cmp_gt_f32 vcc, v24, v25
    s_cbranch_vccz fused_kernel_rs7_0
    s_swappc_b64 s[44:45], s[46:47]
fused_kernel_rs7_0:
    v_fma_f32 v96, v96, s33, -v20
    v_exp_f32 v96, v96
    v_fma_f32 v97, v97, s33, -v20
    v_exp_f32 v97, v97
    v_fma_f32 v98, v98, s33, -v20
    v_exp_f32 v98, v98
    v_fma_f32 v99, v99, s33, -v20
    v_exp_f32 v99, v99
    v_fma_f32 v100, v100, s33, -v20
    v_exp_f32 v100, v100
    v_fma_f32 v101, v101, s33, -v20
    v_exp_f32 v101, v101
    v_fma_f32 v102, v102, s33, -v20
    v_exp_f32 v102, v102
    v_fma_f32 v103, v103, s33, -v20
    v_exp_f32 v103, v103
    v_fma_f32 v104, v104, s33, -v20
    v_exp_f32 v104, v104
    v_fma_f32 v105, v105, s33, -v20
    v_exp_f32 v105, v105
    v_fma_f32 v106, v106, s33, -v20
    v_exp_f32 v106, v106
    v_fma_f32 v107, v107, s33, -v20
    v_exp_f32 v107, v107
    v_fma_f32 v108, v108, s33, -v20
    v_exp_f32 v108, v108
    v_fma_f32 v109, v109, s33, -v20
    v_exp_f32 v109, v109
    v_fma_f32 v110, v110, s33, -v20
    v_exp_f32 v110, v110
    v_fma_f32 v111, v111, s33, -v20
    v_exp_f32 v111, v111
    v_add_f32 v22, v22, v96
    v_add_f32 v22, v22, v97
    v_add_f32 v22, v22, v98
    v_add_f32 v22, v22, v99
    v_add_f32 v22, v22, v100
    v_add_f32 v22, v22, v101
    v_add_f32 v22, v22, v102
    v_add_f32 v22, v22, v103
    v_add_f32 v22, v22, v104
    v_add_f32 v22, v22, v105
    v_add_f32 v22, v22, v106
    v_add_f32 v22, v22, v107
    v_add_f32 v22, v22, v108
    v_add_f32 v22, v22, v109
    v_add_f32 v22, v22, v110
    v_add_f32 v22, v22, v111
    v_cvt_pk_bf16_f32 v96, v96, v97
    v_cvt_pk_bf16_f32 v97, v98, v99
    v_cvt_pk_bf16_f32 v98, v100, v101
    v_cvt_pk_bf16_f32 v99, v102, v103
    v_cvt_pk_bf16_f32 v100, v104, v105
    v_cvt_pk_bf16_f32 v101, v106, v107
    v_cvt_pk_bf16_f32 v102, v108, v109
    v_cvt_pk_bf16_f32 v103, v110, v111
    v_max3_f32 v27, v112, v113, v114
    v_max3_f32 v27, v27, v115, v116
    v_max3_f32 v27, v27, v117, v118
    v_max3_f32 v27, v27, v119, v120
    v_max3_f32 v27, v27, v121, v122
    v_max3_f32 v27, v27, v123, v124
    v_max3_f32 v27, v27, v125, v126
    v_max_f32 v27, v27, v127
    v_mov_b32 v28, v27
    v_mov_b32 v29, v27
    s_nop 1
    v_permlane32_swap_b32 v28, v29
    v_max_f32 v27, v28, v29
    v_mul_f32 v27, s33, v27
    v_add_f32 v28, 0x41000000, v21
    v_cmp_gt_f32 vcc, v27, v28
    s_cbranch_vccz fused_kernel_rs7_1
    s_swappc_b64 s[44:45], s[48:49]
fused_kernel_rs7_1:
    v_fma_f32 v112, v112, s33, -v21
    v_exp_f32 v112, v112
    v_fma_f32 v113, v113, s33, -v21
    v_exp_f32 v113, v113
    v_fma_f32 v114, v114, s33, -v21
    v_exp_f32 v114, v114
    v_fma_f32 v115, v115, s33, -v21
    v_exp_f32 v115, v115
    v_fma_f32 v116, v116, s33, -v21
    v_exp_f32 v116, v116
    v_fma_f32 v117, v117, s33, -v21
    v_exp_f32 v117, v117
    v_fma_f32 v118, v118, s33, -v21
    v_exp_f32 v118, v118
    v_fma_f32 v119, v119, s33, -v21
    v_exp_f32 v119, v119
    v_fma_f32 v120, v120, s33, -v21
    v_exp_f32 v120, v120
    v_fma_f32 v121, v121, s33, -v21
    v_exp_f32 v121, v121
    v_fma_f32 v122, v122, s33, -v21
    v_exp_f32 v122, v122
    v_fma_f32 v123, v123, s33, -v21
    v_exp_f32 v123, v123
    v_fma_f32 v124, v124, s33, -v21
    v_exp_f32 v124, v124
    v_fma_f32 v125, v125, s33, -v21
    v_exp_f32 v125, v125
    v_fma_f32 v126, v126, s33, -v21
    v_exp_f32 v126, v126
    v_fma_f32 v127, v127, s33, -v21
    v_exp_f32 v127, v127
    v_add_f32 v23, v23, v112
    v_add_f32 v23, v23, v113
    v_add_f32 v23, v23, v114
    v_add_f32 v23, v23, v115
    v_add_f32 v23, v23, v116
    v_add_f32 v23, v23, v117
    v_add_f32 v23, v23, v118
    v_add_f32 v23, v23, v119
    v_add_f32 v23, v23, v120
    v_add_f32 v23, v23, v121
    v_add_f32 v23, v23, v122
    v_add_f32 v23, v23, v123
    v_add_f32 v23, v23, v124
    v_add_f32 v23, v23, v125
    v_add_f32 v23, v23, v126
    v_add_f32 v23, v23, v127
    v_cvt_pk_bf16_f32 v112, v112, v113
    v_cvt_pk_bf16_f32 v113, v114, v115
    v_cvt_pk_bf16_f32 v114, v116, v117
    v_cvt_pk_bf16_f32 v115, v118, v119
    v_cvt_pk_bf16_f32 v116, v120, v121
    v_cvt_pk_bf16_f32 v117, v122, v123
    v_cvt_pk_bf16_f32 v118, v124, v125
    v_cvt_pk_bf16_f32 v119, v126, v127
    s_nop 1
    s_waitcnt vmcnt(8)
    ds_read_b64_tr_b16 v[32:33], v16 offset:0
    ds_read_b64_tr_b16 v[34:35], v16 offset:4096
    ds_read_b64_tr_b16 v[36:37], v17 offset:0
    ds_read_b64_tr_b16 v[38:39], v17 offset:4096
    ds_read_b64_tr_b16 v[40:41], v18 offset:0
    ds_read_b64_tr_b16 v[42:43], v18 offset:4096
    s_waitcnt lgkmcnt(4)
    v_mfma_f32_32x32x16_bf16 a[0:15], v[32:35], v[96:99], a[0:15]
    v_mfma_f32_32x32x16_bf16 a[128:143], v[32:35], v[112:115], a[128:143]
    ds_read_b64_tr_b16 v[44:45], v19 offset:0
    ds_read_b64_tr_b16 v[46:47], v19 offset:4096
    s_waitcnt lgkmcnt(4)
    v_mfma_f32_32x32x16_bf16 a[16:31], v[36:39], v[96:99], a[16:31]
    v_mfma_f32_32x32x16_bf16 a[144:159], v[36:39], v[112:115], a[144:159]
    ds_read_b64_tr_b16 v[32:33], v16 offset:256
    ds_read_b64_tr_b16 v[34:35], v16 offset:4352
    s_waitcnt lgkmcnt(4)
    v_mfma_f32_32x32x16_bf16 a[32:47], v[40:43], v[96:99], a[32:47]
    v_mfma_f32_32x32x16_bf16 a[160:175], v[40:43], v[112:115], a[160:175]
    ds_read_b64_tr_b16 v[36:37], v17 offset:256
    ds_read_b64_tr_b16 v[38:39], v17 offset:4352
    s_waitcnt lgkmcnt(4)
    v_mfma_f32_32x32x16_bf16 a[48:63], v[44:47], v[96:99], a[48:63]
    v_mfma_f32_32x32x16_bf16 a[176:191], v[44:47], v[112:115], a[176:191]
    ds_read_b64_tr_b16 v[40:41], v18 offset:256
    ds_read_b64_tr_b16 v[42:43], v18 offset:4352
    s_waitcnt lgkmcnt(4)
    v_mfma_f32_32x32x16_bf16 a[64:79], v[32:35], v[96:99], a[64:79]
    v_mfma_f32_32x32x16_bf16 a[192:207], v[32:35], v[112:115], a[192:207]
    ds_read_b64_tr_b16 v[44:45], v19 offset:256
    ds_read_b64_tr_b16 v[46:47], v19 offset:4352
    s_waitcnt lgkmcnt(4)
    v_mfma_f32_32x32x16_bf16 a[80:95], v[36:39], v[96:99], a[80:95]
    v_mfma_f32_32x32x16_bf16 a[208:223], v[36:39], v[112:115], a[208:223]
    s_waitcnt vmcnt(0)
    ds_read_b64_tr_b16 v[32:33], v16 offset:8192
    ds_read_b64_tr_b16 v[34:35], v16 offset:12288
    s_waitcnt lgkmcnt(4)
    v_mfma_f32_32x32x16_bf16 a[96:111], v[40:43], v[96:99], a[96:111]
    v_mfma_f32_32x32x16_bf16 a[224:239], v[40:43], v[112:115], a[224:239]
    ds_read_b64_tr_b16 v[36:37], v17 offset:8192
    ds_read_b64_tr_b16 v[38:39], v17 offset:12288
    s_waitcnt lgkmcnt(4)
    v_mfma_f32_32x32x16_bf16 a[112:127], v[44:47], v[96:99], a[112:127]
    v_mfma_f32_32x32x16_bf16 a[240:255], v[44:47], v[112:115], a[240:255]
    ds_read_b64_tr_b16 v[40:41], v18 offset:8192
    ds_read_b64_tr_b16 v[42:43], v18 offset:12288
    s_waitcnt lgkmcnt(4)
    v_mfma_f32_32x32x16_bf16 a[0:15], v[32:35], v[100:103], a[0:15]
    v_mfma_f32_32x32x16_bf16 a[128:143], v[32:35], v[116:119], a[128:143]
    ds_read_b64_tr_b16 v[44:45], v19 offset:8192
    ds_read_b64_tr_b16 v[46:47], v19 offset:12288
    s_waitcnt lgkmcnt(4)
    v_mfma_f32_32x32x16_bf16 a[16:31], v[36:39], v[100:103], a[16:31]
    v_mfma_f32_32x32x16_bf16 a[144:159], v[36:39], v[116:119], a[144:159]
    ds_read_b64_tr_b16 v[32:33], v16 offset:8448
    ds_read_b64_tr_b16 v[34:35], v16 offset:12544
    s_waitcnt lgkmcnt(4)
    v_mfma_f32_32x32x16_bf16 a[32:47], v[40:43], v[100:103], a[32:47]
    v_mfma_f32_32x32x16_bf16 a[160:175], v[40:43], v[116:119], a[160:175]
    ds_read_b64_tr_b16 v[36:37], v17 offset:8448
    ds_read_b64_tr_b16 v[38:39], v17 offset:12544
    s_waitcnt lgkmcnt(4)
    v_mfma_f32_32x32x16_bf16 a[48:63], v[44:47], v[100:103], a[48:63]
    v_mfma_f32_32x32x16_bf16 a[176:191], v[44:47], v[116:119], a[176:191]
    ds_read_b64_tr_b16 v[40:41], v18 offset:8448
    ds_read_b64_tr_b16 v[42:43], v18 offset:12544
    s_waitcnt lgkmcnt(4)
    v_mfma_f32_32x32x16_bf16 a[64:79], v[32:35], v[100:103], a[64:79]
    v_mfma_f32_32x32x16_bf16 a[192:207], v[32:35], v[116:119], a[192:207]
    ds_read_b64_tr_b16 v[44:45], v19 offset:8448
    ds_read_b64_tr_b16 v[46:47], v19 offset:12544
    s_waitcnt lgkmcnt(4)
    v_mfma_f32_32x32x16_bf16 a[80:95], v[36:39], v[100:103], a[80:95]
    v_mfma_f32_32x32x16_bf16 a[208:223], v[36:39], v[116:119], a[208:223]
    s_waitcnt lgkmcnt(2)
    v_mfma_f32_32x32x16_bf16 a[96:111], v[40:43], v[100:103], a[96:111]
    v_mfma_f32_32x32x16_bf16 a[224:239], v[40:43], v[116:119], a[224:239]
    s_waitcnt lgkmcnt(0)
    v_mfma_f32_32x32x16_bf16 a[112:127], v[44:47], v[100:103], a[112:127]
    v_mfma_f32_32x32x16_bf16 a[240:255], v[44:47], v[116:119], a[240:255]
    v_mov_b32 v3, v30
    v_mov_b32 v4, v31
    s_nop 15
    s_barrier
    v_lshlrev_b32 v30, 2, v1
    v_add_u32 v30, 0x20000, v30
    s_lshl_b32 s34, s26, 10
    v_add_u32 v31, s34, v30
    v_mov_b32 v24, v22
    v_mov_b32 v25, v22
    s_nop 1
    v_permlane32_swap_b32 v24, v25
    v_add_f32 v22, v24, v25
    ds_write_b32 v31, v20 offset:0
    ds_write_b32 v31, v22 offset:256
    v_mov_b32 v24, v23
    v_mov_b32 v25, v23
    s_nop 1
    v_permlane32_swap_b32 v24, v25
    v_add_f32 v23, v24, v25
    ds_write_b32 v31, v21 offset:512
    ds_write_b32 v31, v23 offset:768
    s_waitcnt lgkmcnt(0)
    s_barrier
    ds_read_b32 v32, v30 offset:0
    ds_read_b32 v36, v30 offset:256
    ds_read_b32 v33, v30 offset:1024
    ds_read_b32 v37, v30 offset:1280
    ds_read_b32 v34, v30 offset:2048
    ds_read_b32 v38, v30 offset:2304
    ds_read_b32 v35, v30 offset:3072
    ds_read_b32 v39, v30 offset:3328
    s_waitcnt lgkmcnt(0)
    v_max3_f32 v24, v32, v33, v34
    v_max_f32 v24, v24, v35
    v_mov_b32 v26, 0
    v_sub_f32 v25, v32, v24
    v_exp_f32 v25, v25
    s_nop 0
    v_fmac_f32 v26, v25, v36
    v_sub_f32 v25, v33, v24
    v_exp_f32 v25, v25
    s_nop 0
    v_fmac_f32 v26, v25, v37
    v_sub_f32 v25, v34, v24
    v_exp_f32 v25, v25
    s_nop 0
    v_fmac_f32 v26, v25, v38
    v_sub_f32 v25, v35, v24
    v_exp_f32 v25, v25
    s_nop 0
    v_fmac_f32 v26, v25, v39
    v_rcp_f32 v26, v26
    v_sub_f32 v25, v20, v24
    v_exp_f32 v25, v25
    s_nop 0
    v_mul_f32 v20, v25, v26
    ds_read_b32 v32, v30 offset:512
    ds_read_b32 v36, v30 offset:768
    ds_read_b32 v33, v30 offset:1536
    ds_read_b32 v37, v30 offset:1792
    ds_read_b32 v34, v30 offset:2560
    ds_read_b32 v38, v30 offset:2816
    ds_read_b32 v35, v30 offset:3584
    ds_read_b32 v39, v30 offset:3840
    s_waitcnt lgkmcnt(0)
    v_max3_f32 v24, v32, v33, v34
    v_max_f32 v24, v24, v35
    v_mov_b32 v26, 0
    v_sub_f32 v25, v32, v24
    v_exp_f32 v25, v25
    s_nop 0
    v_fmac_f32 v26, v25, v36
    v_sub_f32 v25, v33, v24
    v_exp_f32 v25, v25
    s_nop 0
    v_fmac_f32 v26, v25, v37
    v_sub_f32 v25, v34, v24
    v_exp_f32 v25, v25
    s_nop 0
    v_fmac_f32 v26, v25, v38
    v_sub_f32 v25, v35, v24
    v_exp_f32 v25, v25
    s_nop 0
    v_fmac_f32 v26, v25, v39
    v_rcp_f32 v26, v26
    v_sub_f32 v25, v21, v24
    v_exp_f32 v25, v25
    s_nop 0
    v_mul_f32 v21, v25, v26
    s_barrier
    v_lshlrev_b32 v30, 4, v1
    s_lshl_b32 s34, s26, 15
    v_add_u32 v31, s34, v30
    v_lshlrev_b32 v5, 9, v3
    v_lshlrev_b32 v6, 3, v4
    v_add_u32 v5, v5, v6
    v_add_u32 v5, 0x20000, v5
    v_and_b32 v6, 7, v3
    v_accvgpr_read_b32 v24, a0
    v_accvgpr_read_b32 v25, a1
    v_accvgpr_read_b32 v26, a2
    v_accvgpr_read_b32 v27, a3
    s_nop 0
    v_mul_f32 v24, v24, v20
    v_mul_f32 v25, v25, v20
    v_mul_f32 v26, v26, v20
    v_mul_f32 v27, v27, v20
    ds_write_b128 v31, v[24:27] offset:0
    v_accvgpr_read_b32 v24, a4
    v_accvgpr_read_b32 v25, a5
    v_accvgpr_read_b32 v26, a6
    v_accvgpr_read_b32 v27, a7
    s_nop 0
    v_mul_f32 v24, v24, v20
    v_mul_f32 v25, v25, v20
    v_mul_f32 v26, v26, v20
    v_mul_f32 v27, v27, v20
    ds_write_b128 v31, v[24:27] offset:1024
    v_accvgpr_read_b32 v24, a8
    v_accvgpr_read_b32 v25, a9
    v_accvgpr_read_b32 v26, a10
    v_accvgpr_read_b32 v27, a11
    s_nop 0
    v_mul_f32 v24, v24, v20
    v_mul_f32 v25, v25, v20
    v_mul_f32 v26, v26, v20
    v_mul_f32 v27, v27, v20
    ds_write_b128 v31, v[24:27] offset:2048
    v_accvgpr_read_b32 v24, a12
    v_accvgpr_read_b32 v25, a13
    v_accvgpr_read_b32 v26, a14
    v_accvgpr_read_b32 v27, a15
    s_nop 0
    v_mul_f32 v24, v24, v20
    v_mul_f32 v25, v25, v20
    v_mul_f32 v26, v26, v20
    v_mul_f32 v27, v27, v20
    ds_write_b128 v31, v[24:27] offset:3072
    v_accvgpr_read_b32 v24, a16
    v_accvgpr_read_b32 v25, a17
    v_accvgpr_read_b32 v26, a18
    v_accvgpr_read_b32 v27, a19
    s_nop 0
    v_mul_f32 v24, v24, v20
    v_mul_f32 v25, v25, v20
    v_mul_f32 v26, v26, v20
    v_mul_f32 v27, v27, v20
    ds_write_b128 v31, v[24:27] offset:4096
    v_accvgpr_read_b32 v24, a20
    v_accvgpr_read_b32 v25, a21
    v_accvgpr_read_b32 v26, a22
    v_accvgpr_read_b32 v27, a23
    s_nop 0
    v_mul_f32 v24, v24, v20
    v_mul_f32 v25, v25, v20
    v_mul_f32 v26, v26, v20
    v_mul_f32 v27, v27, v20
    ds_write_b128 v31, v[24:27] offset:5120
    v_accvgpr_read_b32 v24, a24
    v_accvgpr_read_b32 v25, a25
    v_accvgpr_read_b32 v26, a26
    v_accvgpr_read_b32 v27, a27
    s_nop 0
    v_mul_f32 v24, v24, v20
    v_mul_f32 v25, v25, v20
    v_mul_f32 v26, v26, v20
    v_mul_f32 v27, v27, v20
    ds_write_b128 v31, v[24:27] offset:6144
    v_accvgpr_read_b32 v24, a28
    v_accvgpr_read_b32 v25, a29
    v_accvgpr_read_b32 v26, a30
    v_accvgpr_read_b32 v27, a31
    s_nop 0
    v_mul_f32 v24, v24, v20
    v_mul_f32 v25, v25, v20
    v_mul_f32 v26, v26, v20
    v_mul_f32 v27, v27, v20
    ds_write_b128 v31, v[24:27] offset:7168
    v_accvgpr_read_b32 v24, a32
    v_accvgpr_read_b32 v25, a33
    v_accvgpr_read_b32 v26, a34
    v_accvgpr_read_b32 v27, a35
    s_nop 0
    v_mul_f32 v24, v24, v20
    v_mul_f32 v25, v25, v20
    v_mul_f32 v26, v26, v20
    v_mul_f32 v27, v27, v20
    ds_write_b128 v31, v[24:27] offset:8192
    v_accvgpr_read_b32 v24, a36
    v_accvgpr_read_b32 v25, a37
    v_accvgpr_read_b32 v26, a38
    v_accvgpr_read_b32 v27, a39
    s_nop 0
    v_mul_f32 v24, v24, v20
    v_mul_f32 v25, v25, v20
    v_mul_f32 v26, v26, v20
    v_mul_f32 v27, v27, v20
    ds_write_b128 v31, v[24:27] offset:9216
    v_accvgpr_read_b32 v24, a40
    v_accvgpr_read_b32 v25, a41
    v_accvgpr_read_b32 v26, a42
    v_accvgpr_read_b32 v27, a43
    s_nop 0
    v_mul_f32 v24, v24, v20
    v_mul_f32 v25, v25, v20
    v_mul_f32 v26, v26, v20
    v_mul_f32 v27, v27, v20
    ds_write_b128 v31, v[24:27] offset:10240
    v_accvgpr_read_b32 v24, a44
    v_accvgpr_read_b32 v25, a45
    v_accvgpr_read_b32 v26, a46
    v_accvgpr_read_b32 v27, a47
    s_nop 0
    v_mul_f32 v24, v24, v20
    v_mul_f32 v25, v25, v20
    v_mul_f32 v26, v26, v20
    v_mul_f32 v27, v27, v20
    ds_write_b128 v31, v[24:27] offset:11264
    v_accvgpr_read_b32 v24, a48
    v_accvgpr_read_b32 v25, a49
    v_accvgpr_read_b32 v26, a50
    v_accvgpr_read_b32 v27, a51
    s_nop 0
    v_mul_f32 v24, v24, v20
    v_mul_f32 v25, v25, v20
    v_mul_f32 v26, v26, v20
    v_mul_f32 v27, v27, v20
    ds_write_b128 v31, v[24:27] offset:12288
    v_accvgpr_read_b32 v24, a52
    v_accvgpr_read_b32 v25, a53
    v_accvgpr_read_b32 v26, a54
    v_accvgpr_read_b32 v27, a55
    s_nop 0
    v_mul_f32 v24, v24, v20
    v_mul_f32 v25, v25, v20
    v_mul_f32 v26, v26, v20
    v_mul_f32 v27, v27, v20
    ds_write_b128 v31, v[24:27] offset:13312
    v_accvgpr_read_b32 v24, a56
    v_accvgpr_read_b32 v25, a57
    v_accvgpr_read_b32 v26, a58
    v_accvgpr_read_b32 v27, a59
    s_nop 0
    v_mul_f32 v24, v24, v20
    v_mul_f32 v25, v25, v20
    v_mul_f32 v26, v26, v20
    v_mul_f32 v27, v27, v20
    ds_write_b128 v31, v[24:27] offset:14336
    v_accvgpr_read_b32 v24, a60
    v_accvgpr_read_b32 v25, a61
    v_accvgpr_read_b32 v26, a62
    v_accvgpr_read_b32 v27, a63
    s_nop 0
    v_mul_f32 v24, v24, v20
    v_mul_f32 v25, v25, v20
    v_mul_f32 v26, v26, v20
    v_mul_f32 v27, v27, v20
    ds_write_b128 v31, v[24:27] offset:15360
    v_accvgpr_read_b32 v24, a64
    v_accvgpr_read_b32 v25, a65
    v_accvgpr_read_b32 v26, a66
    v_accvgpr_read_b32 v27, a67
    s_nop 0
    v_mul_f32 v24, v24, v20
    v_mul_f32 v25, v25, v20
    v_mul_f32 v26, v26, v20
    v_mul_f32 v27, v27, v20
    ds_write_b128 v31, v[24:27] offset:16384
    v_accvgpr_read_b32 v24, a68
    v_accvgpr_read_b32 v25, a69
    v_accvgpr_read_b32 v26, a70
    v_accvgpr_read_b32 v27, a71
    s_nop 0
    v_mul_f32 v24, v24, v20
    v_mul_f32 v25, v25, v20
    v_mul_f32 v26, v26, v20
    v_mul_f32 v27, v27, v20
    ds_write_b128 v31, v[24:27] offset:17408
    v_accvgpr_read_b32 v24, a72
    v_accvgpr_read_b32 v25, a73
    v_accvgpr_read_b32 v26, a74
    v_accvgpr_read_b32 v27, a75
    s_nop 0
    v_mul_f32 v24, v24, v20
    v_mul_f32 v25, v25, v20
    v_mul_f32 v26, v26, v20
    v_mul_f32 v27, v27, v20
    ds_write_b128 v31, v[24:27] offset:18432
    v_accvgpr_read_b32 v24, a76
    v_accvgpr_read_b32 v25, a77
    v_accvgpr_read_b32 v26, a78
    v_accvgpr_read_b32 v27, a79
    s_nop 0
    v_mul_f32 v24, v24, v20
    v_mul_f32 v25, v25, v20
    v_mul_f32 v26, v26, v20
    v_mul_f32 v27, v27, v20
    ds_write_b128 v31, v[24:27] offset:19456
    v_accvgpr_read_b32 v24, a80
    v_accvgpr_read_b32 v25, a81
    v_accvgpr_read_b32 v26, a82
    v_accvgpr_read_b32 v27, a83
    s_nop 0
    v_mul_f32 v24, v24, v20
    v_mul_f32 v25, v25, v20
    v_mul_f32 v26, v26, v20
    v_mul_f32 v27, v27, v20
    ds_write_b128 v31, v[24:27] offset:20480
    v_accvgpr_read_b32 v24, a84
    v_accvgpr_read_b32 v25, a85
    v_accvgpr_read_b32 v26, a86
    v_accvgpr_read_b32 v27, a87
    s_nop 0
    v_mul_f32 v24, v24, v20
    v_mul_f32 v25, v25, v20
    v_mul_f32 v26, v26, v20
    v_mul_f32 v27, v27, v20
    ds_write_b128 v31, v[24:27] offset:21504
    v_accvgpr_read_b32 v24, a88
    v_accvgpr_read_b32 v25, a89
    v_accvgpr_read_b32 v26, a90
    v_accvgpr_read_b32 v27, a91
    s_nop 0
    v_mul_f32 v24, v24, v20
    v_mul_f32 v25, v25, v20
    v_mul_f32 v26, v26, v20
    v_mul_f32 v27, v27, v20
    ds_write_b128 v31, v[24:27] offset:22528
    v_accvgpr_read_b32 v24, a92
    v_accvgpr_read_b32 v25, a93
    v_accvgpr_read_b32 v26, a94
    v_accvgpr_read_b32 v27, a95
    s_nop 0
    v_mul_f32 v24, v24, v20
    v_mul_f32 v25, v25, v20
    v_mul_f32 v26, v26, v20
    v_mul_f32 v27, v27, v20
    ds_write_b128 v31, v[24:27] offset:23552
    v_accvgpr_read_b32 v24, a96
    v_accvgpr_read_b32 v25, a97
    v_accvgpr_read_b32 v26, a98
    v_accvgpr_read_b32 v27, a99
    s_nop 0
    v_mul_f32 v24, v24, v20
    v_mul_f32 v25, v25, v20
    v_mul_f32 v26, v26, v20
    v_mul_f32 v27, v27, v20
    ds_write_b128 v31, v[24:27] offset:24576
    v_accvgpr_read_b32 v24, a100
    v_accvgpr_read_b32 v25, a101
    v_accvgpr_read_b32 v26, a102
    v_accvgpr_read_b32 v27, a103
    s_nop 0
    v_mul_f32 v24, v24, v20
    v_mul_f32 v25, v25, v20
    v_mul_f32 v26, v26, v20
    v_mul_f32 v27, v27, v20
    ds_write_b128 v31, v[24:27] offset:25600
    v_accvgpr_read_b32 v24, a104
    v_accvgpr_read_b32 v25, a105
    v_accvgpr_read_b32 v26, a106
    v_accvgpr_read_b32 v27, a107
    s_nop 0
    v_mul_f32 v24, v24, v20
    v_mul_f32 v25, v25, v20
    v_mul_f32 v26, v26, v20
    v_mul_f32 v27, v27, v20
    ds_write_b128 v31, v[24:27] offset:26624
    v_accvgpr_read_b32 v24, a108
    v_accvgpr_read_b32 v25, a109
    v_accvgpr_read_b32 v26, a110
    v_accvgpr_read_b32 v27, a111
    s_nop 0
    v_mul_f32 v24, v24, v20
    v_mul_f32 v25, v25, v20
    v_mul_f32 v26, v26, v20
    v_mul_f32 v27, v27, v20
    ds_write_b128 v31, v[24:27] offset:27648
    v_accvgpr_read_b32 v24, a112
    v_accvgpr_read_b32 v25, a113
    v_accvgpr_read_b32 v26, a114
    v_accvgpr_read_b32 v27, a115
    s_nop 0
    v_mul_f32 v24, v24, v20
    v_mul_f32 v25, v25, v20
    v_mul_f32 v26, v26, v20
    v_mul_f32 v27, v27, v20
    ds_write_b128 v31, v[24:27] offset:28672
    v_accvgpr_read_b32 v24, a116
    v_accvgpr_read_b32 v25, a117
    v_accvgpr_read_b32 v26, a118
    v_accvgpr_read_b32 v27, a119
    s_nop 0
    v_mul_f32 v24, v24, v20
    v_mul_f32 v25, v25, v20
    v_mul_f32 v26, v26, v20
    v_mul_f32 v27, v27, v20
    ds_write_b128 v31, v[24:27] offset:29696
    v_accvgpr_read_b32 v24, a120
    v_accvgpr_read_b32 v25, a121
    v_accvgpr_read_b32 v26, a122
    v_accvgpr_read_b32 v27, a123
    s_nop 0
    v_mul_f32 v24, v24, v20
    v_mul_f32 v25, v25, v20
    v_mul_f32 v26, v26, v20
    v_mul_f32 v27, v27, v20
    ds_write_b128 v31, v[24:27] offset:30720
    v_accvgpr_read_b32 v24, a124
    v_accvgpr_read_b32 v25, a125
    v_accvgpr_read_b32 v26, a126
    v_accvgpr_read_b32 v27, a127
    s_nop 0
    v_mul_f32 v24, v24, v20
    v_mul_f32 v25, v25, v20
    v_mul_f32 v26, v26, v20
    v_mul_f32 v27, v27, v20
    ds_write_b128 v31, v[24:27] offset:31744
    s_waitcnt lgkmcnt(0)
    s_barrier
    s_lshl_b32 s34, s26, 13
    v_add_u32 v7, s34, v30
    v_add_u32 v8, 0x10000, v7
    ds_read_b128 v[32:35], v7 offset:0
    ds_read_b128 v[36:39], v7 offset:32768
    ds_read_b128 v[40:43], v8 offset:0
    ds_read_b128 v[44:47], v8 offset:32768
    s_waitcnt lgkmcnt(0)
    v_add_f32 v32, v32, v36
    v_add_f32 v40, v40, v44
    v_add_f32 v32, v32, v40
    v_add_f32 v33, v33, v37
    v_add_f32 v41, v41, v45
    v_add_f32 v33, v33, v41
    v_add_f32 v34, v34, v38
    v_add_f32 v42, v42, v46
    v_add_f32 v34, v34, v42
    v_add_f32 v35, v35, v39
    v_add_f32 v43, v43, v47
    v_add_f32 v35, v35, v43
    v_cvt_pk_bf16_f32 v28, v32, v33
    v_cvt_pk_bf16_f32 v29, v34, v35
    s_lshl_b32 s34, s26, 3
    s_add_u32 s34, s34, 0
    v_xor_b32 v9, s34, v6
    v_lshlrev_b32 v9, 4, v9
    v_add_u32 v9, v9, v5
    ds_write_b64 v9, v[28:29] offset:0
    ds_read_b128 v[32:35], v7 offset:1024
    ds_read_b128 v[36:39], v7 offset:33792
    ds_read_b128 v[40:43], v8 offset:1024
    ds_read_b128 v[44:47], v8 offset:33792
    s_waitcnt lgkmcnt(0)
    v_add_f32 v32, v32, v36
    v_add_f32 v40, v40, v44
    v_add_f32 v32, v32, v40
    v_add_f32 v33, v33, v37
    v_add_f32 v41, v41, v45
    v_add_f32 v33, v33, v41
    v_add_f32 v34, v34, v38
    v_add_f32 v42, v42, v46
    v_add_f32 v34, v34, v42
    v_add_f32 v35, v35, v39
    v_add_f32 v43, v43, v47
    v_add_f32 v35, v35, v43
    v_cvt_pk_bf16_f32 v28, v32, v33
    v_cvt_pk_bf16_f32 v29, v34, v35
    s_lshl_b32 s34, s26, 3
    s_add_u32 s34, s34, 1
    v_xor_b32 v9, s34, v6
    v_lshlrev_b32 v9, 4, v9
    v_add_u32 v9, v9, v5
    ds_write_b64 v9, v[28:29] offset:0
    ds_read_b128 v[32:35], v7 offset:2048
    ds_read_b128 v[36:39], v7 offset:34816
    ds_read_b128 v[40:43], v8 offset:2048
    ds_read_b128 v[44:47], v8 offset:34816
    s_waitcnt lgkmcnt(0)
    v_add_f32 v32, v32, v36
    v_add_f32 v40, v40, v44
    v_add_f32 v32, v32, v40
    v_add_f32 v33, v33, v37
    v_add_f32 v41, v41, v45
    v_add_f32 v33, v33, v41
    v_add_f32 v34, v34, v38
    v_add_f32 v42, v42, v46
    v_add_f32 v34, v34, v42
    v_add_f32 v35, v35, v39
    v_add_f32 v43, v43, v47
    v_add_f32 v35, v35, v43
    v_cvt_pk_bf16_f32 v28, v32, v33
    v_cvt_pk_bf16_f32 v29, v34, v35
    s_lshl_b32 s34, s26, 3
    s_add_u32 s34, s34, 2
    v_xor_b32 v9, s34, v6
    v_lshlrev_b32 v9, 4, v9
    v_add_u32 v9, v9, v5
    ds_write_b64 v9, v[28:29] offset:0
    ds_read_b128 v[32:35], v7 offset:3072
    ds_read_b128 v[36:39], v7 offset:35840
    ds_read_b128 v[40:43], v8 offset:3072
    ds_read_b128 v[44:47], v8 offset:35840
    s_waitcnt lgkmcnt(0)
    v_add_f32 v32, v32, v36
    v_add_f32 v40, v40, v44
    v_add_f32 v32, v32, v40
    v_add_f32 v33, v33, v37
    v_add_f32 v41, v41, v45
    v_add_f32 v33, v33, v41
    v_add_f32 v34, v34, v38
    v_add_f32 v42, v42, v46
    v_add_f32 v34, v34, v42
    v_add_f32 v35, v35, v39
    v_add_f32 v43, v43, v47
    v_add_f32 v35, v35, v43
    v_cvt_pk_bf16_f32 v28, v32, v33
    v_cvt_pk_bf16_f32 v29, v34, v35
    s_lshl_b32 s34, s26, 3
    s_add_u32 s34, s34, 3
    v_xor_b32 v9, s34, v6
    v_lshlrev_b32 v9, 4, v9
    v_add_u32 v9, v9, v5
    ds_write_b64 v9, v[28:29] offset:0
    ds_read_b128 v[32:35], v7 offset:4096
    ds_read_b128 v[36:39], v7 offset:36864
    ds_read_b128 v[40:43], v8 offset:4096
    ds_read_b128 v[44:47], v8 offset:36864
    s_waitcnt lgkmcnt(0)
    v_add_f32 v32, v32, v36
    v_add_f32 v40, v40, v44
    v_add_f32 v32, v32, v40
    v_add_f32 v33, v33, v37
    v_add_f32 v41, v41, v45
    v_add_f32 v33, v33, v41
    v_add_f32 v34, v34, v38
    v_add_f32 v42, v42, v46
    v_add_f32 v34, v34, v42
    v_add_f32 v35, v35, v39
    v_add_f32 v43, v43, v47
    v_add_f32 v35, v35, v43
    v_cvt_pk_bf16_f32 v28, v32, v33
    v_cvt_pk_bf16_f32 v29, v34, v35
    s_lshl_b32 s34, s26, 3
    s_add_u32 s34, s34, 4
    v_xor_b32 v9, s34, v6
    v_lshlrev_b32 v9, 4, v9
    v_add_u32 v9, v9, v5
    ds_write_b64 v9, v[28:29] offset:0
    ds_read_b128 v[32:35], v7 offset:5120
    ds_read_b128 v[36:39], v7 offset:37888
    ds_read_b128 v[40:43], v8 offset:5120
    ds_read_b128 v[44:47], v8 offset:37888
    s_waitcnt lgkmcnt(0)
    v_add_f32 v32, v32, v36
    v_add_f32 v40, v40, v44
    v_add_f32 v32, v32, v40
    v_add_f32 v33, v33, v37
    v_add_f32 v41, v41, v45
    v_add_f32 v33, v33, v41
    v_add_f32 v34, v34, v38
    v_add_f32 v42, v42, v46
    v_add_f32 v34, v34, v42
    v_add_f32 v35, v35, v39
    v_add_f32 v43, v43, v47
    v_add_f32 v35, v35, v43
    v_cvt_pk_bf16_f32 v28, v32, v33
    v_cvt_pk_bf16_f32 v29, v34, v35
    s_lshl_b32 s34, s26, 3
    s_add_u32 s34, s34, 5
    v_xor_b32 v9, s34, v6
    v_lshlrev_b32 v9, 4, v9
    v_add_u32 v9, v9, v5
    ds_write_b64 v9, v[28:29] offset:0
    ds_read_b128 v[32:35], v7 offset:6144
    ds_read_b128 v[36:39], v7 offset:38912
    ds_read_b128 v[40:43], v8 offset:6144
    ds_read_b128 v[44:47], v8 offset:38912
    s_waitcnt lgkmcnt(0)
    v_add_f32 v32, v32, v36
    v_add_f32 v40, v40, v44
    v_add_f32 v32, v32, v40
    v_add_f32 v33, v33, v37
    v_add_f32 v41, v41, v45
    v_add_f32 v33, v33, v41
    v_add_f32 v34, v34, v38
    v_add_f32 v42, v42, v46
    v_add_f32 v34, v34, v42
    v_add_f32 v35, v35, v39
    v_add_f32 v43, v43, v47
    v_add_f32 v35, v35, v43
    v_cvt_pk_bf16_f32 v28, v32, v33
    v_cvt_pk_bf16_f32 v29, v34, v35
    s_lshl_b32 s34, s26, 3
    s_add_u32 s34, s34, 6
    v_xor_b32 v9, s34, v6
    v_lshlrev_b32 v9, 4, v9
    v_add_u32 v9, v9, v5
    ds_write_b64 v9, v[28:29] offset:0
    ds_read_b128 v[32:35], v7 offset:7168
    ds_read_b128 v[36:39], v7 offset:39936
    ds_read_b128 v[40:43], v8 offset:7168
    ds_read_b128 v[44:47], v8 offset:39936
    s_waitcnt lgkmcnt(0)
    v_add_f32 v32, v32, v36
    v_add_f32 v40, v40, v44
    v_add_f32 v32, v32, v40
    v_add_f32 v33, v33, v37
    v_add_f32 v41, v41, v45
    v_add_f32 v33, v33, v41
    v_add_f32 v34, v34, v38
    v_add_f32 v42, v42, v46
    v_add_f32 v34, v34, v42
    v_add_f32 v35, v35, v39
    v_add_f32 v43, v43, v47
    v_add_f32 v35, v35, v43
    v_cvt_pk_bf16_f32 v28, v32, v33
    v_cvt_pk_bf16_f32 v29, v34, v35
    s_lshl_b32 s34, s26, 3
    s_add_u32 s34, s34, 7
    v_xor_b32 v9, s34, v6
    v_lshlrev_b32 v9, 4, v9
    v_add_u32 v9, v9, v5
    ds_write_b64 v9, v[28:29] offset:0
    s_waitcnt lgkmcnt(0)
    s_barrier
    v_accvgpr_read_b32 v24, a128
    v_accvgpr_read_b32 v25, a129
    v_accvgpr_read_b32 v26, a130
    v_accvgpr_read_b32 v27, a131
    s_nop 0
    v_mul_f32 v24, v24, v21
    v_mul_f32 v25, v25, v21
    v_mul_f32 v26, v26, v21
    v_mul_f32 v27, v27, v21
    ds_write_b128 v31, v[24:27] offset:0
    v_accvgpr_read_b32 v24, a132
    v_accvgpr_read_b32 v25, a133
    v_accvgpr_read_b32 v26, a134
    v_accvgpr_read_b32 v27, a135
    s_nop 0
    v_mul_f32 v24, v24, v21
    v_mul_f32 v25, v25, v21
    v_mul_f32 v26, v26, v21
    v_mul_f32 v27, v27, v21
    ds_write_b128 v31, v[24:27] offset:1024
    v_accvgpr_read_b32 v24, a136
    v_accvgpr_read_b32 v25, a137
    v_accvgpr_read_b32 v26, a138
    v_accvgpr_read_b32 v27, a139
    s_nop 0
    v_mul_f32 v24, v24, v21
    v_mul_f32 v25, v25, v21
    v_mul_f32 v26, v26, v21
    v_mul_f32 v27, v27, v21
    ds_write_b128 v31, v[24:27] offset:2048
    v_accvgpr_read_b32 v24, a140
    v_accvgpr_read_b32 v25, a141
    v_accvgpr_read_b32 v26, a142
    v_accvgpr_read_b32 v27, a143
    s_nop 0
    v_mul_f32 v24, v24, v21
    v_mul_f32 v25, v25, v21
    v_mul_f32 v26, v26, v21
    v_mul_f32 v27, v27, v21
    ds_write_b128 v31, v[24:27] offset:3072
    v_accvgpr_read_b32 v24, a144
    v_accvgpr_read_b32 v25, a145
    v_accvgpr_read_b32 v26, a146
    v_accvgpr_read_b32 v27, a147
    s_nop 0
    v_mul_f32 v24, v24, v21
    v_mul_f32 v25, v25, v21
    v_mul_f32 v26, v26, v21
    v_mul_f32 v27, v27, v21
    ds_write_b128 v31, v[24:27] offset:4096
    v_accvgpr_read_b32 v24, a148
    v_accvgpr_read_b32 v25, a149
    v_accvgpr_read_b32 v26, a150
    v_accvgpr_read_b32 v27, a151
    s_nop 0
    v_mul_f32 v24, v24, v21
    v_mul_f32 v25, v25, v21
    v_mul_f32 v26, v26, v21
    v_mul_f32 v27, v27, v21
    ds_write_b128 v31, v[24:27] offset:5120
    v_accvgpr_read_b32 v24, a152
    v_accvgpr_read_b32 v25, a153
    v_accvgpr_read_b32 v26, a154
    v_accvgpr_read_b32 v27, a155
    s_nop 0
    v_mul_f32 v24, v24, v21
    v_mul_f32 v25, v25, v21
    v_mul_f32 v26, v26, v21
    v_mul_f32 v27, v27, v21
    ds_write_b128 v31, v[24:27] offset:6144
    v_accvgpr_read_b32 v24, a156
    v_accvgpr_read_b32 v25, a157
    v_accvgpr_read_b32 v26, a158
    v_accvgpr_read_b32 v27, a159
    s_nop 0
    v_mul_f32 v24, v24, v21
    v_mul_f32 v25, v25, v21
    v_mul_f32 v26, v26, v21
    v_mul_f32 v27, v27, v21
    ds_write_b128 v31, v[24:27] offset:7168
    v_accvgpr_read_b32 v24, a160
    v_accvgpr_read_b32 v25, a161
    v_accvgpr_read_b32 v26, a162
    v_accvgpr_read_b32 v27, a163
    s_nop 0
    v_mul_f32 v24, v24, v21
    v_mul_f32 v25, v25, v21
    v_mul_f32 v26, v26, v21
    v_mul_f32 v27, v27, v21
    ds_write_b128 v31, v[24:27] offset:8192
    v_accvgpr_read_b32 v24, a164
    v_accvgpr_read_b32 v25, a165
    v_accvgpr_read_b32 v26, a166
    v_accvgpr_read_b32 v27, a167
    s_nop 0
    v_mul_f32 v24, v24, v21
    v_mul_f32 v25, v25, v21
    v_mul_f32 v26, v26, v21
    v_mul_f32 v27, v27, v21
    ds_write_b128 v31, v[24:27] offset:9216
    v_accvgpr_read_b32 v24, a168
    v_accvgpr_read_b32 v25, a169
    v_accvgpr_read_b32 v26, a170
    v_accvgpr_read_b32 v27, a171
    s_nop 0
    v_mul_f32 v24, v24, v21
    v_mul_f32 v25, v25, v21
    v_mul_f32 v26, v26, v21
    v_mul_f32 v27, v27, v21
    ds_write_b128 v31, v[24:27] offset:10240
    v_accvgpr_read_b32 v24, a172
    v_accvgpr_read_b32 v25, a173
    v_accvgpr_read_b32 v26, a174
    v_accvgpr_read_b32 v27, a175
    s_nop 0
    v_mul_f32 v24, v24, v21
    v_mul_f32 v25, v25, v21
    v_mul_f32 v26, v26, v21
    v_mul_f32 v27, v27, v21
    ds_write_b128 v31, v[24:27] offset:11264
    v_accvgpr_read_b32 v24, a176
    v_accvgpr_read_b32 v25, a177
    v_accvgpr_read_b32 v26, a178
    v_accvgpr_read_b32 v27, a179
    s_nop 0
    v_mul_f32 v24, v24, v21
    v_mul_f32 v25, v25, v21
    v_mul_f32 v26, v26, v21
    v_mul_f32 v27, v27, v21
    ds_write_b128 v31, v[24:27] offset:12288
    v_accvgpr_read_b32 v24, a180
    v_accvgpr_read_b32 v25, a181
    v_accvgpr_read_b32 v26, a182
    v_accvgpr_read_b32 v27, a183
    s_nop 0
    v_mul_f32 v24, v24, v21
    v_mul_f32 v25, v25, v21
    v_mul_f32 v26, v26, v21
    v_mul_f32 v27, v27, v21
    ds_write_b128 v31, v[24:27] offset:13312
    v_accvgpr_read_b32 v24, a184
    v_accvgpr_read_b32 v25, a185
    v_accvgpr_read_b32 v26, a186
    v_accvgpr_read_b32 v27, a187
    s_nop 0
    v_mul_f32 v24, v24, v21
    v_mul_f32 v25, v25, v21
    v_mul_f32 v26, v26, v21
    v_mul_f32 v27, v27, v21
    ds_write_b128 v31, v[24:27] offset:14336
    v_accvgpr_read_b32 v24, a188
    v_accvgpr_read_b32 v25, a189
    v_accvgpr_read_b32 v26, a190
    v_accvgpr_read_b32 v27, a191
    s_nop 0
    v_mul_f32 v24, v24, v21
    v_mul_f32 v25, v25, v21
    v_mul_f32 v26, v26, v21
    v_mul_f32 v27, v27, v21
    ds_write_b128 v31, v[24:27] offset:15360
    v_accvgpr_read_b32 v24, a192
    v_accvgpr_read_b32 v25, a193
    v_accvgpr_read_b32 v26, a194
    v_accvgpr_read_b32 v27, a195
    s_nop 0
    v_mul_f32 v24, v24, v21
    v_mul_f32 v25, v25, v21
    v_mul_f32 v26, v26, v21
    v_mul_f32 v27, v27, v21
    ds_write_b128 v31, v[24:27] offset:16384
    v_accvgpr_read_b32 v24, a196
    v_accvgpr_read_b32 v25, a197
    v_accvgpr_read_b32 v26, a198
    v_accvgpr_read_b32 v27, a199
    s_nop 0
    v_mul_f32 v24, v24, v21
    v_mul_f32 v25, v25, v21
    v_mul_f32 v26, v26, v21
    v_mul_f32 v27, v27, v21
    ds_write_b128 v31, v[24:27] offset:17408
    v_accvgpr_read_b32 v24, a200
    v_accvgpr_read_b32 v25, a201
    v_accvgpr_read_b32 v26, a202
    v_accvgpr_read_b32 v27, a203
    s_nop 0
    v_mul_f32 v24, v24, v21
    v_mul_f32 v25, v25, v21
    v_mul_f32 v26, v26, v21
    v_mul_f32 v27, v27, v21
    ds_write_b128 v31, v[24:27] offset:18432
    v_accvgpr_read_b32 v24, a204
    v_accvgpr_read_b32 v25, a205
    v_accvgpr_read_b32 v26, a206
    v_accvgpr_read_b32 v27, a207
    s_nop 0
    v_mul_f32 v24, v24, v21
    v_mul_f32 v25, v25, v21
    v_mul_f32 v26, v26, v21
    v_mul_f32 v27, v27, v21
    ds_write_b128 v31, v[24:27] offset:19456
    v_accvgpr_read_b32 v24, a208
    v_accvgpr_read_b32 v25, a209
    v_accvgpr_read_b32 v26, a210
    v_accvgpr_read_b32 v27, a211
    s_nop 0
    v_mul_f32 v24, v24, v21
    v_mul_f32 v25, v25, v21
    v_mul_f32 v26, v26, v21
    v_mul_f32 v27, v27, v21
    ds_write_b128 v31, v[24:27] offset:20480
    v_accvgpr_read_b32 v24, a212
    v_accvgpr_read_b32 v25, a213
    v_accvgpr_read_b32 v26, a214
    v_accvgpr_read_b32 v27, a215
    s_nop 0
    v_mul_f32 v24, v24, v21
    v_mul_f32 v25, v25, v21
    v_mul_f32 v26, v26, v21
    v_mul_f32 v27, v27, v21
    ds_write_b128 v31, v[24:27] offset:21504
    v_accvgpr_read_b32 v24, a216
    v_accvgpr_read_b32 v25, a217
    v_accvgpr_read_b32 v26, a218
    v_accvgpr_read_b32 v27, a219
    s_nop 0
    v_mul_f32 v24, v24, v21
    v_mul_f32 v25, v25, v21
    v_mul_f32 v26, v26, v21
    v_mul_f32 v27, v27, v21
    ds_write_b128 v31, v[24:27] offset:22528
    v_accvgpr_read_b32 v24, a220
    v_accvgpr_read_b32 v25, a221
    v_accvgpr_read_b32 v26, a222
    v_accvgpr_read_b32 v27, a223
    s_nop 0
    v_mul_f32 v24, v24, v21
    v_mul_f32 v25, v25, v21
    v_mul_f32 v26, v26, v21
    v_mul_f32 v27, v27, v21
    ds_write_b128 v31, v[24:27] offset:23552
    v_accvgpr_read_b32 v24, a224
    v_accvgpr_read_b32 v25, a225
    v_accvgpr_read_b32 v26, a226
    v_accvgpr_read_b32 v27, a227
    s_nop 0
    v_mul_f32 v24, v24, v21
    v_mul_f32 v25, v25, v21
    v_mul_f32 v26, v26, v21
    v_mul_f32 v27, v27, v21
    ds_write_b128 v31, v[24:27] offset:24576
    v_accvgpr_read_b32 v24, a228
    v_accvgpr_read_b32 v25, a229
    v_accvgpr_read_b32 v26, a230
    v_accvgpr_read_b32 v27, a231
    s_nop 0
    v_mul_f32 v24, v24, v21
    v_mul_f32 v25, v25, v21
    v_mul_f32 v26, v26, v21
    v_mul_f32 v27, v27, v21
    ds_write_b128 v31, v[24:27] offset:25600
    v_accvgpr_read_b32 v24, a232
    v_accvgpr_read_b32 v25, a233
    v_accvgpr_read_b32 v26, a234
    v_accvgpr_read_b32 v27, a235
    s_nop 0
    v_mul_f32 v24, v24, v21
    v_mul_f32 v25, v25, v21
    v_mul_f32 v26, v26, v21
    v_mul_f32 v27, v27, v21
    ds_write_b128 v31, v[24:27] offset:26624
    v_accvgpr_read_b32 v24, a236
    v_accvgpr_read_b32 v25, a237
    v_accvgpr_read_b32 v26, a238
    v_accvgpr_read_b32 v27, a239
    s_nop 0
    v_mul_f32 v24, v24, v21
    v_mul_f32 v25, v25, v21
    v_mul_f32 v26, v26, v21
    v_mul_f32 v27, v27, v21
    ds_write_b128 v31, v[24:27] offset:27648
    v_accvgpr_read_b32 v24, a240
    v_accvgpr_read_b32 v25, a241
    v_accvgpr_read_b32 v26, a242
    v_accvgpr_read_b32 v27, a243
    s_nop 0
    v_mul_f32 v24, v24, v21
    v_mul_f32 v25, v25, v21
    v_mul_f32 v26, v26, v21
    v_mul_f32 v27, v27, v21
    ds_write_b128 v31, v[24:27] offset:28672
    v_accvgpr_read_b32 v24, a244
    v_accvgpr_read_b32 v25, a245
    v_accvgpr_read_b32 v26, a246
    v_accvgpr_read_b32 v27, a247
    s_nop 0
    v_mul_f32 v24, v24, v21
    v_mul_f32 v25, v25, v21
    v_mul_f32 v26, v26, v21
    v_mul_f32 v27, v27, v21
    ds_write_b128 v31, v[24:27] offset:29696
    v_accvgpr_read_b32 v24, a248
    v_accvgpr_read_b32 v25, a249
    v_accvgpr_read_b32 v26, a250
    v_accvgpr_read_b32 v27, a251
    s_nop 0
    v_mul_f32 v24, v24, v21
    v_mul_f32 v25, v25, v21
    v_mul_f32 v26, v26, v21
    v_mul_f32 v27, v27, v21
    ds_write_b128 v31, v[24:27] offset:30720
    v_accvgpr_read_b32 v24, a252
    v_accvgpr_read_b32 v25, a253
    v_accvgpr_read_b32 v26, a254
    v_accvgpr_read_b32 v27, a255
    s_nop 0
    v_mul_f32 v24, v24, v21
    v_mul_f32 v25, v25, v21
    v_mul_f32 v26, v26, v21
    v_mul_f32 v27, v27, v21
    ds_write_b128 v31, v[24:27] offset:31744
    s_waitcnt lgkmcnt(0)
    s_barrier
    s_lshl_b32 s34, s26, 13
    v_add_u32 v7, s34, v30
    v_add_u32 v8, 0x10000, v7
    ds_read_b128 v[32:35], v7 offset:0
    ds_read_b128 v[36:39], v7 offset:32768
    ds_read_b128 v[40:43], v8 offset:0
    ds_read_b128 v[44:47], v8 offset:32768
    s_waitcnt lgkmcnt(0)
    v_add_f32 v32, v32, v36
    v_add_f32 v40, v40, v44
    v_add_f32 v32, v32, v40
    v_add_f32 v33, v33, v37
    v_add_f32 v41, v41, v45
    v_add_f32 v33, v33, v41
    v_add_f32 v34, v34, v38
    v_add_f32 v42, v42, v46
    v_add_f32 v34, v34, v42
    v_add_f32 v35, v35, v39
    v_add_f32 v43, v43, v47
    v_add_f32 v35, v35, v43
    v_cvt_pk_bf16_f32 v28, v32, v33
    v_cvt_pk_bf16_f32 v29, v34, v35
    s_lshl_b32 s34, s26, 3
    s_add_u32 s34, s34, 0
    v_xor_b32 v9, s34, v6
    v_lshlrev_b32 v9, 4, v9
    v_add_u32 v9, v9, v5
    ds_write_b64 v9, v[28:29] offset:16384
    ds_read_b128 v[32:35], v7 offset:1024
    ds_read_b128 v[36:39], v7 offset:33792
    ds_read_b128 v[40:43], v8 offset:1024
    ds_read_b128 v[44:47], v8 offset:33792
    s_waitcnt lgkmcnt(0)
    v_add_f32 v32, v32, v36
    v_add_f32 v40, v40, v44
    v_add_f32 v32, v32, v40
    v_add_f32 v33, v33, v37
    v_add_f32 v41, v41, v45
    v_add_f32 v33, v33, v41
    v_add_f32 v34, v34, v38
    v_add_f32 v42, v42, v46
    v_add_f32 v34, v34, v42
    v_add_f32 v35, v35, v39
    v_add_f32 v43, v43, v47
    v_add_f32 v35, v35, v43
    v_cvt_pk_bf16_f32 v28, v32, v33
    v_cvt_pk_bf16_f32 v29, v34, v35
    s_lshl_b32 s34, s26, 3
    s_add_u32 s34, s34, 1
    v_xor_b32 v9, s34, v6
    v_lshlrev_b32 v9, 4, v9
    v_add_u32 v9, v9, v5
    ds_write_b64 v9, v[28:29] offset:16384
    ds_read_b128 v[32:35], v7 offset:2048
    ds_read_b128 v[36:39], v7 offset:34816
    ds_read_b128 v[40:43], v8 offset:2048
    ds_read_b128 v[44:47], v8 offset:34816
    s_waitcnt lgkmcnt(0)
    v_add_f32 v32, v32, v36
    v_add_f32 v40, v40, v44
    v_add_f32 v32, v32, v40
    v_add_f32 v33, v33, v37
    v_add_f32 v41, v41, v45
    v_add_f32 v33, v33, v41
    v_add_f32 v34, v34, v38
    v_add_f32 v42, v42, v46
    v_add_f32 v34, v34, v42
    v_add_f32 v35, v35, v39
    v_add_f32 v43, v43, v47
    v_add_f32 v35, v35, v43
    v_cvt_pk_bf16_f32 v28, v32, v33
    v_cvt_pk_bf16_f32 v29, v34, v35
    s_lshl_b32 s34, s26, 3
    s_add_u32 s34, s34, 2
    v_xor_b32 v9, s34, v6
    v_lshlrev_b32 v9, 4, v9
    v_add_u32 v9, v9, v5
    ds_write_b64 v9, v[28:29] offset:16384
    ds_read_b128 v[32:35], v7 offset:3072
    ds_read_b128 v[36:39], v7 offset:35840
    ds_read_b128 v[40:43], v8 offset:3072
    ds_read_b128 v[44:47], v8 offset:35840
    s_waitcnt lgkmcnt(0)
    v_add_f32 v32, v32, v36
    v_add_f32 v40, v40, v44
    v_add_f32 v32, v32, v40
    v_add_f32 v33, v33, v37
    v_add_f32 v41, v41, v45
    v_add_f32 v33, v33, v41
    v_add_f32 v34, v34, v38
    v_add_f32 v42, v42, v46
    v_add_f32 v34, v34, v42
    v_add_f32 v35, v35, v39
    v_add_f32 v43, v43, v47
    v_add_f32 v35, v35, v43
    v_cvt_pk_bf16_f32 v28, v32, v33
    v_cvt_pk_bf16_f32 v29, v34, v35
    s_lshl_b32 s34, s26, 3
    s_add_u32 s34, s34, 3
    v_xor_b32 v9, s34, v6
    v_lshlrev_b32 v9, 4, v9
    v_add_u32 v9, v9, v5
    ds_write_b64 v9, v[28:29] offset:16384
    ds_read_b128 v[32:35], v7 offset:4096
    ds_read_b128 v[36:39], v7 offset:36864
    ds_read_b128 v[40:43], v8 offset:4096
    ds_read_b128 v[44:47], v8 offset:36864
    s_waitcnt lgkmcnt(0)
    v_add_f32 v32, v32, v36
    v_add_f32 v40, v40, v44
    v_add_f32 v32, v32, v40
    v_add_f32 v33, v33, v37
    v_add_f32 v41, v41, v45
    v_add_f32 v33, v33, v41
    v_add_f32 v34, v34, v38
    v_add_f32 v42, v42, v46
    v_add_f32 v34, v34, v42
    v_add_f32 v35, v35, v39
    v_add_f32 v43, v43, v47
    v_add_f32 v35, v35, v43
    v_cvt_pk_bf16_f32 v28, v32, v33
    v_cvt_pk_bf16_f32 v29, v34, v35
    s_lshl_b32 s34, s26, 3
    s_add_u32 s34, s34, 4
    v_xor_b32 v9, s34, v6
    v_lshlrev_b32 v9, 4, v9
    v_add_u32 v9, v9, v5
    ds_write_b64 v9, v[28:29] offset:16384
    ds_read_b128 v[32:35], v7 offset:5120
    ds_read_b128 v[36:39], v7 offset:37888
    ds_read_b128 v[40:43], v8 offset:5120
    ds_read_b128 v[44:47], v8 offset:37888
    s_waitcnt lgkmcnt(0)
    v_add_f32 v32, v32, v36
    v_add_f32 v40, v40, v44
    v_add_f32 v32, v32, v40
    v_add_f32 v33, v33, v37
    v_add_f32 v41, v41, v45
    v_add_f32 v33, v33, v41
    v_add_f32 v34, v34, v38
    v_add_f32 v42, v42, v46
    v_add_f32 v34, v34, v42
    v_add_f32 v35, v35, v39
    v_add_f32 v43, v43, v47
    v_add_f32 v35, v35, v43
    v_cvt_pk_bf16_f32 v28, v32, v33
    v_cvt_pk_bf16_f32 v29, v34, v35
    s_lshl_b32 s34, s26, 3
    s_add_u32 s34, s34, 5
    v_xor_b32 v9, s34, v6
    v_lshlrev_b32 v9, 4, v9
    v_add_u32 v9, v9, v5
    ds_write_b64 v9, v[28:29] offset:16384
    ds_read_b128 v[32:35], v7 offset:6144
    ds_read_b128 v[36:39], v7 offset:38912
    ds_read_b128 v[40:43], v8 offset:6144
    ds_read_b128 v[44:47], v8 offset:38912
    s_waitcnt lgkmcnt(0)
    v_add_f32 v32, v32, v36
    v_add_f32 v40, v40, v44
    v_add_f32 v32, v32, v40
    v_add_f32 v33, v33, v37
    v_add_f32 v41, v41, v45
    v_add_f32 v33, v33, v41
    v_add_f32 v34, v34, v38
    v_add_f32 v42, v42, v46
    v_add_f32 v34, v34, v42
    v_add_f32 v35, v35, v39
    v_add_f32 v43, v43, v47
    v_add_f32 v35, v35, v43
    v_cvt_pk_bf16_f32 v28, v32, v33
    v_cvt_pk_bf16_f32 v29, v34, v35
    s_lshl_b32 s34, s26, 3
    s_add_u32 s34, s34, 6
    v_xor_b32 v9, s34, v6
    v_lshlrev_b32 v9, 4, v9
    v_add_u32 v9, v9, v5
    ds_write_b64 v9, v[28:29] offset:16384
    ds_read_b128 v[32:35], v7 offset:7168
    ds_read_b128 v[36:39], v7 offset:39936
    ds_read_b128 v[40:43], v8 offset:7168
    ds_read_b128 v[44:47], v8 offset:39936
    s_waitcnt lgkmcnt(0)
    v_add_f32 v32, v32, v36
    v_add_f32 v40, v40, v44
    v_add_f32 v32, v32, v40
    v_add_f32 v33, v33, v37
    v_add_f32 v41, v41, v45
    v_add_f32 v33, v33, v41
    v_add_f32 v34, v34, v38
    v_add_f32 v42, v42, v46
    v_add_f32 v34, v34, v42
    v_add_f32 v35, v35, v39
    v_add_f32 v43, v43, v47
    v_add_f32 v35, v35, v43
    v_cvt_pk_bf16_f32 v28, v32, v33
    v_cvt_pk_bf16_f32 v29, v34, v35
    s_lshl_b32 s34, s26, 3
    s_add_u32 s34, s34, 7
    v_xor_b32 v9, s34, v6
    v_lshlrev_b32 v9, 4, v9
    v_add_u32 v9, v9, v5
    ds_write_b64 v9, v[28:29] offset:16384
    s_waitcnt lgkmcnt(0)
    s_barrier
    s_mov_b32 s36, s40
    s_and_b32 s37, s41, 0xffff
    s_mov_b32 s38, 0x380000
    s_mov_b32 s39, 0x00020000
    s_add_u32 s20, s42, 0
    s_and_b32 s21, s43, 0xffff
    s_mov_b32 s22, 0x1880000
    s_mov_b32 s23, 0x00020000
    s_lshl_b32 s35, s26, 7
    s_min_u32 s35, s35, 320
    v_lshrrev_b32 v7, 4, v1
    v_and_b32 v8, 15, v1
    v_lshrrev_b32 v9, 2, v8
    v_xor_b32 v9, v9, v7
    v_lshlrev_b32 v9, 2, v9
    v_and_b32 v8, 3, v8
    v_or_b32 v9, v9, v8
    v_lshlrev_b32 v9, 4, v9
    s_movk_i32 s34, 896
    v_mul_lo_u32 v7, v7, s34
    v_add_u32 v2, v7, v9
    s_lshl_b32 s34, s35, 1
    v_add_u32 v2, s34, v2
    s_lshl_b32 s31, s26, 15
    s_mul_i32 s30, s29, 229376
    s_add_u32 m0, s31, 0
    s_add_u32 s34, s30, 0
    buffer_load_dwordx4 v2, s[36:39], s34 offen lds
    s_add_u32 m0, s31, 1024
    s_add_u32 s34, s30, 3584
    buffer_load_dwordx4 v2, s[36:39], s34 offen lds
    s_add_u32 m0, s31, 2048
    s_add_u32 s34, s30, 7168
    buffer_load_dwordx4 v2, s[36:39], s34 offen lds
    s_add_u32 m0, s31, 3072
    s_add_u32 s34, s30, 10752
    buffer_load_dwordx4 v2, s[36:39], s34 offen lds
    s_add_u32 m0, s31, 4096
    s_add_u32 s34, s30, 14336
    buffer_load_dwordx4 v2, s[36:39], s34 offen lds
    s_add_u32 m0, s31, 5120
    s_add_u32 s34, s30, 17920
    buffer_load_dwordx4 v2, s[36:39], s34 offen lds
    s_add_u32 m0, s31, 6144
    s_add_u32 s34, s30, 21504
    buffer_load_dwordx4 v2, s[36:39], s34 offen lds
    s_add_u32 m0, s31, 7168
    s_add_u32 s34, s30, 25088
    buffer_load_dwordx4 v2, s[36:39], s34 offen lds
    s_add_u32 m0, s31, 8192
    s_add_u32 s34, s30, 28672
    buffer_load_dwordx4 v2, s[36:39], s34 offen lds
    s_add_u32 m0, s31, 9216
    s_add_u32 s34, s30, 32256
    buffer_load_dwordx4 v2, s[36:39], s34 offen lds
    s_add_u32 m0, s31, 10240
    s_add_u32 s34, s30, 35840
    buffer_load_dwordx4 v2, s[36:39], s34 offen lds
    s_add_u32 m0, s31, 11264
    s_add_u32 s34, s30, 39424
    buffer_load_dwordx4 v2, s[36:39], s34 offen lds
    s_add_u32 m0, s31, 12288
    s_add_u32 s34, s30, 43008
    buffer_load_dwordx4 v2, s[36:39], s34 offen lds
    s_add_u32 m0, s31, 13312
    s_add_u32 s34, s30, 46592
    buffer_load_dwordx4 v2, s[36:39], s34 offen lds
    s_add_u32 m0, s31, 14336
    s_add_u32 s34, s30, 50176
    buffer_load_dwordx4 v2, s[36:39], s34 offen lds
    s_add_u32 m0, s31, 15360
    s_add_u32 s34, s30, 53760
    buffer_load_dwordx4 v2, s[36:39], s34 offen lds
    s_add_u32 m0, s31, 16384
    s_add_u32 s34, s30, 57344
    buffer_load_dwordx4 v2, s[36:39], s34 offen lds
    s_add_u32 m0, s31, 17408
    s_add_u32 s34, s30, 60928
    buffer_load_dwordx4 v2, s[36:39], s34 offen lds
    s_add_u32 m0, s31, 18432
    s_add_u32 s34, s30, 64512
    buffer_load_dwordx4 v2, s[36:39], s34 offen lds
    s_add_u32 m0, s31, 19456
    s_add_u32 s34, s30, 68096
    buffer_load_dwordx4 v2, s[36:39], s34 offen lds
    s_add_u32 m0, s31, 20480
    s_add_u32 s34, s30, 71680
    buffer_load_dwordx4 v2, s[36:39], s34 offen lds
    s_add_u32 m0, s31, 21504
    s_add_u32 s34, s30, 75264
    buffer_load_dwordx4 v2, s[36:39], s34 offen lds
    s_add_u32 m0, s31, 22528
    s_add_u32 s34, s30, 78848
    buffer_load_dwordx4 v2, s[36:39], s34 offen lds
    s_add_u32 m0, s31, 23552
    s_add_u32 s34, s30, 82432
    buffer_load_dwordx4 v2, s[36:39], s34 offen lds
    s_add_u32 m0, s31, 24576
    s_add_u32 s34, s30, 86016
    buffer_load_dwordx4 v2, s[36:39], s34 offen lds
    s_add_u32 m0, s31, 25600
    s_add_u32 s34, s30, 89600
    buffer_load_dwordx4 v2, s[36:39], s34 offen lds
    s_add_u32 m0, s31, 26624
    s_add_u32 s34, s30, 93184
    buffer_load_dwordx4 v2, s[36:39], s34 offen lds
    s_add_u32 m0, s31, 27648
    s_add_u32 s34, s30, 96768
    buffer_load_dwordx4 v2, s[36:39], s34 offen lds
    s_add_u32 m0, s31, 28672
    s_add_u32 s34, s30, 100352
    buffer_load_dwordx4 v2, s[36:39], s34 offen lds
    s_add_u32 m0, s31, 29696
    s_add_u32 s34, s30, 103936
    buffer_load_dwordx4 v2, s[36:39], s34 offen lds
    s_add_u32 m0, s31, 30720
    s_add_u32 s34, s30, 107520
    buffer_load_dwordx4 v2, s[36:39], s34 offen lds
    s_add_u32 m0, s31, 31744
    s_add_u32 s34, s30, 111104
    buffer_load_dwordx4 v2, s[36:39], s34 offen lds
    v_lshlrev_b32 v5, 9, v3
    v_and_b32 v6, 7, v3
    v_add_u32 v24, 0, v4
    v_xor_b32 v24, v24, v6
    v_lshlrev_b32 v24, 4, v24
    v_add_u32 v24, v24, v5
    v_add_u32 v8, 0x20000, v24
    v_add_u32 v24, 2, v4
    v_xor_b32 v24, v24, v6
    v_lshlrev_b32 v24, 4, v24
    v_add_u32 v24, v24, v5
    v_add_u32 v9, 0x20000, v24
    v_add_u32 v24, 4, v4
    v_xor_b32 v24, v24, v6
    v_lshlrev_b32 v24, 4, v24
    v_add_u32 v24, v24, v5
    v_add_u32 v10, 0x20000, v24
    v_add_u32 v24, 6, v4
    v_xor_b32 v24, v24, v6
    v_lshlrev_b32 v24, 4, v24
    v_add_u32 v24, v24, v5
    v_add_u32 v11, 0x20000, v24
    ds_read_b128 v[128:131], v8 offset:0
    ds_read_b128 v[132:135], v9 offset:0
    ds_read_b128 v[136:139], v10 offset:0
    ds_read_b128 v[140:143], v11 offset:0
    ds_read_b128 v[144:147], v8 offset:128
    ds_read_b128 v[148:151], v9 offset:128
    ds_read_b128 v[152:155], v10 offset:128
    ds_read_b128 v[156:159], v11 offset:128
    ds_read_b128 v[160:163], v8 offset:256
    ds_read_b128 v[164:167], v9 offset:256
    ds_read_b128 v[168:171], v10 offset:256
    ds_read_b128 v[172:175], v11 offset:256
    ds_read_b128 v[176:179], v8 offset:384
    ds_read_b128 v[180:183], v9 offset:384
    ds_read_b128 v[184:187], v10 offset:384
    ds_read_b128 v[188:191], v11 offset:384
    ds_read_b128 v[192:195], v8 offset:16384
    ds_read_b128 v[196:199], v9 offset:16384
    ds_read_b128 v[200:203], v10 offset:16384
    ds_read_b128 v[204:207], v11 offset:16384
    ds_read_b128 v[208:211], v8 offset:16512
    ds_read_b128 v[212:215], v9 offset:16512
    ds_read_b128 v[216:219], v10 offset:16512
    ds_read_b128 v[220:223], v11 offset:16512
    ds_read_b128 v[224:227], v8 offset:16640
    ds_read_b128 v[228:231], v9 offset:16640
    ds_read_b128 v[232:235], v10 offset:16640
    ds_read_b128 v[236:239], v11 offset:16640
    ds_read_b128 v[240:243], v8 offset:16768
    ds_read_b128 v[244:247], v9 offset:16768
    ds_read_b128 v[248:251], v10 offset:16768
    ds_read_b128 v[252:255], v11 offset:16768
    s_waitcnt lgkmcnt(0)
    v_and_b32 v5, 15, v1
    v_lshrrev_b32 v5, 2, v5
    v_lshlrev_b32 v6, 3, v4
    v_add_u32 v6, v6, v5
    v_lshlrev_b32 v6, 8, v6
    v_lshrrev_b32 v7, 4, v1
    v_and_b32 v7, 1, v7
    v_lshlrev_b32 v7, 5, v7
    v_add_u32 v6, v6, v7
    v_and_b32 v7, 3, v1
    v_lshlrev_b32 v7, 3, v7
    v_add_u32 v6, v6, v7
    v_add_u32 v6, s31, v6
    v_xor_b32 v7, 0, v5
    v_lshlrev_b32 v7, 6, v7
    v_add_u32 v16, v6, v7
    v_xor_b32 v7, 1, v5
    v_lshlrev_b32 v7, 6, v7
    v_add_u32 v17, v6, v7
    v_xor_b32 v7, 2, v5
    v_lshlrev_b32 v7, 6, v7
    v_add_u32 v18, v6, v7
    v_xor_b32 v7, 3, v5
    v_lshlrev_b32 v7, 6, v7
    v_add_u32 v19, v6, v7
    s_waitcnt vmcnt(24)
    ds_read_b64_tr_b16 v[32:33], v16 offset:0
    ds_read_b64_tr_b16 v[34:35], v16 offset:1024
    ds_read_b64_tr_b16 v[36:37], v17 offset:0
    ds_read_b64_tr_b16 v[38:39], v17 offset:1024
    ds_read_b64_tr_b16 v[40:41], v18 offset:0
    ds_read_b64_tr_b16 v[42:43], v18 offset:1024
    ds_read_b64_tr_b16 v[44:45], v19 offset:0
    ds_read_b64_tr_b16 v[46:47], v19 offset:1024
    s_waitcnt lgkmcnt(0)
    v_mfma_f32_32x32x16_bf16 a[0:15], v[32:35], v[128:131], 0
    v_mfma_f32_32x32x16_bf16 a[16:31], v[32:35], v[192:195], 0
    v_mfma_f32_32x32x16_bf16 a[32:47], v[36:39], v[128:131], 0
    v_mfma_f32_32x32x16_bf16 a[48:63], v[36:39], v[192:195], 0
    v_mfma_f32_32x32x16_bf16 a[64:79], v[40:43], v[128:131], 0
    v_mfma_f32_32x32x16_bf16 a[80:95], v[40:43], v[192:195], 0
    v_mfma_f32_32x32x16_bf16 a[96:111], v[44:47], v[128:131], 0
    v_mfma_f32_32x32x16_bf16 a[112:127], v[44:47], v[192:195], 0
    ds_read_b64_tr_b16 v[48:49], v16 offset:4096
    ds_read_b64_tr_b16 v[50:51], v16 offset:5120
    ds_read_b64_tr_b16 v[52:53], v17 offset:4096
    ds_read_b64_tr_b16 v[54:55], v17 offset:5120
    ds_read_b64_tr_b16 v[56:57], v18 offset:4096
    ds_read_b64_tr_b16 v[58:59], v18 offset:5120
    ds_read_b64_tr_b16 v[60:61], v19 offset:4096
    ds_read_b64_tr_b16 v[62:63], v19 offset:5120
    s_waitcnt lgkmcnt(0)
    v_mfma_f32_32x32x16_bf16 a[0:15], v[48:51], v[132:135], a[0:15]
    v_mfma_f32_32x32x16_bf16 a[16:31], v[48:51], v[196:199], a[16:31]
    v_mfma_f32_32x32x16_bf16 a[32:47], v[52:55], v[132:135], a[32:47]
    v_mfma_f32_32x32x16_bf16 a[48:63], v[52:55], v[196:199], a[48:63]
    v_mfma_f32_32x32x16_bf16 a[64:79], v[56:59], v[132:135], a[64:79]
    v_mfma_f32_32x32x16_bf16 a[80:95], v[56:59], v[196:199], a[80:95]
    v_mfma_f32_32x32x16_bf16 a[96:111], v[60:63], v[132:135], a[96:111]
    v_mfma_f32_32x32x16_bf16 a[112:127], v[60:63], v[196:199], a[112:127]
    s_add_u32 m0, s31, 0
    s_add_u32 s34, s30, 114688
    buffer_load_dwordx4 v2, s[36:39], s34 offen lds
    s_add_u32 m0, s31, 1024
    s_add_u32 s34, s30, 118272
    buffer_load_dwordx4 v2, s[36:39], s34 offen lds
    s_add_u32 m0, s31, 2048
    s_add_u32 s34, s30, 121856
    buffer_load_dwordx4 v2, s[36:39], s34 offen lds
    s_add_u32 m0, s31, 3072
    s_add_u32 s34, s30, 125440
    buffer_load_dwordx4 v2, s[36:39], s34 offen lds
    s_add_u32 m0, s31, 4096
    s_add_u32 s34, s30, 129024
    buffer_load_dwordx4 v2, s[36:39], s34 offen lds
    s_add_u32 m0, s31, 5120
    s_add_u32 s34, s30, 132608
    buffer_load_dwordx4 v2, s[36:39], s34 offen lds
    s_add_u32 m0, s31, 6144
    s_add_u32 s34, s30, 136192
    buffer_load_dwordx4 v2, s[36:39], s34 offen lds
    s_add_u32 m0, s31, 7168
    s_add_u32 s34, s30, 139776
    buffer_load_dwordx4 v2, s[36:39], s34 offen lds
    s_waitcnt vmcnt(24)
    ds_read_b64_tr_b16 v[32:33], v16 offset:8192
    ds_read_b64_tr_b16 v[34:35], v16 offset:9216
    ds_read_b64_tr_b16 v[36:37], v17 offset:8192
    ds_read_b64_tr_b16 v[38:39], v17 offset:9216
    ds_read_b64_tr_b16 v[40:41], v18 offset:8192
    ds_read_b64_tr_b16 v[42:43], v18 offset:9216
    ds_read_b64_tr_b16 v[44:45], v19 offset:8192
    ds_read_b64_tr_b16 v[46:47], v19 offset:9216
    s_waitcnt lgkmcnt(0)
    v_mfma_f32_32x32x16_bf16 a[0:15], v[32:35], v[136:139], a[0:15]
    v_mfma_f32_32x32x16_bf16 a[16:31], v[32:35], v[200:203], a[16:31]
    v_mfma_f32_32x32x16_bf16 a[32:47], v[36:39], v[136:139], a[32:47]
    v_mfma_f32_32x32x16_bf16 a[48:63], v[36:39], v[200:203], a[48:63]
    v_mfma_f32_32x32x16_bf16 a[64:79], v[40:43], v[136:139], a[64:79]
    v_mfma_f32_32x32x16_bf16 a[80:95], v[40:43], v[200:203], a[80:95]
    v_mfma_f32_32x32x16_bf16 a[96:111], v[44:47], v[136:139], a[96:111]
    v_mfma_f32_32x32x16_bf16 a[112:127], v[44:47], v[200:203], a[112:127]
    ds_read_b64_tr_b16 v[48:49], v16 offset:12288
    ds_read_b64_tr_b16 v[50:51], v16 offset:13312
    ds_read_b64_tr_b16 v[52:53], v17 offset:12288
    ds_read_b64_tr_b16 v[54:55], v17 offset:13312
    ds_read_b64_tr_b16 v[56:57], v18 offset:12288
    ds_read_b64_tr_b16 v[58:59], v18 offset:13312
    ds_read_b64_tr_b16 v[60:61], v19 offset:12288
    ds_read_b64_tr_b16 v[62:63], v19 offset:13312
    s_waitcnt lgkmcnt(0)
    v_mfma_f32_32x32x16_bf16 a[0:15], v[48:51], v[140:143], a[0:15]
    v_mfma_f32_32x32x16_bf16 a[16:31], v[48:51], v[204:207], a[16:31]
    v_mfma_f32_32x32x16_bf16 a[32:47], v[52:55], v[140:143], a[32:47]
    v_mfma_f32_32x32x16_bf16 a[48:63], v[52:55], v[204:207], a[48:63]
    v_mfma_f32_32x32x16_bf16 a[64:79], v[56:59], v[140:143], a[64:79]
    v_mfma_f32_32x32x16_bf16 a[80:95], v[56:59], v[204:207], a[80:95]
    v_mfma_f32_32x32x16_bf16 a[96:111], v[60:63], v[140:143], a[96:111]
    v_mfma_f32_32x32x16_bf16 a[112:127], v[60:63], v[204:207], a[112:127]
    s_add_u32 m0, s31, 8192
    s_add_u32 s34, s30, 143360
    buffer_load_dwordx4 v2, s[36:39], s34 offen lds
    s_add_u32 m0, s31, 9216
    s_add_u32 s34, s30, 146944
    buffer_load_dwordx4 v2, s[36:39], s34 offen lds
    s_add_u32 m0, s31, 10240
    s_add_u32 s34, s30, 150528
    buffer_load_dwordx4 v2, s[36:39], s34 offen lds
    s_add_u32 m0, s31, 11264
    s_add_u32 s34, s30, 154112
    buffer_load_dwordx4 v2, s[36:39], s34 offen lds
    s_add_u32 m0, s31, 12288
    s_add_u32 s34, s30, 157696
    buffer_load_dwordx4 v2, s[36:39], s34 offen lds
    s_add_u32 m0, s31, 13312
    s_add_u32 s34, s30, 161280
    buffer_load_dwordx4 v2, s[36:39], s34 offen lds
    s_add_u32 m0, s31, 14336
    s_add_u32 s34, s30, 164864
    buffer_load_dwordx4 v2, s[36:39], s34 offen lds
    s_add_u32 m0, s31, 15360
    s_add_u32 s34, s30, 168448
    buffer_load_dwordx4 v2, s[36:39], s34 offen lds
    s_waitcnt vmcnt(24)
    ds_read_b64_tr_b16 v[32:33], v16 offset:16384
    ds_read_b64_tr_b16 v[34:35], v16 offset:17408
    ds_read_b64_tr_b16 v[36:37], v17 offset:16384
    ds_read_b64_tr_b16 v[38:39], v17 offset:17408
    ds_read_b64_tr_b16 v[40:41], v18 offset:16384
    ds_read_b64_tr_b16 v[42:43], v18 offset:17408
    ds_read_b64_tr_b16 v[44:45], v19 offset:16384
    ds_read_b64_tr_b16 v[46:47], v19 offset:17408
    s_waitcnt lgkmcnt(0)
    v_mfma_f32_32x32x16_bf16 a[0:15], v[32:35], v[144:147], a[0:15]
    v_mfma_f32_32x32x16_bf16 a[16:31], v[32:35], v[208:211], a[16:31]
    v_mfma_f32_32x32x16_bf16 a[32:47], v[36:39], v[144:147], a[32:47]
    v_mfma_f32_32x32x16_bf16 a[48:63], v[36:39], v[208:211], a[48:63]
    v_mfma_f32_32x32x16_bf16 a[64:79], v[40:43], v[144:147], a[64:79]
    v_mfma_f32_32x32x16_bf16 a[80:95], v[40:43], v[208:211], a[80:95]
    v_mfma_f32_32x32x16_bf16 a[96:111], v[44:47], v[144:147], a[96:111]
    v_mfma_f32_32x32x16_bf16 a[112:127], v[44:47], v[208:211], a[112:127]
    ds_read_b64_tr_b16 v[48:49], v16 offset:20480
    ds_read_b64_tr_b16 v[50:51], v16 offset:21504
    ds_read_b64_tr_b16 v[52:53], v17 offset:20480
    ds_read_b64_tr_b16 v[54:55], v17 offset:21504
    ds_read_b64_tr_b16 v[56:57], v18 offset:20480
    ds_read_b64_tr_b16 v[58:59], v18 offset:21504
    ds_read_b64_tr_b16 v[60:61], v19 offset:20480
    ds_read_b64_tr_b16 v[62:63], v19 offset:21504
    s_waitcnt lgkmcnt(0)
    v_mfma_f32_32x32x16_bf16 a[0:15], v[48:51], v[148:151], a[0:15]
    v_mfma_f32_32x32x16_bf16 a[16:31], v[48:51], v[212:215], a[16:31]
    v_mfma_f32_32x32x16_bf16 a[32:47], v[52:55], v[148:151], a[32:47]
    v_mfma_f32_32x32x16_bf16 a[48:63], v[52:55], v[212:215], a[48:63]
    v_mfma_f32_32x32x16_bf16 a[64:79], v[56:59], v[148:151], a[64:79]
    v_mfma_f32_32x32x16_bf16 a[80:95], v[56:59], v[212:215], a[80:95]
    v_mfma_f32_32x32x16_bf16 a[96:111], v[60:63], v[148:151], a[96:111]
    v_mfma_f32_32x32x16_bf16 a[112:127], v[60:63], v[212:215], a[112:127]
    s_add_u32 m0, s31, 16384
    s_add_u32 s34, s30, 172032
    buffer_load_dwordx4 v2, s[36:39], s34 offen lds
    s_add_u32 m0, s31, 17408
    s_add_u32 s34, s30, 175616
    buffer_load_dwordx4 v2, s[36:39], s34 offen lds
    s_add_u32 m0, s31, 18432
    s_add_u32 s34, s30, 179200
    buffer_load_dwordx4 v2, s[36:39], s34 offen lds
    s_add_u32 m0, s31, 19456
    s_add_u32 s34, s30, 182784
    buffer_load_dwordx4 v2, s[36:39], s34 offen lds
    s_add_u32 m0, s31, 20480
    s_add_u32 s34, s30, 186368
    buffer_load_dwordx4 v2, s[36:39], s34 offen lds
    s_add_u32 m0, s31, 21504
    s_add_u32 s34, s30, 189952
    buffer_load_dwordx4 v2, s[36:39], s34 offen lds
    s_add_u32 m0, s31, 22528
    s_add_u32 s34, s30, 193536
    buffer_load_dwordx4 v2, s[36:39], s34 offen lds
    s_add_u32 m0, s31, 23552
    s_add_u32 s34, s30, 197120
    buffer_load_dwordx4 v2, s[36:39], s34 offen lds
    s_waitcnt vmcnt(24)
    ds_read_b64_tr_b16 v[32:33], v16 offset:24576
    ds_read_b64_tr_b16 v[34:35], v16 offset:25600
    ds_read_b64_tr_b16 v[36:37], v17 offset:24576
    ds_read_b64_tr_b16 v[38:39], v17 offset:25600
    ds_read_b64_tr_b16 v[40:41], v18 offset:24576
    ds_read_b64_tr_b16 v[42:43], v18 offset:25600
    ds_read_b64_tr_b16 v[44:45], v19 offset:24576
    ds_read_b64_tr_b16 v[46:47], v19 offset:25600
    s_waitcnt lgkmcnt(0)
    v_mfma_f32_32x32x16_bf16 a[0:15], v[32:35], v[152:155], a[0:15]
    v_mfma_f32_32x32x16_bf16 a[16:31], v[32:35], v[216:219], a[16:31]
    v_mfma_f32_32x32x16_bf16 a[32:47], v[36:39], v[152:155], a[32:47]
    v_mfma_f32_32x32x16_bf16 a[48:63], v[36:39], v[216:219], a[48:63]
    v_mfma_f32_32x32x16_bf16 a[64:79], v[40:43], v[152:155], a[64:79]
    v_mfma_f32_32x32x16_bf16 a[80:95], v[40:43], v[216:219], a[80:95]
    v_mfma_f32_32x32x16_bf16 a[96:111], v[44:47], v[152:155], a[96:111]
    v_mfma_f32_32x32x16_bf16 a[112:127], v[44:47], v[216:219], a[112:127]
    ds_read_b64_tr_b16 v[48:49], v16 offset:28672
    ds_read_b64_tr_b16 v[50:51], v16 offset:29696
    ds_read_b64_tr_b16 v[52:53], v17 offset:28672
    ds_read_b64_tr_b16 v[54:55], v17 offset:29696
    ds_read_b64_tr_b16 v[56:57], v18 offset:28672
    ds_read_b64_tr_b16 v[58:59], v18 offset:29696
    ds_read_b64_tr_b16 v[60:61], v19 offset:28672
    ds_read_b64_tr_b16 v[62:63], v19 offset:29696
    s_waitcnt lgkmcnt(0)
    v_mfma_f32_32x32x16_bf16 a[0:15], v[48:51], v[156:159], a[0:15]
    v_mfma_f32_32x32x16_bf16 a[16:31], v[48:51], v[220:223], a[16:31]
    v_mfma_f32_32x32x16_bf16 a[32:47], v[52:55], v[156:159], a[32:47]
    v_mfma_f32_32x32x16_bf16 a[48:63], v[52:55], v[220:223], a[48:63]
    v_mfma_f32_32x32x16_bf16 a[64:79], v[56:59], v[156:159], a[64:79]
    v_mfma_f32_32x32x16_bf16 a[80:95], v[56:59], v[220:223], a[80:95]
    v_mfma_f32_32x32x16_bf16 a[96:111], v[60:63], v[156:159], a[96:111]
    v_mfma_f32_32x32x16_bf16 a[112:127], v[60:63], v[220:223], a[112:127]
    s_add_u32 m0, s31, 24576
    s_add_u32 s34, s30, 200704
    buffer_load_dwordx4 v2, s[36:39], s34 offen lds
    s_add_u32 m0, s31, 25600
    s_add_u32 s34, s30, 204288
    buffer_load_dwordx4 v2, s[36:39], s34 offen lds
    s_add_u32 m0, s31, 26624
    s_add_u32 s34, s30, 207872
    buffer_load_dwordx4 v2, s[36:39], s34 offen lds
    s_add_u32 m0, s31, 27648
    s_add_u32 s34, s30, 211456
    buffer_load_dwordx4 v2, s[36:39], s34 offen lds
    s_add_u32 m0, s31, 28672
    s_add_u32 s34, s30, 215040
    buffer_load_dwordx4 v2, s[36:39], s34 offen lds
    s_add_u32 m0, s31, 29696
    s_add_u32 s34, s30, 218624
    buffer_load_dwordx4 v2, s[36:39], s34 offen lds
    s_add_u32 m0, s31, 30720
    s_add_u32 s34, s30, 222208
    buffer_load_dwordx4 v2, s[36:39], s34 offen lds
    s_add_u32 m0, s31, 31744
    s_add_u32 s34, s30, 225792
    buffer_load_dwordx4 v2, s[36:39], s34 offen lds
    s_waitcnt vmcnt(24)
    ds_read_b64_tr_b16 v[32:33], v16 offset:0
    ds_read_b64_tr_b16 v[34:35], v16 offset:1024
    ds_read_b64_tr_b16 v[36:37], v17 offset:0
    ds_read_b64_tr_b16 v[38:39], v17 offset:1024
    ds_read_b64_tr_b16 v[40:41], v18 offset:0
    ds_read_b64_tr_b16 v[42:43], v18 offset:1024
    ds_read_b64_tr_b16 v[44:45], v19 offset:0
    ds_read_b64_tr_b16 v[46:47], v19 offset:1024
    s_waitcnt lgkmcnt(0)
    v_mfma_f32_32x32x16_bf16 a[0:15], v[32:35], v[160:163], a[0:15]
    v_mfma_f32_32x32x16_bf16 a[16:31], v[32:35], v[224:227], a[16:31]
    v_mfma_f32_32x32x16_bf16 a[32:47], v[36:39], v[160:163], a[32:47]
    v_mfma_f32_32x32x16_bf16 a[48:63], v[36:39], v[224:227], a[48:63]
    v_mfma_f32_32x32x16_bf16 a[64:79], v[40:43], v[160:163], a[64:79]
    v_mfma_f32_32x32x16_bf16 a[80:95], v[40:43], v[224:227], a[80:95]
    v_mfma_f32_32x32x16_bf16 a[96:111], v[44:47], v[160:163], a[96:111]
    v_mfma_f32_32x32x16_bf16 a[112:127], v[44:47], v[224:227], a[112:127]
    ds_read_b64_tr_b16 v[48:49], v16 offset:4096
    ds_read_b64_tr_b16 v[50:51], v16 offset:5120
    ds_read_b64_tr_b16 v[52:53], v17 offset:4096
    ds_read_b64_tr_b16 v[54:55], v17 offset:5120
    ds_read_b64_tr_b16 v[56:57], v18 offset:4096
    ds_read_b64_tr_b16 v[58:59], v18 offset:5120
    ds_read_b64_tr_b16 v[60:61], v19 offset:4096
    ds_read_b64_tr_b16 v[62:63], v19 offset:5120
    s_waitcnt lgkmcnt(0)
    v_mfma_f32_32x32x16_bf16 a[0:15], v[48:51], v[164:167], a[0:15]
    v_mfma_f32_32x32x16_bf16 a[16:31], v[48:51], v[228:231], a[16:31]
    v_mfma_f32_32x32x16_bf16 a[32:47], v[52:55], v[164:167], a[32:47]
    v_mfma_f32_32x32x16_bf16 a[48:63], v[52:55], v[228:231], a[48:63]
    v_mfma_f32_32x32x16_bf16 a[64:79], v[56:59], v[164:167], a[64:79]
    v_mfma_f32_32x32x16_bf16 a[80:95], v[56:59], v[228:231], a[80:95]
    v_mfma_f32_32x32x16_bf16 a[96:111], v[60:63], v[164:167], a[96:111]
    v_mfma_f32_32x32x16_bf16 a[112:127], v[60:63], v[228:231], a[112:127]
    s_waitcnt vmcnt(16)
    ds_read_b64_tr_b16 v[32:33], v16 offset:8192
    ds_read_b64_tr_b16 v[34:35], v16 offset:9216
    ds_read_b64_tr_b16 v[36:37], v17 offset:8192
    ds_read_b64_tr_b16 v[38:39], v17 offset:9216
    ds_read_b64_tr_b16 v[40:41], v18 offset:8192
    ds_read_b64_tr_b16 v[42:43], v18 offset:9216
    ds_read_b64_tr_b16 v[44:45], v19 offset:8192
    ds_read_b64_tr_b16 v[46:47], v19 offset:9216
    s_waitcnt lgkmcnt(0)
    v_mfma_f32_32x32x16_bf16 a[0:15], v[32:35], v[168:171], a[0:15]
    v_mfma_f32_32x32x16_bf16 a[16:31], v[32:35], v[232:235], a[16:31]
    v_mfma_f32_32x32x16_bf16 a[32:47], v[36:39], v[168:171], a[32:47]
    v_mfma_f32_32x32x16_bf16 a[48:63], v[36:39], v[232:235], a[48:63]
    v_mfma_f32_32x32x16_bf16 a[64:79], v[40:43], v[168:171], a[64:79]
    v_mfma_f32_32x32x16_bf16 a[80:95], v[40:43], v[232:235], a[80:95]
    v_mfma_f32_32x32x16_bf16 a[96:111], v[44:47], v[168:171], a[96:111]
    v_mfma_f32_32x32x16_bf16 a[112:127], v[44:47], v[232:235], a[112:127]
    ds_read_b64_tr_b16 v[48:49], v16 offset:12288
    ds_read_b64_tr_b16 v[50:51], v16 offset:13312
    ds_read_b64_tr_b16 v[52:53], v17 offset:12288
    ds_read_b64_tr_b16 v[54:55], v17 offset:13312
    ds_read_b64_tr_b16 v[56:57], v18 offset:12288
    ds_read_b64_tr_b16 v[58:59], v18 offset:13312
    ds_read_b64_tr_b16 v[60:61], v19 offset:12288
    ds_read_b64_tr_b16 v[62:63], v19 offset:13312
    s_waitcnt lgkmcnt(0)
    v_mfma_f32_32x32x16_bf16 a[0:15], v[48:51], v[172:175], a[0:15]
    v_mfma_f32_32x32x16_bf16 a[16:31], v[48:51], v[236:239], a[16:31]
    v_mfma_f32_32x32x16_bf16 a[32:47], v[52:55], v[172:175], a[32:47]
    v_mfma_f32_32x32x16_bf16 a[48:63], v[52:55], v[236:239], a[48:63]
    v_mfma_f32_32x32x16_bf16 a[64:79], v[56:59], v[172:175], a[64:79]
    v_mfma_f32_32x32x16_bf16 a[80:95], v[56:59], v[236:239], a[80:95]
    v_mfma_f32_32x32x16_bf16 a[96:111], v[60:63], v[172:175], a[96:111]
    v_mfma_f32_32x32x16_bf16 a[112:127], v[60:63], v[236:239], a[112:127]
    s_waitcnt vmcnt(8)
    ds_read_b64_tr_b16 v[32:33], v16 offset:16384
    ds_read_b64_tr_b16 v[34:35], v16 offset:17408
    ds_read_b64_tr_b16 v[36:37], v17 offset:16384
    ds_read_b64_tr_b16 v[38:39], v17 offset:17408
    ds_read_b64_tr_b16 v[40:41], v18 offset:16384
    ds_read_b64_tr_b16 v[42:43], v18 offset:17408
    ds_read_b64_tr_b16 v[44:45], v19 offset:16384
    ds_read_b64_tr_b16 v[46:47], v19 offset:17408
    s_waitcnt lgkmcnt(0)
    v_mfma_f32_32x32x16_bf16 a[0:15], v[32:35], v[176:179], a[0:15]
    v_mfma_f32_32x32x16_bf16 a[16:31], v[32:35], v[240:243], a[16:31]
    v_mfma_f32_32x32x16_bf16 a[32:47], v[36:39], v[176:179], a[32:47]
    v_mfma_f32_32x32x16_bf16 a[48:63], v[36:39], v[240:243], a[48:63]
    v_mfma_f32_32x32x16_bf16 a[64:79], v[40:43], v[176:179], a[64:79]
    v_mfma_f32_32x32x16_bf16 a[80:95], v[40:43], v[240:243], a[80:95]
    v_mfma_f32_32x32x16_bf16 a[96:111], v[44:47], v[176:179], a[96:111]
    v_mfma_f32_32x32x16_bf16 a[112:127], v[44:47], v[240:243], a[112:127]
    ds_read_b64_tr_b16 v[48:49], v16 offset:20480
    ds_read_b64_tr_b16 v[50:51], v16 offset:21504
    ds_read_b64_tr_b16 v[52:53], v17 offset:20480
    ds_read_b64_tr_b16 v[54:55], v17 offset:21504
    ds_read_b64_tr_b16 v[56:57], v18 offset:20480
    ds_read_b64_tr_b16 v[58:59], v18 offset:21504
    ds_read_b64_tr_b16 v[60:61], v19 offset:20480
    ds_read_b64_tr_b16 v[62:63], v19 offset:21504
    s_waitcnt lgkmcnt(0)
    v_mfma_f32_32x32x16_bf16 a[0:15], v[48:51], v[180:183], a[0:15]
    v_mfma_f32_32x32x16_bf16 a[16:31], v[48:51], v[244:247], a[16:31]
    v_mfma_f32_32x32x16_bf16 a[32:47], v[52:55], v[180:183], a[32:47]
    v_mfma_f32_32x32x16_bf16 a[48:63], v[52:55], v[244:247], a[48:63]
    v_mfma_f32_32x32x16_bf16 a[64:79], v[56:59], v[180:183], a[64:79]
    v_mfma_f32_32x32x16_bf16 a[80:95], v[56:59], v[244:247], a[80:95]
    v_mfma_f32_32x32x16_bf16 a[96:111], v[60:63], v[180:183], a[96:111]
    v_mfma_f32_32x32x16_bf16 a[112:127], v[60:63], v[244:247], a[112:127]
    s_waitcnt vmcnt(0)
    ds_read_b64_tr_b16 v[32:33], v16 offset:24576
    ds_read_b64_tr_b16 v[34:35], v16 offset:25600
    ds_read_b64_tr_b16 v[36:37], v17 offset:24576
    ds_read_b64_tr_b16 v[38:39], v17 offset:25600
    ds_read_b64_tr_b16 v[40:41], v18 offset:24576
    ds_read_b64_tr_b16 v[42:43], v18 offset:25600
    ds_read_b64_tr_b16 v[44:45], v19 offset:24576
    ds_read_b64_tr_b16 v[46:47], v19 offset:25600
    s_waitcnt lgkmcnt(0)
    v_mfma_f32_32x32x16_bf16 a[0:15], v[32:35], v[184:187], a[0:15]
    v_mfma_f32_32x32x16_bf16 a[16:31], v[32:35], v[248:251], a[16:31]
    v_mfma_f32_32x32x16_bf16 a[32:47], v[36:39], v[184:187], a[32:47]
    v_mfma_f32_32x32x16_bf16 a[48:63], v[36:39], v[248:251], a[48:63]
    v_mfma_f32_32x32x16_bf16 a[64:79], v[40:43], v[184:187], a[64:79]
    v_mfma_f32_32x32x16_bf16 a[80:95], v[40:43], v[248:251], a[80:95]
    v_mfma_f32_32x32x16_bf16 a[96:111], v[44:47], v[184:187], a[96:111]
    v_mfma_f32_32x32x16_bf16 a[112:127], v[44:47], v[248:251], a[112:127]
    ds_read_b64_tr_b16 v[48:49], v16 offset:28672
    ds_read_b64_tr_b16 v[50:51], v16 offset:29696
    ds_read_b64_tr_b16 v[52:53], v17 offset:28672
    ds_read_b64_tr_b16 v[54:55], v17 offset:29696
    ds_read_b64_tr_b16 v[56:57], v18 offset:28672
    ds_read_b64_tr_b16 v[58:59], v18 offset:29696
    ds_read_b64_tr_b16 v[60:61], v19 offset:28672
    ds_read_b64_tr_b16 v[62:63], v19 offset:29696
    s_waitcnt lgkmcnt(0)
    v_mfma_f32_32x32x16_bf16 a[0:15], v[48:51], v[188:191], a[0:15]
    v_mfma_f32_32x32x16_bf16 a[16:31], v[48:51], v[252:255], a[16:31]
    v_mfma_f32_32x32x16_bf16 a[32:47], v[52:55], v[188:191], a[32:47]
    v_mfma_f32_32x32x16_bf16 a[48:63], v[52:55], v[252:255], a[48:63]
    v_mfma_f32_32x32x16_bf16 a[64:79], v[56:59], v[188:191], a[64:79]
    v_mfma_f32_32x32x16_bf16 a[80:95], v[56:59], v[252:255], a[80:95]
    v_mfma_f32_32x32x16_bf16 a[96:111], v[60:63], v[188:191], a[96:111]
    v_mfma_f32_32x32x16_bf16 a[112:127], v[60:63], v[252:255], a[112:127]
    s_nop 15
    s_mul_i32 s34, s29, 896
    s_mul_i32 s30, s28, 112
    s_add_u32 s34, s34, s30
    s_add_u32 s34, s34, s27
    v_add_u32 v5, s34, v3
    s_movk_i32 s30, 1792
    v_mul_lo_u32 v5, v5, s30
    s_lshl_b32 s34, s35, 2
    v_add_u32 v5, s34, v5
    v_lshlrev_b32 v6, 4, v4
    v_add_u32 v5, v5, v6
    v_add_u32 v6, 57344, v5
    v_cmp_gt_u32 vcc, 24, v3
    v_mov_b32 v7, 0x80000000
    s_nop 1
    v_cndmask_b32 v6, v7, v6, vcc
    v_accvgpr_read_b32 v24, a0
    v_accvgpr_read_b32 v25, a1
    v_accvgpr_read_b32 v26, a2
    v_accvgpr_read_b32 v27, a3
    s_nop 0
    buffer_store_dwordx4 v[24:27], v5, s[20:23], 0 offen offset:0
    s_nop 1
    v_accvgpr_read_b32 v28, a4
    v_accvgpr_read_b32 v29, a5
    v_accvgpr_read_b32 v30, a6
    v_accvgpr_read_b32 v31, a7
    s_nop 0
    buffer_store_dwordx4 v[28:31], v5, s[20:23], 0 offen offset:32
    s_nop 1
    v_accvgpr_read_b32 v24, a8
    v_accvgpr_read_b32 v25, a9
    v_accvgpr_read_b32 v26, a10
    v_accvgpr_read_b32 v27, a11
    s_nop 0
    buffer_store_dwordx4 v[24:27], v5, s[20:23], 0 offen offset:64
    s_nop 1
    v_accvgpr_read_b32 v28, a12
    v_accvgpr_read_b32 v29, a13
    v_accvgpr_read_b32 v30, a14
    v_accvgpr_read_b32 v31, a15
    s_nop 0
    buffer_store_dwordx4 v[28:31], v5, s[20:23], 0 offen offset:96
    s_nop 1
    v_accvgpr_read_b32 v24, a16
    v_accvgpr_read_b32 v25, a17
    v_accvgpr_read_b32 v26, a18
    v_accvgpr_read_b32 v27, a19
    s_nop 0
    buffer_store_dwordx4 v[24:27], v6, s[20:23], 0 offen offset:0
    s_nop 1
    v_accvgpr_read_b32 v28, a20
    v_accvgpr_read_b32 v29, a21
    v_accvgpr_read_b32 v30, a22
    v_accvgpr_read_b32 v31, a23
    s_nop 0
    buffer_store_dwordx4 v[28:31], v6, s[20:23], 0 offen offset:32
    s_nop 1
    v_accvgpr_read_b32 v24, a24
    v_accvgpr_read_b32 v25, a25
    v_accvgpr_read_b32 v26, a26
    v_accvgpr_read_b32 v27, a27
    s_nop 0
    buffer_store_dwordx4 v[24:27], v6, s[20:23], 0 offen offset:64
    s_nop 1
    v_accvgpr_read_b32 v28, a28
    v_accvgpr_read_b32 v29, a29
    v_accvgpr_read_b32 v30, a30
    v_accvgpr_read_b32 v31, a31
    s_nop 0
    buffer_store_dwordx4 v[28:31], v6, s[20:23], 0 offen offset:96
    s_nop 1
    v_accvgpr_read_b32 v24, a32
    v_accvgpr_read_b32 v25, a33
    v_accvgpr_read_b32 v26, a34
    v_accvgpr_read_b32 v27, a35
    s_nop 0
    buffer_store_dwordx4 v[24:27], v5, s[20:23], 0 offen offset:128
    s_nop 1
    v_accvgpr_read_b32 v28, a36
    v_accvgpr_read_b32 v29, a37
    v_accvgpr_read_b32 v30, a38
    v_accvgpr_read_b32 v31, a39
    s_nop 0
    buffer_store_dwordx4 v[28:31], v5, s[20:23], 0 offen offset:160
    s_nop 1
    v_accvgpr_read_b32 v24, a40
    v_accvgpr_read_b32 v25, a41
    v_accvgpr_read_b32 v26, a42
    v_accvgpr_read_b32 v27, a43
    s_nop 0
    buffer_store_dwordx4 v[24:27], v5, s[20:23], 0 offen offset:192
    s_nop 1
    v_accvgpr_read_b32 v28, a44
    v_accvgpr_read_b32 v29, a45
    v_accvgpr_read_b32 v30, a46
    v_accvgpr_read_b32 v31, a47
    s_nop 0
    buffer_store_dwordx4 v[28:31], v5, s[20:23], 0 offen offset:224
    s_nop 1
    v_accvgpr_read_b32 v24, a48
    v_accvgpr_read_b32 v25, a49
    v_accvgpr_read_b32 v26, a50
    v_accvgpr_read_b32 v27, a51
    s_nop 0
    buffer_store_dwordx4 v[24:27], v6, s[20:23], 0 offen offset:128
    s_nop 1
    v_accvgpr_read_b32 v28, a52
    v_accvgpr_read_b32 v29, a53
    v_accvgpr_read_b32 v30, a54
    v_accvgpr_read_b32 v31, a55
    s_nop 0
    buffer_store_dwordx4 v[28:31], v6, s[20:23], 0 offen offset:160
    s_nop 1
    v_accvgpr_read_b32 v24, a56
    v_accvgpr_read_b32 v25, a57
    v_accvgpr_read_b32 v26, a58
    v_accvgpr_read_b32 v27, a59
    s_nop 0
    buffer_store_dwordx4 v[24:27], v6, s[20:23], 0 offen offset:192
    s_nop 1
    v_accvgpr_read_b32 v28, a60
    v_accvgpr_read_b32 v29, a61
    v_accvgpr_read_b32 v30, a62
    v_accvgpr_read_b32 v31, a63
    s_nop 0
    buffer_store_dwordx4 v[28:31], v6, s[20:23], 0 offen offset:224
    s_nop 1
    v_accvgpr_read_b32 v24, a64
    v_accvgpr_read_b32 v25, a65
    v_accvgpr_read_b32 v26, a66
    v_accvgpr_read_b32 v27, a67
    s_nop 0
    buffer_store_dwordx4 v[24:27], v5, s[20:23], 0 offen offset:256
    s_nop 1
    v_accvgpr_read_b32 v28, a68
    v_accvgpr_read_b32 v29, a69
    v_accvgpr_read_b32 v30, a70
    v_accvgpr_read_b32 v31, a71
    s_nop 0
    buffer_store_dwordx4 v[28:31], v5, s[20:23], 0 offen offset:288
    s_nop 1
    v_accvgpr_read_b32 v24, a72
    v_accvgpr_read_b32 v25, a73
    v_accvgpr_read_b32 v26, a74
    v_accvgpr_read_b32 v27, a75
    s_nop 0
    buffer_store_dwordx4 v[24:27], v5, s[20:23], 0 offen offset:320
    s_nop 1
    v_accvgpr_read_b32 v28, a76
    v_accvgpr_read_b32 v29, a77
    v_accvgpr_read_b32 v30, a78
    v_accvgpr_read_b32 v31, a79
    s_nop 0
    buffer_store_dwordx4 v[28:31], v5, s[20:23], 0 offen offset:352
    s_nop 1
    v_accvgpr_read_b32 v24, a80
    v_accvgpr_read_b32 v25, a81
    v_accvgpr_read_b32 v26, a82
    v_accvgpr_read_b32 v27, a83
    s_nop 0
    buffer_store_dwordx4 v[24:27], v6, s[20:23], 0 offen offset:256
    s_nop 1
    v_accvgpr_read_b32 v28, a84
    v_accvgpr_read_b32 v29, a85
    v_accvgpr_read_b32 v30, a86
    v_accvgpr_read_b32 v31, a87
    s_nop 0
    buffer_store_dwordx4 v[28:31], v6, s[20:23], 0 offen offset:288
    s_nop 1
    v_accvgpr_read_b32 v24, a88
    v_accvgpr_read_b32 v25, a89
    v_accvgpr_read_b32 v26, a90
    v_accvgpr_read_b32 v27, a91
    s_nop 0
    buffer_store_dwordx4 v[24:27], v6, s[20:23], 0 offen offset:320
    s_nop 1
    v_accvgpr_read_b32 v28, a92
    v_accvgpr_read_b32 v29, a93
    v_accvgpr_read_b32 v30, a94
    v_accvgpr_read_b32 v31, a95
    s_nop 0
    buffer_store_dwordx4 v[28:31], v6, s[20:23], 0 offen offset:352
    s_nop 1
    v_accvgpr_read_b32 v24, a96
    v_accvgpr_read_b32 v25, a97
    v_accvgpr_read_b32 v26, a98
    v_accvgpr_read_b32 v27, a99
    s_nop 0
    buffer_store_dwordx4 v[24:27], v5, s[20:23], 0 offen offset:384
    s_nop 1
    v_accvgpr_read_b32 v28, a100
    v_accvgpr_read_b32 v29, a101
    v_accvgpr_read_b32 v30, a102
    v_accvgpr_read_b32 v31, a103
    s_nop 0
    buffer_store_dwordx4 v[28:31], v5, s[20:23], 0 offen offset:416
    s_nop 1
    v_accvgpr_read_b32 v24, a104
    v_accvgpr_read_b32 v25, a105
    v_accvgpr_read_b32 v26, a106
    v_accvgpr_read_b32 v27, a107
    s_nop 0
    buffer_store_dwordx4 v[24:27], v5, s[20:23], 0 offen offset:448
    s_nop 1
    v_accvgpr_read_b32 v28, a108
    v_accvgpr_read_b32 v29, a109
    v_accvgpr_read_b32 v30, a110
    v_accvgpr_read_b32 v31, a111
    s_nop 0
    buffer_store_dwordx4 v[28:31], v5, s[20:23], 0 offen offset:480
    s_nop 1
    v_accvgpr_read_b32 v24, a112
    v_accvgpr_read_b32 v25, a113
    v_accvgpr_read_b32 v26, a114
    v_accvgpr_read_b32 v27, a115
    s_nop 0
    buffer_store_dwordx4 v[24:27], v6, s[20:23], 0 offen offset:384
    s_nop 1
    v_accvgpr_read_b32 v28, a116
    v_accvgpr_read_b32 v29, a117
    v_accvgpr_read_b32 v30, a118
    v_accvgpr_read_b32 v31, a119
    s_nop 0
    buffer_store_dwordx4 v[28:31], v6, s[20:23], 0 offen offset:416
    s_nop 1
    v_accvgpr_read_b32 v24, a120
    v_accvgpr_read_b32 v25, a121
    v_accvgpr_read_b32 v26, a122
    v_accvgpr_read_b32 v27, a123
    s_nop 0
    buffer_store_dwordx4 v[24:27], v6, s[20:23], 0 offen offset:448
    s_nop 1
    v_accvgpr_read_b32 v28, a124
    v_accvgpr_read_b32 v29, a125
    v_accvgpr_read_b32 v30, a126
    v_accvgpr_read_b32 v31, a127
    s_nop 0
    buffer_store_dwordx4 v[28:31], v6, s[20:23], 0 offen offset:480
    s_nop 1
fused_kernel_end:
    s_endpgm
fused_kernel_sub0:
    v_max_f32 v24, v24, v20
    v_sub_f32 v25, v20, v24
    v_exp_f32 v25, v25
    v_mov_b32 v20, v24
    s_nop 7
    s_nop 7
    v_mul_f32 v22, v22, v25
    v_accvgpr_read_b32 v26, a0
    s_nop 0
    v_mul_f32 v26, v26, v25
    s_nop 0
    v_accvgpr_write_b32 a0, v26
    v_accvgpr_read_b32 v26, a1
    s_nop 0
    v_mul_f32 v26, v26, v25
    s_nop 0
    v_accvgpr_write_b32 a1, v26
    v_accvgpr_read_b32 v26, a2
    s_nop 0
    v_mul_f32 v26, v26, v25
    s_nop 0
    v_accvgpr_write_b32 a2, v26
    v_accvgpr_read_b32 v26, a3
    s_nop 0
    v_mul_f32 v26, v26, v25
    s_nop 0
    v_accvgpr_write_b32 a3, v26
    v_accvgpr_read_b32 v26, a4
    s_nop 0
    v_mul_f32 v26, v26, v25
    s_nop 0
    v_accvgpr_write_b32 a4, v26
    v_accvgpr_read_b32 v26, a5
    s_nop 0
    v_mul_f32 v26, v26, v25
    s_nop 0
    v_accvgpr_write_b32 a5, v26
    v_accvgpr_read_b32 v26, a6
    s_nop 0
    v_mul_f32 v26, v26, v25
    s_nop 0
    v_accvgpr_write_b32 a6, v26
    v_accvgpr_read_b32 v26, a7
    s_nop 0
    v_mul_f32 v26, v26, v25
    s_nop 0
    v_accvgpr_write_b32 a7, v26
    v_accvgpr_read_b32 v26, a8
    s_nop 0
    v_mul_f32 v26, v26, v25
    s_nop 0
    v_accvgpr_write_b32 a8, v26
    v_accvgpr_read_b32 v26, a9
    s_nop 0
    v_mul_f32 v26, v26, v25
    s_nop 0
    v_accvgpr_write_b32 a9, v26
    v_accvgpr_read_b32 v26, a10
    s_nop 0
    v_mul_f32 v26, v26, v25
    s_nop 0
    v_accvgpr_write_b32 a10, v26
    v_accvgpr_read_b32 v26, a11
    s_nop 0
    v_mul_f32 v26, v26, v25
    s_nop 0
    v_accvgpr_write_b32 a11, v26
    v_accvgpr_read_b32 v26, a12
    s_nop 0
    v_mul_f32 v26, v26, v25
    s_nop 0
    v_accvgpr_write_b32 a12, v26
    v_accvgpr_read_b32 v26, a13
    s_nop 0
    v_mul_f32 v26, v26, v25
    s_nop 0
    v_accvgpr_write_b32 a13, v26
    v_accvgpr_read_b32 v26, a14
    s_nop 0
    v_mul_f32 v26, v26, v25
    s_nop 0
    v_accvgpr_write_b32 a14, v26
    v_accvgpr_read_b32 v26, a15
    s_nop 0
    v_mul_f32 v26, v26, v25
    s_nop 0
    v_accvgpr_write_b32 a15, v26
    v_accvgpr_read_b32 v26, a16
    s_nop 0
    v_mul_f32 v26, v26, v25
    s_nop 0
    v_accvgpr_write_b32 a16, v26
    v_accvgpr_read_b32 v26, a17
    s_nop 0
    v_mul_f32 v26, v26, v25
    s_nop 0
    v_accvgpr_write_b32 a17, v26
    v_accvgpr_read_b32 v26, a18
    s_nop 0
    v_mul_f32 v26, v26, v25
    s_nop 0
    v_accvgpr_write_b32 a18, v26
    v_accvgpr_read_b32 v26, a19
    s_nop 0
    v_mul_f32 v26, v26, v25
    s_nop 0
    v_accvgpr_write_b32 a19, v26
    v_accvgpr_read_b32 v26, a20
    s_nop 0
    v_mul_f32 v26, v26, v25
    s_nop 0
    v_accvgpr_write_b32 a20, v26
    v_accvgpr_read_b32 v26, a21
    s_nop 0
    v_mul_f32 v26, v26, v25
    s_nop 0
    v_accvgpr_write_b32 a21, v26
    v_accvgpr_read_b32 v26, a22
    s_nop 0
    v_mul_f32 v26, v26, v25
    s_nop 0
    v_accvgpr_write_b32 a22, v26
    v_accvgpr_read_b32 v26, a23
    s_nop 0
    v_mul_f32 v26, v26, v25
    s_nop 0
    v_accvgpr_write_b32 a23, v26
    v_accvgpr_read_b32 v26, a24
    s_nop 0
    v_mul_f32 v26, v26, v25
    s_nop 0
    v_accvgpr_write_b32 a24, v26
    v_accvgpr_read_b32 v26, a25
    s_nop 0
    v_mul_f32 v26, v26, v25
    s_nop 0
    v_accvgpr_write_b32 a25, v26
    v_accvgpr_read_b32 v26, a26
    s_nop 0
    v_mul_f32 v26, v26, v25
    s_nop 0
    v_accvgpr_write_b32 a26, v26
    v_accvgpr_read_b32 v26, a27
    s_nop 0
    v_mul_f32 v26, v26, v25
    s_nop 0
    v_accvgpr_write_b32 a27, v26
    v_accvgpr_read_b32 v26, a28
    s_nop 0
    v_mul_f32 v26, v26, v25
    s_nop 0
    v_accvgpr_write_b32 a28, v26
    v_accvgpr_read_b32 v26, a29
    s_nop 0
    v_mul_f32 v26, v26, v25
    s_nop 0
    v_accvgpr_write_b32 a29, v26
    v_accvgpr_read_b32 v26, a30
    s_nop 0
    v_mul_f32 v26, v26, v25
    s_nop 0
    v_accvgpr_write_b32 a30, v26
    v_accvgpr_read_b32 v26, a31
    s_nop 0
    v_mul_f32 v26, v26, v25
    s_nop 0
    v_accvgpr_write_b32 a31, v26
    v_accvgpr_read_b32 v26, a32
    s_nop 0
    v_mul_f32 v26, v26, v25
    s_nop 0
    v_accvgpr_write_b32 a32, v26
    v_accvgpr_read_b32 v26, a33
    s_nop 0
    v_mul_f32 v26, v26, v25
    s_nop 0
    v_accvgpr_write_b32 a33, v26
    v_accvgpr_read_b32 v26, a34
    s_nop 0
    v_mul_f32 v26, v26, v25
    s_nop 0
    v_accvgpr_write_b32 a34, v26
    v_accvgpr_read_b32 v26, a35
    s_nop 0
    v_mul_f32 v26, v26, v25
    s_nop 0
    v_accvgpr_write_b32 a35, v26
    v_accvgpr_read_b32 v26, a36
    s_nop 0
    v_mul_f32 v26, v26, v25
    s_nop 0
    v_accvgpr_write_b32 a36, v26
    v_accvgpr_read_b32 v26, a37
    s_nop 0
    v_mul_f32 v26, v26, v25
    s_nop 0
    v_accvgpr_write_b32 a37, v26
    v_accvgpr_read_b32 v26, a38
    s_nop 0
    v_mul_f32 v26, v26, v25
    s_nop 0
    v_accvgpr_write_b32 a38, v26
    v_accvgpr_read_b32 v26, a39
    s_nop 0
    v_mul_f32 v26, v26, v25
    s_nop 0
    v_accvgpr_write_b32 a39, v26
    v_accvgpr_read_b32 v26, a40
    s_nop 0
    v_mul_f32 v26, v26, v25
    s_nop 0
    v_accvgpr_write_b32 a40, v26
    v_accvgpr_read_b32 v26, a41
    s_nop 0
    v_mul_f32 v26, v26, v25
    s_nop 0
    v_accvgpr_write_b32 a41, v26
    v_accvgpr_read_b32 v26, a42
    s_nop 0
    v_mul_f32 v26, v26, v25
    s_nop 0
    v_accvgpr_write_b32 a42, v26
    v_accvgpr_read_b32 v26, a43
    s_nop 0
    v_mul_f32 v26, v26, v25
    s_nop 0
    v_accvgpr_write_b32 a43, v26
    v_accvgpr_read_b32 v26, a44
    s_nop 0
    v_mul_f32 v26, v26, v25
    s_nop 0
    v_accvgpr_write_b32 a44, v26
    v_accvgpr_read_b32 v26, a45
    s_nop 0
    v_mul_f32 v26, v26, v25
    s_nop 0
    v_accvgpr_write_b32 a45, v26
    v_accvgpr_read_b32 v26, a46
    s_nop 0
    v_mul_f32 v26, v26, v25
    s_nop 0
    v_accvgpr_write_b32 a46, v26
    v_accvgpr_read_b32 v26, a47
    s_nop 0
    v_mul_f32 v26, v26, v25
    s_nop 0
    v_accvgpr_write_b32 a47, v26
    v_accvgpr_read_b32 v26, a48
    s_nop 0
    v_mul_f32 v26, v26, v25
    s_nop 0
    v_accvgpr_write_b32 a48, v26
    v_accvgpr_read_b32 v26, a49
    s_nop 0
    v_mul_f32 v26, v26, v25
    s_nop 0
    v_accvgpr_write_b32 a49, v26
    v_accvgpr_read_b32 v26, a50
    s_nop 0
    v_mul_f32 v26, v26, v25
    s_nop 0
    v_accvgpr_write_b32 a50, v26
    v_accvgpr_read_b32 v26, a51
    s_nop 0
    v_mul_f32 v26, v26, v25
    s_nop 0
    v_accvgpr_write_b32 a51, v26
    v_accvgpr_read_b32 v26, a52
    s_nop 0
    v_mul_f32 v26, v26, v25
    s_nop 0
    v_accvgpr_write_b32 a52, v26
    v_accvgpr_read_b32 v26, a53
    s_nop 0
    v_mul_f32 v26, v26, v25
    s_nop 0
    v_accvgpr_write_b32 a53, v26
    v_accvgpr_read_b32 v26, a54
    s_nop 0
    v_mul_f32 v26, v26, v25
    s_nop 0
    v_accvgpr_write_b32 a54, v26
    v_accvgpr_read_b32 v26, a55
    s_nop 0
    v_mul_f32 v26, v26, v25
    s_nop 0
    v_accvgpr_write_b32 a55, v26
    v_accvgpr_read_b32 v26, a56
    s_nop 0
    v_mul_f32 v26, v26, v25
    s_nop 0
    v_accvgpr_write_b32 a56, v26
    v_accvgpr_read_b32 v26, a57
    s_nop 0
    v_mul_f32 v26, v26, v25
    s_nop 0
    v_accvgpr_write_b32 a57, v26
    v_accvgpr_read_b32 v26, a58
    s_nop 0
    v_mul_f32 v26, v26, v25
    s_nop 0
    v_accvgpr_write_b32 a58, v26
    v_accvgpr_read_b32 v26, a59
    s_nop 0
    v_mul_f32 v26, v26, v25
    s_nop 0
    v_accvgpr_write_b32 a59, v26
    v_accvgpr_read_b32 v26, a60
    s_nop 0
    v_mul_f32 v26, v26, v25
    s_nop 0
    v_accvgpr_write_b32 a60, v26
    v_accvgpr_read_b32 v26, a61
    s_nop 0
    v_mul_f32 v26, v26, v25
    s_nop 0
    v_accvgpr_write_b32 a61, v26
    v_accvgpr_read_b32 v26, a62
    s_nop 0
    v_mul_f32 v26, v26, v25
    s_nop 0
    v_accvgpr_write_b32 a62, v26
    v_accvgpr_read_b32 v26, a63
    s_nop 0
    v_mul_f32 v26, v26, v25
    s_nop 0
    v_accvgpr_write_b32 a63, v26
    v_accvgpr_read_b32 v26, a64
    s_nop 0
    v_mul_f32 v26, v26, v25
    s_nop 0
    v_accvgpr_write_b32 a64, v26
    v_accvgpr_read_b32 v26, a65
    s_nop 0
    v_mul_f32 v26, v26, v25
    s_nop 0
    v_accvgpr_write_b32 a65, v26
    v_accvgpr_read_b32 v26, a66
    s_nop 0
    v_mul_f32 v26, v26, v25
    s_nop 0
    v_accvgpr_write_b32 a66, v26
    v_accvgpr_read_b32 v26, a67
    s_nop 0
    v_mul_f32 v26, v26, v25
    s_nop 0
    v_accvgpr_write_b32 a67, v26
    v_accvgpr_read_b32 v26, a68
    s_nop 0
    v_mul_f32 v26, v26, v25
    s_nop 0
    v_accvgpr_write_b32 a68, v26
    v_accvgpr_read_b32 v26, a69
    s_nop 0
    v_mul_f32 v26, v26, v25
    s_nop 0
    v_accvgpr_write_b32 a69, v26
    v_accvgpr_read_b32 v26, a70
    s_nop 0
    v_mul_f32 v26, v26, v25
    s_nop 0
    v_accvgpr_write_b32 a70, v26
    v_accvgpr_read_b32 v26, a71
    s_nop 0
    v_mul_f32 v26, v26, v25
    s_nop 0
    v_accvgpr_write_b32 a71, v26
    v_accvgpr_read_b32 v26, a72
    s_nop 0
    v_mul_f32 v26, v26, v25
    s_nop 0
    v_accvgpr_write_b32 a72, v26
    v_accvgpr_read_b32 v26, a73
    s_nop 0
    v_mul_f32 v26, v26, v25
    s_nop 0
    v_accvgpr_write_b32 a73, v26
    v_accvgpr_read_b32 v26, a74
    s_nop 0
    v_mul_f32 v26, v26, v25
    s_nop 0
    v_accvgpr_write_b32 a74, v26
    v_accvgpr_read_b32 v26, a75
    s_nop 0
    v_mul_f32 v26, v26, v25
    s_nop 0
    v_accvgpr_write_b32 a75, v26
    v_accvgpr_read_b32 v26, a76
    s_nop 0
    v_mul_f32 v26, v26, v25
    s_nop 0
    v_accvgpr_write_b32 a76, v26
    v_accvgpr_read_b32 v26, a77
    s_nop 0
    v_mul_f32 v26, v26, v25
    s_nop 0
    v_accvgpr_write_b32 a77, v26
    v_accvgpr_read_b32 v26, a78
    s_nop 0
    v_mul_f32 v26, v26, v25
    s_nop 0
    v_accvgpr_write_b32 a78, v26
    v_accvgpr_read_b32 v26, a79
    s_nop 0
    v_mul_f32 v26, v26, v25
    s_nop 0
    v_accvgpr_write_b32 a79, v26
    v_accvgpr_read_b32 v26, a80
    s_nop 0
    v_mul_f32 v26, v26, v25
    s_nop 0
    v_accvgpr_write_b32 a80, v26
    v_accvgpr_read_b32 v26, a81
    s_nop 0
    v_mul_f32 v26, v26, v25
    s_nop 0
    v_accvgpr_write_b32 a81, v26
    v_accvgpr_read_b32 v26, a82
    s_nop 0
    v_mul_f32 v26, v26, v25
    s_nop 0
    v_accvgpr_write_b32 a82, v26
    v_accvgpr_read_b32 v26, a83
    s_nop 0
    v_mul_f32 v26, v26, v25
    s_nop 0
    v_accvgpr_write_b32 a83, v26
    v_accvgpr_read_b32 v26, a84
    s_nop 0
    v_mul_f32 v26, v26, v25
    s_nop 0
    v_accvgpr_write_b32 a84, v26
    v_accvgpr_read_b32 v26, a85
    s_nop 0
    v_mul_f32 v26, v26, v25
    s_nop 0
    v_accvgpr_write_b32 a85, v26
    v_accvgpr_read_b32 v26, a86
    s_nop 0
    v_mul_f32 v26, v26, v25
    s_nop 0
    v_accvgpr_write_b32 a86, v26
    v_accvgpr_read_b32 v26, a87
    s_nop 0
    v_mul_f32 v26, v26, v25
    s_nop 0
    v_accvgpr_write_b32 a87, v26
    v_accvgpr_read_b32 v26, a88
    s_nop 0
    v_mul_f32 v26, v26, v25
    s_nop 0
    v_accvgpr_write_b32 a88, v26
    v_accvgpr_read_b32 v26, a89
    s_nop 0
    v_mul_f32 v26, v26, v25
    s_nop 0
    v_accvgpr_write_b32 a89, v26
    v_accvgpr_read_b32 v26, a90
    s_nop 0
    v_mul_f32 v26, v26, v25
    s_nop 0
    v_accvgpr_write_b32 a90, v26
    v_accvgpr_read_b32 v26, a91
    s_nop 0
    v_mul_f32 v26, v26, v25
    s_nop 0
    v_accvgpr_write_b32 a91, v26
    v_accvgpr_read_b32 v26, a92
    s_nop 0
    v_mul_f32 v26, v26, v25
    s_nop 0
    v_accvgpr_write_b32 a92, v26
    v_accvgpr_read_b32 v26, a93
    s_nop 0
    v_mul_f32 v26, v26, v25
    s_nop 0
    v_accvgpr_write_b32 a93, v26
    v_accvgpr_read_b32 v26, a94
    s_nop 0
    v_mul_f32 v26, v26, v25
    s_nop 0
    v_accvgpr_write_b32 a94, v26
    v_accvgpr_read_b32 v26, a95
    s_nop 0
    v_mul_f32 v26, v26, v25
    s_nop 0
    v_accvgpr_write_b32 a95, v26
    v_accvgpr_read_b32 v26, a96
    s_nop 0
    v_mul_f32 v26, v26, v25
    s_nop 0
    v_accvgpr_write_b32 a96, v26
    v_accvgpr_read_b32 v26, a97
    s_nop 0
    v_mul_f32 v26, v26, v25
    s_nop 0
    v_accvgpr_write_b32 a97, v26
    v_accvgpr_read_b32 v26, a98
    s_nop 0
    v_mul_f32 v26, v26, v25
    s_nop 0
    v_accvgpr_write_b32 a98, v26
    v_accvgpr_read_b32 v26, a99
    s_nop 0
    v_mul_f32 v26, v26, v25
    s_nop 0
    v_accvgpr_write_b32 a99, v26
    v_accvgpr_read_b32 v26, a100
    s_nop 0
    v_mul_f32 v26, v26, v25
    s_nop 0
    v_accvgpr_write_b32 a100, v26
    v_accvgpr_read_b32 v26, a101
    s_nop 0
    v_mul_f32 v26, v26, v25
    s_nop 0
    v_accvgpr_write_b32 a101, v26
    v_accvgpr_read_b32 v26, a102
    s_nop 0
    v_mul_f32 v26, v26, v25
    s_nop 0
    v_accvgpr_write_b32 a102, v26
    v_accvgpr_read_b32 v26, a103
    s_nop 0
    v_mul_f32 v26, v26, v25
    s_nop 0
    v_accvgpr_write_b32 a103, v26
    v_accvgpr_read_b32 v26, a104
    s_nop 0
    v_mul_f32 v26, v26, v25
    s_nop 0
    v_accvgpr_write_b32 a104, v26
    v_accvgpr_read_b32 v26, a105
    s_nop 0
    v_mul_f32 v26, v26, v25
    s_nop 0
    v_accvgpr_write_b32 a105, v26
    v_accvgpr_read_b32 v26, a106
    s_nop 0
    v_mul_f32 v26, v26, v25
    s_nop 0
    v_accvgpr_write_b32 a106, v26
    v_accvgpr_read_b32 v26, a107
    s_nop 0
    v_mul_f32 v26, v26, v25
    s_nop 0
    v_accvgpr_write_b32 a107, v26
    v_accvgpr_read_b32 v26, a108
    s_nop 0
    v_mul_f32 v26, v26, v25
    s_nop 0
    v_accvgpr_write_b32 a108, v26
    v_accvgpr_read_b32 v26, a109
    s_nop 0
    v_mul_f32 v26, v26, v25
    s_nop 0
    v_accvgpr_write_b32 a109, v26
    v_accvgpr_read_b32 v26, a110
    s_nop 0
    v_mul_f32 v26, v26, v25
    s_nop 0
    v_accvgpr_write_b32 a110, v26
    v_accvgpr_read_b32 v26, a111
    s_nop 0
    v_mul_f32 v26, v26, v25
    s_nop 0
    v_accvgpr_write_b32 a111, v26
    v_accvgpr_read_b32 v26, a112
    s_nop 0
    v_mul_f32 v26, v26, v25
    s_nop 0
    v_accvgpr_write_b32 a112, v26
    v_accvgpr_read_b32 v26, a113
    s_nop 0
    v_mul_f32 v26, v26, v25
    s_nop 0
    v_accvgpr_write_b32 a113, v26
    v_accvgpr_read_b32 v26, a114
    s_nop 0
    v_mul_f32 v26, v26, v25
    s_nop 0
    v_accvgpr_write_b32 a114, v26
    v_accvgpr_read_b32 v26, a115
    s_nop 0
    v_mul_f32 v26, v26, v25
    s_nop 0
    v_accvgpr_write_b32 a115, v26
    v_accvgpr_read_b32 v26, a116
    s_nop 0
    v_mul_f32 v26, v26, v25
    s_nop 0
    v_accvgpr_write_b32 a116, v26
    v_accvgpr_read_b32 v26, a117
    s_nop 0
    v_mul_f32 v26, v26, v25
    s_nop 0
    v_accvgpr_write_b32 a117, v26
    v_accvgpr_read_b32 v26, a118
    s_nop 0
    v_mul_f32 v26, v26, v25
    s_nop 0
    v_accvgpr_write_b32 a118, v26
    v_accvgpr_read_b32 v26, a119
    s_nop 0
    v_mul_f32 v26, v26, v25
    s_nop 0
    v_accvgpr_write_b32 a119, v26
    v_accvgpr_read_b32 v26, a120
    s_nop 0
    v_mul_f32 v26, v26, v25
    s_nop 0
    v_accvgpr_write_b32 a120, v26
    v_accvgpr_read_b32 v26, a121
    s_nop 0
    v_mul_f32 v26, v26, v25
    s_nop 0
    v_accvgpr_write_b32 a121, v26
    v_accvgpr_read_b32 v26, a122
    s_nop 0
    v_mul_f32 v26, v26, v25
    s_nop 0
    v_accvgpr_write_b32 a122, v26
    v_accvgpr_read_b32 v26, a123
    s_nop 0
    v_mul_f32 v26, v26, v25
    s_nop 0
    v_accvgpr_write_b32 a123, v26
    v_accvgpr_read_b32 v26, a124
    s_nop 0
    v_mul_f32 v26, v26, v25
    s_nop 0
    v_accvgpr_write_b32 a124, v26
    v_accvgpr_read_b32 v26, a125
    s_nop 0
    v_mul_f32 v26, v26, v25
    s_nop 0
    v_accvgpr_write_b32 a125, v26
    v_accvgpr_read_b32 v26, a126
    s_nop 0
    v_mul_f32 v26, v26, v25
    s_nop 0
    v_accvgpr_write_b32 a126, v26
    v_accvgpr_read_b32 v26, a127
    s_nop 0
    v_mul_f32 v26, v26, v25
    s_nop 0
    v_accvgpr_write_b32 a127, v26
    s_nop 7
    s_setpc_b64 s[44:45]
fused_kernel_sub1:
    v_max_f32 v27, v27, v21
    v_sub_f32 v28, v21, v27
    v_exp_f32 v28, v28
    v_mov_b32 v21, v27
    s_nop 7
    s_nop 7
    v_mul_f32 v23, v23, v28
    v_accvgpr_read_b32 v29, a128
    s_nop 0
    v_mul_f32 v29, v29, v28
    s_nop 0
    v_accvgpr_write_b32 a128, v29
    v_accvgpr_read_b32 v29, a129
    s_nop 0
    v_mul_f32 v29, v29, v28
    s_nop 0
    v_accvgpr_write_b32 a129, v29
    v_accvgpr_read_b32 v29, a130
    s_nop 0
    v_mul_f32 v29, v29, v28
    s_nop 0
    v_accvgpr_write_b32 a130, v29
    v_accvgpr_read_b32 v29, a131
    s_nop 0
    v_mul_f32 v29, v29, v28
    s_nop 0
    v_accvgpr_write_b32 a131, v29
    v_accvgpr_read_b32 v29, a132
    s_nop 0
    v_mul_f32 v29, v29, v28
    s_nop 0
    v_accvgpr_write_b32 a132, v29
    v_accvgpr_read_b32 v29, a133
    s_nop 0
    v_mul_f32 v29, v29, v28
    s_nop 0
    v_accvgpr_write_b32 a133, v29
    v_accvgpr_read_b32 v29, a134
    s_nop 0
    v_mul_f32 v29, v29, v28
    s_nop 0
    v_accvgpr_write_b32 a134, v29
    v_accvgpr_read_b32 v29, a135
    s_nop 0
    v_mul_f32 v29, v29, v28
    s_nop 0
    v_accvgpr_write_b32 a135, v29
    v_accvgpr_read_b32 v29, a136
    s_nop 0
    v_mul_f32 v29, v29, v28
    s_nop 0
    v_accvgpr_write_b32 a136, v29
    v_accvgpr_read_b32 v29, a137
    s_nop 0
    v_mul_f32 v29, v29, v28
    s_nop 0
    v_accvgpr_write_b32 a137, v29
    v_accvgpr_read_b32 v29, a138
    s_nop 0
    v_mul_f32 v29, v29, v28
    s_nop 0
    v_accvgpr_write_b32 a138, v29
    v_accvgpr_read_b32 v29, a139
    s_nop 0
    v_mul_f32 v29, v29, v28
    s_nop 0
    v_accvgpr_write_b32 a139, v29
    v_accvgpr_read_b32 v29, a140
    s_nop 0
    v_mul_f32 v29, v29, v28
    s_nop 0
    v_accvgpr_write_b32 a140, v29
    v_accvgpr_read_b32 v29, a141
    s_nop 0
    v_mul_f32 v29, v29, v28
    s_nop 0
    v_accvgpr_write_b32 a141, v29
    v_accvgpr_read_b32 v29, a142
    s_nop 0
    v_mul_f32 v29, v29, v28
    s_nop 0
    v_accvgpr_write_b32 a142, v29
    v_accvgpr_read_b32 v29, a143
    s_nop 0
    v_mul_f32 v29, v29, v28
    s_nop 0
    v_accvgpr_write_b32 a143, v29
    v_accvgpr_read_b32 v29, a144
    s_nop 0
    v_mul_f32 v29, v29, v28
    s_nop 0
    v_accvgpr_write_b32 a144, v29
    v_accvgpr_read_b32 v29, a145
    s_nop 0
    v_mul_f32 v29, v29, v28
    s_nop 0
    v_accvgpr_write_b32 a145, v29
    v_accvgpr_read_b32 v29, a146
    s_nop 0
    v_mul_f32 v29, v29, v28
    s_nop 0
    v_accvgpr_write_b32 a146, v29
    v_accvgpr_read_b32 v29, a147
    s_nop 0
    v_mul_f32 v29, v29, v28
    s_nop 0
    v_accvgpr_write_b32 a147, v29
    v_accvgpr_read_b32 v29, a148
    s_nop 0
    v_mul_f32 v29, v29, v28
    s_nop 0
    v_accvgpr_write_b32 a148, v29
    v_accvgpr_read_b32 v29, a149
    s_nop 0
    v_mul_f32 v29, v29, v28
    s_nop 0
    v_accvgpr_write_b32 a149, v29
    v_accvgpr_read_b32 v29, a150
    s_nop 0
    v_mul_f32 v29, v29, v28
    s_nop 0
    v_accvgpr_write_b32 a150, v29
    v_accvgpr_read_b32 v29, a151
    s_nop 0
    v_mul_f32 v29, v29, v28
    s_nop 0
    v_accvgpr_write_b32 a151, v29
    v_accvgpr_read_b32 v29, a152
    s_nop 0
    v_mul_f32 v29, v29, v28
    s_nop 0
    v_accvgpr_write_b32 a152, v29
    v_accvgpr_read_b32 v29, a153
    s_nop 0
    v_mul_f32 v29, v29, v28
    s_nop 0
    v_accvgpr_write_b32 a153, v29
    v_accvgpr_read_b32 v29, a154
    s_nop 0
    v_mul_f32 v29, v29, v28
    s_nop 0
    v_accvgpr_write_b32 a154, v29
    v_accvgpr_read_b32 v29, a155
    s_nop 0
    v_mul_f32 v29, v29, v28
    s_nop 0
    v_accvgpr_write_b32 a155, v29
    v_accvgpr_read_b32 v29, a156
    s_nop 0
    v_mul_f32 v29, v29, v28
    s_nop 0
    v_accvgpr_write_b32 a156, v29
    v_accvgpr_read_b32 v29, a157
    s_nop 0
    v_mul_f32 v29, v29, v28
    s_nop 0
    v_accvgpr_write_b32 a157, v29
    v_accvgpr_read_b32 v29, a158
    s_nop 0
    v_mul_f32 v29, v29, v28
    s_nop 0
    v_accvgpr_write_b32 a158, v29
    v_accvgpr_read_b32 v29, a159
    s_nop 0
    v_mul_f32 v29, v29, v28
    s_nop 0
    v_accvgpr_write_b32 a159, v29
    v_accvgpr_read_b32 v29, a160
    s_nop 0
    v_mul_f32 v29, v29, v28
    s_nop 0
    v_accvgpr_write_b32 a160, v29
    v_accvgpr_read_b32 v29, a161
    s_nop 0
    v_mul_f32 v29, v29, v28
    s_nop 0
    v_accvgpr_write_b32 a161, v29
    v_accvgpr_read_b32 v29, a162
    s_nop 0
    v_mul_f32 v29, v29, v28
    s_nop 0
    v_accvgpr_write_b32 a162, v29
    v_accvgpr_read_b32 v29, a163
    s_nop 0
    v_mul_f32 v29, v29, v28
    s_nop 0
    v_accvgpr_write_b32 a163, v29
    v_accvgpr_read_b32 v29, a164
    s_nop 0
    v_mul_f32 v29, v29, v28
    s_nop 0
    v_accvgpr_write_b32 a164, v29
    v_accvgpr_read_b32 v29, a165
    s_nop 0
    v_mul_f32 v29, v29, v28
    s_nop 0
    v_accvgpr_write_b32 a165, v29
    v_accvgpr_read_b32 v29, a166
    s_nop 0
    v_mul_f32 v29, v29, v28
    s_nop 0
    v_accvgpr_write_b32 a166, v29
    v_accvgpr_read_b32 v29, a167
    s_nop 0
    v_mul_f32 v29, v29, v28
    s_nop 0
    v_accvgpr_write_b32 a167, v29
    v_accvgpr_read_b32 v29, a168
    s_nop 0
    v_mul_f32 v29, v29, v28
    s_nop 0
    v_accvgpr_write_b32 a168, v29
    v_accvgpr_read_b32 v29, a169
    s_nop 0
    v_mul_f32 v29, v29, v28
    s_nop 0
    v_accvgpr_write_b32 a169, v29
    v_accvgpr_read_b32 v29, a170
    s_nop 0
    v_mul_f32 v29, v29, v28
    s_nop 0
    v_accvgpr_write_b32 a170, v29
    v_accvgpr_read_b32 v29, a171
    s_nop 0
    v_mul_f32 v29, v29, v28
    s_nop 0
    v_accvgpr_write_b32 a171, v29
    v_accvgpr_read_b32 v29, a172
    s_nop 0
    v_mul_f32 v29, v29, v28
    s_nop 0
    v_accvgpr_write_b32 a172, v29
    v_accvgpr_read_b32 v29, a173
    s_nop 0
    v_mul_f32 v29, v29, v28
    s_nop 0
    v_accvgpr_write_b32 a173, v29
    v_accvgpr_read_b32 v29, a174
    s_nop 0
    v_mul_f32 v29, v29, v28
    s_nop 0
    v_accvgpr_write_b32 a174, v29
    v_accvgpr_read_b32 v29, a175
    s_nop 0
    v_mul_f32 v29, v29, v28
    s_nop 0
    v_accvgpr_write_b32 a175, v29
    v_accvgpr_read_b32 v29, a176
    s_nop 0
    v_mul_f32 v29, v29, v28
    s_nop 0
    v_accvgpr_write_b32 a176, v29
    v_accvgpr_read_b32 v29, a177
    s_nop 0
    v_mul_f32 v29, v29, v28
    s_nop 0
    v_accvgpr_write_b32 a177, v29
    v_accvgpr_read_b32 v29, a178
    s_nop 0
    v_mul_f32 v29, v29, v28
    s_nop 0
    v_accvgpr_write_b32 a178, v29
    v_accvgpr_read_b32 v29, a179
    s_nop 0
    v_mul_f32 v29, v29, v28
    s_nop 0
    v_accvgpr_write_b32 a179, v29
    v_accvgpr_read_b32 v29, a180
    s_nop 0
    v_mul_f32 v29, v29, v28
    s_nop 0
    v_accvgpr_write_b32 a180, v29
    v_accvgpr_read_b32 v29, a181
    s_nop 0
    v_mul_f32 v29, v29, v28
    s_nop 0
    v_accvgpr_write_b32 a181, v29
    v_accvgpr_read_b32 v29, a182
    s_nop 0
    v_mul_f32 v29, v29, v28
    s_nop 0
    v_accvgpr_write_b32 a182, v29
    v_accvgpr_read_b32 v29, a183
    s_nop 0
    v_mul_f32 v29, v29, v28
    s_nop 0
    v_accvgpr_write_b32 a183, v29
    v_accvgpr_read_b32 v29, a184
    s_nop 0
    v_mul_f32 v29, v29, v28
    s_nop 0
    v_accvgpr_write_b32 a184, v29
    v_accvgpr_read_b32 v29, a185
    s_nop 0
    v_mul_f32 v29, v29, v28
    s_nop 0
    v_accvgpr_write_b32 a185, v29
    v_accvgpr_read_b32 v29, a186
    s_nop 0
    v_mul_f32 v29, v29, v28
    s_nop 0
    v_accvgpr_write_b32 a186, v29
    v_accvgpr_read_b32 v29, a187
    s_nop 0
    v_mul_f32 v29, v29, v28
    s_nop 0
    v_accvgpr_write_b32 a187, v29
    v_accvgpr_read_b32 v29, a188
    s_nop 0
    v_mul_f32 v29, v29, v28
    s_nop 0
    v_accvgpr_write_b32 a188, v29
    v_accvgpr_read_b32 v29, a189
    s_nop 0
    v_mul_f32 v29, v29, v28
    s_nop 0
    v_accvgpr_write_b32 a189, v29
    v_accvgpr_read_b32 v29, a190
    s_nop 0
    v_mul_f32 v29, v29, v28
    s_nop 0
    v_accvgpr_write_b32 a190, v29
    v_accvgpr_read_b32 v29, a191
    s_nop 0
    v_mul_f32 v29, v29, v28
    s_nop 0
    v_accvgpr_write_b32 a191, v29
    v_accvgpr_read_b32 v29, a192
    s_nop 0
    v_mul_f32 v29, v29, v28
    s_nop 0
    v_accvgpr_write_b32 a192, v29
    v_accvgpr_read_b32 v29, a193
    s_nop 0
    v_mul_f32 v29, v29, v28
    s_nop 0
    v_accvgpr_write_b32 a193, v29
    v_accvgpr_read_b32 v29, a194
    s_nop 0
    v_mul_f32 v29, v29, v28
    s_nop 0
    v_accvgpr_write_b32 a194, v29
    v_accvgpr_read_b32 v29, a195
    s_nop 0
    v_mul_f32 v29, v29, v28
    s_nop 0
    v_accvgpr_write_b32 a195, v29
    v_accvgpr_read_b32 v29, a196
    s_nop 0
    v_mul_f32 v29, v29, v28
    s_nop 0
    v_accvgpr_write_b32 a196, v29
    v_accvgpr_read_b32 v29, a197
    s_nop 0
    v_mul_f32 v29, v29, v28
    s_nop 0
    v_accvgpr_write_b32 a197, v29
    v_accvgpr_read_b32 v29, a198
    s_nop 0
    v_mul_f32 v29, v29, v28
    s_nop 0
    v_accvgpr_write_b32 a198, v29
    v_accvgpr_read_b32 v29, a199
    s_nop 0
    v_mul_f32 v29, v29, v28
    s_nop 0
    v_accvgpr_write_b32 a199, v29
    v_accvgpr_read_b32 v29, a200
    s_nop 0
    v_mul_f32 v29, v29, v28
    s_nop 0
    v_accvgpr_write_b32 a200, v29
    v_accvgpr_read_b32 v29, a201
    s_nop 0
    v_mul_f32 v29, v29, v28
    s_nop 0
    v_accvgpr_write_b32 a201, v29
    v_accvgpr_read_b32 v29, a202
    s_nop 0
    v_mul_f32 v29, v29, v28
    s_nop 0
    v_accvgpr_write_b32 a202, v29
    v_accvgpr_read_b32 v29, a203
    s_nop 0
    v_mul_f32 v29, v29, v28
    s_nop 0
    v_accvgpr_write_b32 a203, v29
    v_accvgpr_read_b32 v29, a204
    s_nop 0
    v_mul_f32 v29, v29, v28
    s_nop 0
    v_accvgpr_write_b32 a204, v29
    v_accvgpr_read_b32 v29, a205
    s_nop 0
    v_mul_f32 v29, v29, v28
    s_nop 0
    v_accvgpr_write_b32 a205, v29
    v_accvgpr_read_b32 v29, a206
    s_nop 0
    v_mul_f32 v29, v29, v28
    s_nop 0
    v_accvgpr_write_b32 a206, v29
    v_accvgpr_read_b32 v29, a207
    s_nop 0
    v_mul_f32 v29, v29, v28
    s_nop 0
    v_accvgpr_write_b32 a207, v29
    v_accvgpr_read_b32 v29, a208
    s_nop 0
    v_mul_f32 v29, v29, v28
    s_nop 0
    v_accvgpr_write_b32 a208, v29
    v_accvgpr_read_b32 v29, a209
    s_nop 0
    v_mul_f32 v29, v29, v28
    s_nop 0
    v_accvgpr_write_b32 a209, v29
    v_accvgpr_read_b32 v29, a210
    s_nop 0
    v_mul_f32 v29, v29, v28
    s_nop 0
    v_accvgpr_write_b32 a210, v29
    v_accvgpr_read_b32 v29, a211
    s_nop 0
    v_mul_f32 v29, v29, v28
    s_nop 0
    v_accvgpr_write_b32 a211, v29
    v_accvgpr_read_b32 v29, a212
    s_nop 0
    v_mul_f32 v29, v29, v28
    s_nop 0
    v_accvgpr_write_b32 a212, v29
    v_accvgpr_read_b32 v29, a213
    s_nop 0
    v_mul_f32 v29, v29, v28
    s_nop 0
    v_accvgpr_write_b32 a213, v29
    v_accvgpr_read_b32 v29, a214
    s_nop 0
    v_mul_f32 v29, v29, v28
    s_nop 0
    v_accvgpr_write_b32 a214, v29
    v_accvgpr_read_b32 v29, a215
    s_nop 0
    v_mul_f32 v29, v29, v28
    s_nop 0
    v_accvgpr_write_b32 a215, v29
    v_accvgpr_read_b32 v29, a216
    s_nop 0
    v_mul_f32 v29, v29, v28
    s_nop 0
    v_accvgpr_write_b32 a216, v29
    v_accvgpr_read_b32 v29, a217
    s_nop 0
    v_mul_f32 v29, v29, v28
    s_nop 0
    v_accvgpr_write_b32 a217, v29
    v_accvgpr_read_b32 v29, a218
    s_nop 0
    v_mul_f32 v29, v29, v28
    s_nop 0
    v_accvgpr_write_b32 a218, v29
    v_accvgpr_read_b32 v29, a219
    s_nop 0
    v_mul_f32 v29, v29, v28
    s_nop 0
    v_accvgpr_write_b32 a219, v29
    v_accvgpr_read_b32 v29, a220
    s_nop 0
    v_mul_f32 v29, v29, v28
    s_nop 0
    v_accvgpr_write_b32 a220, v29
    v_accvgpr_read_b32 v29, a221
    s_nop 0
    v_mul_f32 v29, v29, v28
    s_nop 0
    v_accvgpr_write_b32 a221, v29
    v_accvgpr_read_b32 v29, a222
    s_nop 0
    v_mul_f32 v29, v29, v28
    s_nop 0
    v_accvgpr_write_b32 a222, v29
    v_accvgpr_read_b32 v29, a223
    s_nop 0
    v_mul_f32 v29, v29, v28
    s_nop 0
    v_accvgpr_write_b32 a223, v29
    v_accvgpr_read_b32 v29, a224
    s_nop 0
    v_mul_f32 v29, v29, v28
    s_nop 0
    v_accvgpr_write_b32 a224, v29
    v_accvgpr_read_b32 v29, a225
    s_nop 0
    v_mul_f32 v29, v29, v28
    s_nop 0
    v_accvgpr_write_b32 a225, v29
    v_accvgpr_read_b32 v29, a226
    s_nop 0
    v_mul_f32 v29, v29, v28
    s_nop 0
    v_accvgpr_write_b32 a226, v29
    v_accvgpr_read_b32 v29, a227
    s_nop 0
    v_mul_f32 v29, v29, v28
    s_nop 0
    v_accvgpr_write_b32 a227, v29
    v_accvgpr_read_b32 v29, a228
    s_nop 0
    v_mul_f32 v29, v29, v28
    s_nop 0
    v_accvgpr_write_b32 a228, v29
    v_accvgpr_read_b32 v29, a229
    s_nop 0
    v_mul_f32 v29, v29, v28
    s_nop 0
    v_accvgpr_write_b32 a229, v29
    v_accvgpr_read_b32 v29, a230
    s_nop 0
    v_mul_f32 v29, v29, v28
    s_nop 0
    v_accvgpr_write_b32 a230, v29
    v_accvgpr_read_b32 v29, a231
    s_nop 0
    v_mul_f32 v29, v29, v28
    s_nop 0
    v_accvgpr_write_b32 a231, v29
    v_accvgpr_read_b32 v29, a232
    s_nop 0
    v_mul_f32 v29, v29, v28
    s_nop 0
    v_accvgpr_write_b32 a232, v29
    v_accvgpr_read_b32 v29, a233
    s_nop 0
    v_mul_f32 v29, v29, v28
    s_nop 0
    v_accvgpr_write_b32 a233, v29
    v_accvgpr_read_b32 v29, a234
    s_nop 0
    v_mul_f32 v29, v29, v28
    s_nop 0
    v_accvgpr_write_b32 a234, v29
    v_accvgpr_read_b32 v29, a235
    s_nop 0
    v_mul_f32 v29, v29, v28
    s_nop 0
    v_accvgpr_write_b32 a235, v29
    v_accvgpr_read_b32 v29, a236
    s_nop 0
    v_mul_f32 v29, v29, v28
    s_nop 0
    v_accvgpr_write_b32 a236, v29
    v_accvgpr_read_b32 v29, a237
    s_nop 0
    v_mul_f32 v29, v29, v28
    s_nop 0
    v_accvgpr_write_b32 a237, v29
    v_accvgpr_read_b32 v29, a238
    s_nop 0
    v_mul_f32 v29, v29, v28
    s_nop 0
    v_accvgpr_write_b32 a238, v29
    v_accvgpr_read_b32 v29, a239
    s_nop 0
    v_mul_f32 v29, v29, v28
    s_nop 0
    v_accvgpr_write_b32 a239, v29
    v_accvgpr_read_b32 v29, a240
    s_nop 0
    v_mul_f32 v29, v29, v28
    s_nop 0
    v_accvgpr_write_b32 a240, v29
    v_accvgpr_read_b32 v29, a241
    s_nop 0
    v_mul_f32 v29, v29, v28
    s_nop 0
    v_accvgpr_write_b32 a241, v29
    v_accvgpr_read_b32 v29, a242
    s_nop 0
    v_mul_f32 v29, v29, v28
    s_nop 0
    v_accvgpr_write_b32 a242, v29
    v_accvgpr_read_b32 v29, a243
    s_nop 0
    v_mul_f32 v29, v29, v28
    s_nop 0
    v_accvgpr_write_b32 a243, v29
    v_accvgpr_read_b32 v29, a244
    s_nop 0
    v_mul_f32 v29, v29, v28
    s_nop 0
    v_accvgpr_write_b32 a244, v29
    v_accvgpr_read_b32 v29, a245
    s_nop 0
    v_mul_f32 v29, v29, v28
    s_nop 0
    v_accvgpr_write_b32 a245, v29
    v_accvgpr_read_b32 v29, a246
    s_nop 0
    v_mul_f32 v29, v29, v28
    s_nop 0
    v_accvgpr_write_b32 a246, v29
    v_accvgpr_read_b32 v29, a247
    s_nop 0
    v_mul_f32 v29, v29, v28
    s_nop 0
    v_accvgpr_write_b32 a247, v29
    v_accvgpr_read_b32 v29, a248
    s_nop 0
    v_mul_f32 v29, v29, v28
    s_nop 0
    v_accvgpr_write_b32 a248, v29
    v_accvgpr_read_b32 v29, a249
    s_nop 0
    v_mul_f32 v29, v29, v28
    s_nop 0
    v_accvgpr_write_b32 a249, v29
    v_accvgpr_read_b32 v29, a250
    s_nop 0
    v_mul_f32 v29, v29, v28
    s_nop 0
    v_accvgpr_write_b32 a250, v29
    v_accvgpr_read_b32 v29, a251
    s_nop 0
    v_mul_f32 v29, v29, v28
    s_nop 0
    v_accvgpr_write_b32 a251, v29
    v_accvgpr_read_b32 v29, a252
    s_nop 0
    v_mul_f32 v29, v29, v28
    s_nop 0
    v_accvgpr_write_b32 a252, v29
    v_accvgpr_read_b32 v29, a253
    s_nop 0
    v_mul_f32 v29, v29, v28
    s_nop 0
    v_accvgpr_write_b32 a253, v29
    v_accvgpr_read_b32 v29, a254
    s_nop 0
    v_mul_f32 v29, v29, v28
    s_nop 0
    v_accvgpr_write_b32 a254, v29
    v_accvgpr_read_b32 v29, a255
    s_nop 0
    v_mul_f32 v29, v29, v28
    s_nop 0
    v_accvgpr_write_b32 a255, v29
    s_nop 7
    s_setpc_b64 s[44:45]
.globl reduce_kernel
.p2align 8
.type reduce_kernel,@function
reduce_kernel:
    s_cmp_ge_u32 s2, 392
    s_cbranch_scc1 reduce_kernel_end
    s_load_dwordx2 s[4:5], s[0:1], 40
    s_load_dwordx2 s[8:9], s[0:1], 56
    s_waitcnt lgkmcnt(0)
    s_mov_b32 s12, s4
    s_and_b32 s13, s5, 0xffff
    s_mov_b32 s14, 0xc4000
    s_mov_b32 s15, 0x00020000
    s_mov_b32 s20, s8
    s_and_b32 s21, s9, 0xffff
    s_mov_b32 s22, 0x1880000
    s_mov_b32 s23, 0x00020000
    s_lshl_b32 s3, s2, 8
    v_add_u32 v1, s3, v0
    v_lshlrev_b32 v2, 4, v1
    s_mov_b32 s24, 0
    buffer_load_dwordx4 v[8:11], v2, s[20:23], s24 offen
    s_add_u32 s24, s24, 1605632
    buffer_load_dwordx4 v[12:15], v2, s[20:23], s24 offen
    s_add_u32 s24, s24, 1605632
    buffer_load_dwordx4 v[16:19], v2, s[20:23], s24 offen
    s_add_u32 s24, s24, 1605632
    buffer_load_dwordx4 v[20:23], v2, s[20:23], s24 offen
    s_add_u32 s24, s24, 1605632
    buffer_load_dwordx4 v[24:27], v2, s[20:23], s24 offen
    s_add_u32 s24, s24, 1605632
    buffer_load_dwordx4 v[28:31], v2, s[20:23], s24 offen
    s_add_u32 s24, s24, 1605632
    buffer_load_dwordx4 v[32:35], v2, s[20:23], s24 offen
    s_add_u32 s24, s24, 1605632
    buffer_load_dwordx4 v[36:39], v2, s[20:23], s24 offen
    s_add_u32 s24, s24, 1605632
    buffer_load_dwordx4 v[40:43], v2, s[20:23], s24 offen
    s_add_u32 s24, s24, 1605632
    buffer_load_dwordx4 v[44:47], v2, s[20:23], s24 offen
    s_add_u32 s24, s24, 1605632
    buffer_load_dwordx4 v[48:51], v2, s[20:23], s24 offen
    s_add_u32 s24, s24, 1605632
    buffer_load_dwordx4 v[52:55], v2, s[20:23], s24 offen
    s_add_u32 s24, s24, 1605632
    buffer_load_dwordx4 v[56:59], v2, s[20:23], s24 offen
    s_add_u32 s24, s24, 1605632
    buffer_load_dwordx4 v[60:63], v2, s[20:23], s24 offen
    s_add_u32 s24, s24, 1605632
    buffer_load_dwordx4 v[64:67], v2, s[20:23], s24 offen
    s_add_u32 s24, s24, 1605632
    buffer_load_dwordx4 v[68:71], v2, s[20:23], s24 offen
    s_add_u32 s24, s24, 1605632
    s_waitcnt vmcnt(14)
    v_add_f32 v8, v8, v12
    v_add_f32 v9, v9, v13
    v_add_f32 v10, v10, v14
    v_add_f32 v11, v11, v15
    s_waitcnt vmcnt(13)
    v_add_f32 v8, v8, v16
    v_add_f32 v9, v9, v17
    v_add_f32 v10, v10, v18
    v_add_f32 v11, v11, v19
    s_waitcnt vmcnt(12)
    v_add_f32 v8, v8, v20
    v_add_f32 v9, v9, v21
    v_add_f32 v10, v10, v22
    v_add_f32 v11, v11, v23
    s_waitcnt vmcnt(11)
    v_add_f32 v8, v8, v24
    v_add_f32 v9, v9, v25
    v_add_f32 v10, v10, v26
    v_add_f32 v11, v11, v27
    s_waitcnt vmcnt(10)
    v_add_f32 v8, v8, v28
    v_add_f32 v9, v9, v29
    v_add_f32 v10, v10, v30
    v_add_f32 v11, v11, v31
    s_waitcnt vmcnt(9)
    v_add_f32 v8, v8, v32
    v_add_f32 v9, v9, v33
    v_add_f32 v10, v10, v34
    v_add_f32 v11, v11, v35
    s_waitcnt vmcnt(8)
    v_add_f32 v8, v8, v36
    v_add_f32 v9, v9, v37
    v_add_f32 v10, v10, v38
    v_add_f32 v11, v11, v39
    s_waitcnt vmcnt(7)
    v_add_f32 v8, v8, v40
    v_add_f32 v9, v9, v41
    v_add_f32 v10, v10, v42
    v_add_f32 v11, v11, v43
    s_waitcnt vmcnt(6)
    v_add_f32 v8, v8, v44
    v_add_f32 v9, v9, v45
    v_add_f32 v10, v10, v46
    v_add_f32 v11, v11, v47
    s_waitcnt vmcnt(5)
    v_add_f32 v8, v8, v48
    v_add_f32 v9, v9, v49
    v_add_f32 v10, v10, v50
    v_add_f32 v11, v11, v51
    s_waitcnt vmcnt(4)
    v_add_f32 v8, v8, v52
    v_add_f32 v9, v9, v53
    v_add_f32 v10, v10, v54
    v_add_f32 v11, v11, v55
    s_waitcnt vmcnt(3)
    v_add_f32 v8, v8, v56
    v_add_f32 v9, v9, v57
    v_add_f32 v10, v10, v58
    v_add_f32 v11, v11, v59
    s_waitcnt vmcnt(2)
    v_add_f32 v8, v8, v60
    v_add_f32 v9, v9, v61
    v_add_f32 v10, v10, v62
    v_add_f32 v11, v11, v63
    s_waitcnt vmcnt(1)
    v_add_f32 v8, v8, v64
    v_add_f32 v9, v9, v65
    v_add_f32 v10, v10, v66
    v_add_f32 v11, v11, v67
    s_waitcnt vmcnt(0)
    v_add_f32 v8, v8, v68
    v_add_f32 v9, v9, v69
    v_add_f32 v10, v10, v70
    v_add_f32 v11, v11, v71
    v_cvt_pk_bf16_f32 v4, v8, v9
    v_cvt_pk_bf16_f32 v5, v10, v11
    v_lshlrev_b32 v3, 3, v1
    buffer_store_dwordx2 v[4:5], v3, s[12:15], 0 offen
reduce_kernel_end:
    s_endpgm
.section .rodata,"a"
.p2align 6
.amdhsa_kernel fused_kernel
  .amdhsa_next_free_vgpr 512
  .amdhsa_next_free_sgpr 56
  .amdhsa_accum_offset 256
  .amdhsa_group_segment_fixed_size 0
  .amdhsa_kernarg_size 64
  .amdhsa_user_sgpr_count 2
  .amdhsa_user_sgpr_kernarg_segment_ptr 1
  .amdhsa_system_sgpr_workgroup_id_x 1
.end_amdhsa_kernel
.text
.section .rodata,"a"
.p2align 6
.amdhsa_kernel reduce_kernel
  .amdhsa_next_free_vgpr 80
  .amdhsa_next_free_sgpr 40
  .amdhsa_accum_offset 80
  .amdhsa_group_segment_fixed_size 0
  .amdhsa_kernarg_size 64
  .amdhsa_user_sgpr_count 2
  .amdhsa_user_sgpr_kernarg_segment_ptr 1
  .amdhsa_system_sgpr_workgroup_id_x 1
.end_amdhsa_kernel
.text
```
